```python
import torch

def _softmax(x, axis=-1):
    return torch.softmax(x, dim=axis)
def _gelu(x):
    return torch.nn.functional.gelu(x, approximate="tanh")
def _silu(x):
    return torch.nn.functional.silu(x)
def _sigmoid(x):
    return torch.sigmoid(x)
def _layernorm(x, axis=-1, eps=1e-5):
    m = x.mean(dim=axis, keepdim=True)
    v = x.var(dim=axis, keepdim=True, unbiased=False)
    return (x - m) / torch.sqrt(v + eps)
def _scatter_add(tgt, idx, src, axis=0):
    return tgt.clone().index_add_(axis, idx, src)
def _segment_sum(src, seg, n):
    out = torch.zeros((n,) + src.shape[1:], dtype=src.dtype)
    return out.index_add_(0, seg, src)
def _pad(x, pw):
    flat = tuple(v for pair in reversed(pw) for v in pair)
    return torch.nn.functional.pad(x, flat)

kernel_name = 'recurrent_scan__linear_attn_block__glu_gated_geglu__prompt'

def setup_inputs():

    _w = (lambda a: (lambda t: t.to(torch.bfloat16) if t.is_floating_point() else t)(torch.as_tensor(a)))
    def _A_setup():
        B, S, D = 1, 2048, 576
        return {
            "x": _w((lambda *s: torch.randn(*s, dtype=torch.bfloat16) * 0.05)(B, S, D)),
            "wqkv": _w((lambda *s: torch.randn(*s, dtype=torch.bfloat16) * 0.8)(D, 3 * D)),
            "wo": _w((lambda *s: torch.randn(*s, dtype=torch.bfloat16) * 0.8)(D, D)),
        }
    _A_in = _A_setup()

    def _B_setup():
        B, S, Dm, Df = 1, 2048, 576, 4608
        return {
            "x": _w((lambda *s: torch.randn(*s, dtype=torch.bfloat16) * 0.05)(B, S, Dm)),
            "w_gate": _w((lambda *s: torch.randn(*s, dtype=torch.bfloat16) * 0.2)(Dm, Df) * (Dm ** -0.5)),
            "w_up": _w((lambda *s: torch.randn(*s, dtype=torch.bfloat16) * 0.2)(Dm, Df) * (Dm ** -0.5)),
            "w_down": _w((lambda *s: torch.randn(*s, dtype=torch.bfloat16) * 0.2)(Df, Dm) * (Df ** -0.5)),
        }
    _B_in = _B_setup()

    return {
        "A_x": _A_in["x"],
        "A_wqkv": _A_in["wqkv"],
        "A_wo": _A_in["wo"],
        "B_x": _B_in["x"],
        "B_w_gate": _B_in["w_gate"],
        "B_w_up": _B_in["w_up"],
        "B_w_down": _B_in["w_down"],
    }

def reference(A_x, A_wqkv, A_wo, B_x, B_w_gate, B_w_up, B_w_down):
    def _A_ref(x, wqkv, wo):
        B, S, D = x.shape
        H = 32; Dh = D // H
        qkv = (lambda x, *d: x.permute(*d))((x @ wqkv).reshape(B, S, 3, H, Dh), 2, 0, 3, 1, 4)
        q, k, v = qkv[0], qkv[1], qkv[2]
        phi = lambda t: torch.where(t > 0, t + 1, torch.exp(t)) + 1e-6
        pq, pk = phi(q), phi(k)
        kv = torch.einsum("bhsd,bhse->bhde", pk, v)
        z = torch.einsum("bhsd->bhd", pk)
        num = torch.einsum("bhqd,bhde->bhqe", pq, kv)
        den = torch.einsum("bhqd,bhd->bhq", pq, z)[..., None] + 1e-6
        o = num / den
        return (lambda x, *d: x.permute(*d))(o, 0, 2, 1, 3).reshape(B, S, D) @ wo

    def _B_ref(x, w_gate, w_up, w_down):
        g = torch.einsum("bsd,df->bsf", x, w_gate)
        u = torch.einsum("bsd,df->bsf", x, w_up)
        h = _gelu(g) * u
        return torch.einsum("bsf,fd->bsd", h, w_down)

    x = A_x
    xn = _layernorm(x, axis=-1)
    s = _A_ref(xn, A_wqkv, A_wo)
    g = _silu(_B_ref(xn, B_w_gate, B_w_up, B_w_down))
    return x + s * g
```

```asm
; @launch grid=(256,1,1) block=(256,1,1) lds=163840
.amdgcn_target "amdgcn-amd-amdhsa--gfx950"
.text
.globl recurrent_scan__linear_attn_block__glu_gated_geglu__prompt_kernel
.p2align 8
.type recurrent_scan__linear_attn_block__glu_gated_geglu__prompt_kernel,@function
recurrent_scan__linear_attn_block__glu_gated_geglu__prompt_kernel:
  s_cmp_ge_u32 s2, 256
  s_cbranch_scc1 L_end
  s_load_dwordx16 s[48:63], s[0:1], 0
  s_load_dwordx4 s[64:67], s[0:1], 64
  v_and_b32 v208, 63, v0
  v_lshrrev_b32 v225, 6, v0
  s_nop 0
  v_readfirstlane_b32 s46, v225
  s_and_b32 s47, s2, 7
  s_lshl_b32 s47, s47, 1
  s_lshr_b32 s68, s2, 3
  s_and_b32 s68, s68, 1
  s_or_b32 s44, s47, s68
  s_lshr_b32 s45, s2, 4
  s_mov_b32 s100, s45
  v_bfe_u32 v225, v208, 2, 2
  v_lshrrev_b32 v226, 4, v208
  v_lshl_add_u32 v225, v225, 2, v226
  v_mul_u32_u24 v225, 1152, v225
  v_and_b32 v227, 3, v208
  v_xor_b32 v227, v227, v226
  v_lshl_add_u32 v215, v227, 4, v225
  v_add_u32 v216, 17408, v215
  s_lshl_b32 s81, s45, 2
  s_add_u32 s81, s81, s46
  s_mul_i32 s81, s81, 36864
  s_mul_i32 s83, s46, 36864
  s_waitcnt lgkmcnt(0)
  s_mov_b32 s8, s48
  s_and_b32 s9, s49, 0xffff
  s_mov_b32 s10, 2359296
  s_mov_b32 s11, 0x00020000
  s_add_u32 m0, s83, 0
  s_add_u32 s71, s81, 0
  buffer_load_dwordx4 v215, s[8:11], s71 offen lds
  buffer_load_dwordx4 v216, s[8:11], s71 offen offset:1024 lds
  s_add_u32 m0, s83, 2048
  s_add_u32 s71, s81, 64
  buffer_load_dwordx4 v215, s[8:11], s71 offen lds
  buffer_load_dwordx4 v216, s[8:11], s71 offen offset:1024 lds
  s_add_u32 m0, s83, 4096
  s_add_u32 s71, s81, 128
  buffer_load_dwordx4 v215, s[8:11], s71 offen lds
  buffer_load_dwordx4 v216, s[8:11], s71 offen offset:1024 lds
  s_add_u32 m0, s83, 6144
  s_add_u32 s71, s81, 192
  buffer_load_dwordx4 v215, s[8:11], s71 offen lds
  buffer_load_dwordx4 v216, s[8:11], s71 offen offset:1024 lds
  s_add_u32 m0, s83, 8192
  s_add_u32 s71, s81, 256
  buffer_load_dwordx4 v215, s[8:11], s71 offen lds
  buffer_load_dwordx4 v216, s[8:11], s71 offen offset:1024 lds
  s_add_u32 m0, s83, 10240
  s_add_u32 s71, s81, 320
  buffer_load_dwordx4 v215, s[8:11], s71 offen lds
  buffer_load_dwordx4 v216, s[8:11], s71 offen offset:1024 lds
  s_add_u32 m0, s83, 12288
  s_add_u32 s71, s81, 384
  buffer_load_dwordx4 v215, s[8:11], s71 offen lds
  buffer_load_dwordx4 v216, s[8:11], s71 offen offset:1024 lds
  s_add_u32 m0, s83, 14336
  s_add_u32 s71, s81, 448
  buffer_load_dwordx4 v215, s[8:11], s71 offen lds
  buffer_load_dwordx4 v216, s[8:11], s71 offen offset:1024 lds
  s_add_u32 m0, s83, 16384
  s_add_u32 s71, s81, 512
  buffer_load_dwordx4 v215, s[8:11], s71 offen lds
  buffer_load_dwordx4 v216, s[8:11], s71 offen offset:1024 lds
  s_add_u32 m0, s83, 18432
  s_add_u32 s71, s81, 576
  buffer_load_dwordx4 v215, s[8:11], s71 offen lds
  buffer_load_dwordx4 v216, s[8:11], s71 offen offset:1024 lds
  s_add_u32 m0, s83, 20480
  s_add_u32 s71, s81, 640
  buffer_load_dwordx4 v215, s[8:11], s71 offen lds
  buffer_load_dwordx4 v216, s[8:11], s71 offen offset:1024 lds
  s_add_u32 m0, s83, 22528
  s_add_u32 s71, s81, 704
  buffer_load_dwordx4 v215, s[8:11], s71 offen lds
  buffer_load_dwordx4 v216, s[8:11], s71 offen offset:1024 lds
  s_add_u32 m0, s83, 24576
  s_add_u32 s71, s81, 768
  buffer_load_dwordx4 v215, s[8:11], s71 offen lds
  buffer_load_dwordx4 v216, s[8:11], s71 offen offset:1024 lds
  s_add_u32 m0, s83, 26624
  s_add_u32 s71, s81, 832
  buffer_load_dwordx4 v215, s[8:11], s71 offen lds
  buffer_load_dwordx4 v216, s[8:11], s71 offen offset:1024 lds
  s_mov_b32 s12, s50
  s_and_b32 s13, s51, 0xffff
  s_mov_b32 s14, 1990656
  s_mov_b32 s15, 0x00020000
  s_mov_b32 s16, s52
  s_and_b32 s17, s53, 0xffff
  s_mov_b32 s18, 663552
  s_mov_b32 s19, 0x00020000
  s_mov_b32 s20, s56
  s_and_b32 s21, s57, 0xffff
  s_mov_b32 s22, 5308416
  s_mov_b32 s23, 0x00020000
  s_mov_b32 s24, s58
  s_and_b32 s25, s59, 0xffff
  s_mov_b32 s26, 5308416
  s_mov_b32 s27, 0x00020000
  s_mov_b32 s28, s60
  s_and_b32 s29, s61, 0xffff
  s_mov_b32 s30, 5308416
  s_mov_b32 s31, 0x00020000
  s_mov_b32 s32, s62
  s_and_b32 s33, s63, 0xffff
  s_mov_b32 s34, 2359296
  s_mov_b32 s35, 0x00020000
  s_mov_b32 s36, s64
  s_and_b32 s37, s65, 0xffff
  s_mov_b32 s38, 256
  s_mov_b32 s39, 0x00020000
  s_mov_b32 s40, s66
  s_and_b32 s41, s67, 0xffff
  s_mov_b32 s42, 268435456
  s_mov_b32 s43, 0x00020000
  s_lshr_b32 s94, s44, 2
  s_and_b32 s95, s44, 3
  v_lshlrev_b32 v224, 4, v208
  v_and_b32 v225, 16, v208
  v_and_b32 v226, 3, v208
  v_lshl_add_u32 v225, v226, 2, v225
  v_bfe_u32 v227, v208, 2, 2
  v_add_u32 v225, v225, v227
  v_lshlrev_b32 v225, 6, v225
  v_lshrrev_b32 v227, 5, v208
  v_xor_b32 v227, v227, v226
  v_lshl_add_u32 v225, v227, 4, v225
  v_add_u32 v209, s83, v225
  v_xor_b32 v210, 32, v209
  s_mul_i32 s72, s46, 3072
  s_and_b32 s47, s44, 1
  s_mul_i32 s68, s44, 72
  s_and_b32 s77, s68, 63
  s_sub_u32 s68, s68, s77
  s_mul_i32 s69, s46, 27648
  s_add_u32 s74, s68, s69
  s_mul_i32 s68, s44, 576
  s_lshl_b32 s69, s47, 6
  s_add_u32 s75, s68, s69
  s_mul_i32 s70, s46, 221184
  s_add_u32 s75, s75, s70
  s_xor_b32 s69, s47, 1
  s_lshl_b32 s69, s69, 9
  s_add_u32 s76, s68, s69
  s_mul_i32 s70, s46, 442368
  s_add_u32 s76, s76, s70
  s_and_b32 s99, s44, 1
  s_lshl_b32 s73, s46, 10
  s_mul_i32 s85, s46, 5120
  s_mov_b32 s47, s44
  s_and_b32 s68, s47, 1
  s_mul_i32 s69, s47, 288
  s_lshl_b32 s70, s68, 5
  s_add_u32 s70, s69, s70
  s_mul_i32 s70, s70, 1152
  s_lshl_b32 s68, s68, 8
  s_sub_u32 s69, s69, s68
  s_mul_i32 s69, s69, 1152
  s_mul_i32 s98, s99, 640
  s_add_u32 s48, s70, s98
  s_add_u32 s50, s69, s98
  s_mov_b32 s49, s48
  s_mul_i32 s98, s46, 27648
  s_add_u32 s48, s48, s98
  s_mul_i32 s98, s46, 9216
  s_add_u32 s49, s49, s98
  s_add_u32 s50, s50, s98
  s_lshl_b32 s98, s99, 6
  s_add_u32 s98, s98, 512
  s_add_u32 s54, s70, s98
  s_add_u32 s55, s69, s98
  s_mul_i32 s98, s46, 18432
  s_add_u32 s54, s54, s98
  s_and_b32 s98, s46, 1
  s_add_u32 s98, s98, 16
  s_mul_i32 s98, s98, 18432
  s_add_u32 s55, s55, s98
  s_xor_b32 s47, s44, 1
  s_and_b32 s68, s47, 1
  s_mul_i32 s69, s47, 288
  s_lshl_b32 s70, s68, 5
  s_add_u32 s70, s69, s70
  s_mul_i32 s70, s70, 1152
  s_lshl_b32 s68, s68, 8
  s_sub_u32 s69, s69, s68
  s_mul_i32 s69, s69, 1152
  s_mul_i32 s98, s99, 640
  s_add_u32 s51, s70, s98
  s_add_u32 s53, s69, s98
  s_mov_b32 s52, s51
  s_mul_i32 s98, s46, 27648
  s_add_u32 s51, s51, s98
  s_mul_i32 s98, s46, 9216
  s_add_u32 s52, s52, s98
  s_add_u32 s53, s53, s98
  s_lshl_b32 s98, s99, 6
  s_add_u32 s98, s98, 512
  s_add_u32 s56, s70, s98
  s_add_u32 s57, s69, s98
  s_mul_i32 s98, s46, 18432
  s_add_u32 s56, s56, s98
  s_and_b32 s98, s46, 1
  s_add_u32 s98, s98, 16
  s_mul_i32 s98, s98, 18432
  s_add_u32 s57, s57, s98
  s_lshl_b32 s68, s45, 2
  s_add_u32 s69, s68, s46
  s_mul_i32 s69, s69, 294912
  s_lshr_b32 s70, s44, 1
  s_lshl_b32 s70, s70, 10
  s_add_u32 s69, s69, s70
  s_mul_i32 s70, s99, 163840
  s_add_u32 s58, s69, s70
  s_lshl_b32 s70, s99, 14
  s_add_u32 s59, s69, s70
  s_add_u32 s59, s59, 131072
  s_add_u32 s69, s68, s94
  s_mul_i32 s69, s69, 36
  s_mul_i32 s70, s95, 9
  s_add_u32 s69, s69, s70
  s_lshl_b32 s80, s69, 13
  s_lshl_b32 s69, s45, 4
  s_add_u32 s69, s69, s44
  s_lshl_b32 s69, s69, 2
  s_add_u32 s69, s69, s46
  s_mul_i32 s69, s69, 18432
  s_add_u32 s60, s69, 18874368
  s_lshl_b32 s69, s45, 4
  s_xor_b32 s70, s44, 1
  s_add_u32 s69, s69, s70
  s_lshl_b32 s69, s69, 2
  s_add_u32 s69, s69, s46
  s_mul_i32 s69, s69, 18432
  s_add_u32 s61, s69, 18874368
  s_mul_i32 s69, s46, 165888
  s_mul_i32 s70, s95, 288
  s_and_b32 s70, s70, 0xffffffc0
  s_add_u32 s62, s69, s70
  s_add_u32 s69, s68, s94
  s_mul_i32 s69, s69, 36
  s_mul_i32 s70, s46, 9
  s_add_u32 s69, s69, s70
  s_lshl_b32 s69, s69, 10
  s_add_u32 s63, s69, 37748736
  s_lshl_b32 s69, s45, 7
  s_add_u32 s4, s69, 41156608
  s_lshl_b32 s70, s44, 2
  s_add_u32 s64, s4, s70
  s_lshl_b32 s69, s45, 4
  s_add_u32 s70, s69, s44
  s_lshl_b32 s70, s70, 7
  s_add_u32 s65, s70, 41160704
  s_xor_b32 s70, s44, 1
  s_add_u32 s70, s69, s70
  s_lshl_b32 s70, s70, 7
  s_add_u32 s67, s70, 41160704
  s_lshl_b32 s69, s45, 1
  s_add_u32 s70, s69, s99
  s_lshl_b32 s70, s70, 7
  s_lshr_b32 s98, s44, 1
  s_lshl_b32 s98, s98, 2
  s_add_u32 s70, s70, s98
  s_add_u32 s66, s70, 41222144
  s_lshr_b32 s70, s95, 1
  s_add_u32 s70, s69, s70
  s_lshl_b32 s70, s70, 7
  s_add_u32 s5, s70, 41222144
  s_lshl_b32 s0, s44, 2
  s_add_u32 s0, s0, 64
  v_mov_b32 v252, 0
  v_and_b32 v254, 15, v208
  v_lshlrev_b32 v254, 2, v254
  s_lshl_b32 s69, s46, 6
  v_add_u32 v253, s69, v208
  v_cmp_ne_u32 vcc, 0, v253
  v_mov_b32 v253, 0x70000000
  s_nop 0
  v_cndmask_b32 v253, 0, v253, vcc
  s_lshl_b32 s78, s44, 12
  s_add_u32 s78, s78, 40108032
  s_mov_b32 s90, 0xfff00000
  s_mov_b32 s91, 0xfff00000
  s_mov_b32 s92, 0x000fffff
  s_mov_b32 s93, 0x000fffff
  s_mov_b32 s86, 0x40000
  s_mov_b32 s87, 0x40000
  s_mov_b32 s88, 1
  s_mov_b32 s89, 1
  v_lshrrev_b32 v225, 2, v208
  v_add_u32 v225, 0, v225
  v_mul_u32_u24 v226, 43, v225
  v_lshrrev_b32 v226, 8, v226
  v_mul_u32_u24 v227, 6, v226
  v_sub_u32 v225, v225, v227
  v_bfe_u32 v227, v226, 1, 1
  v_sub_u32 v225, v225, v227
  v_add_u32 v227, 6, v225
  v_cmp_gt_i32 vcc, 0, v225
  s_nop 1
  v_cndmask_b32 v225, v225, v227, vcc
  v_lshrrev_b32 v227, 1, v225
  v_mul_u32_u24 v227, 1152, v227
  v_and_b32 v225, 1, v225
  v_lshl_add_u32 v227, v225, 6, v227
  v_mul_u32_u24 v226, 3456, v226
  v_add_u32 v227, v227, v226
  v_and_b32 v225, 3, v208
  v_lshl_add_u32 v227, v225, 4, v227
  v_mov_b32 v219, v227
  v_lshrrev_b32 v225, 2, v208
  v_add_u32 v225, 16, v225
  v_mul_u32_u24 v226, 43, v225
  v_lshrrev_b32 v226, 8, v226
  v_mul_u32_u24 v227, 6, v226
  v_sub_u32 v225, v225, v227
  v_bfe_u32 v227, v226, 1, 1
  v_sub_u32 v225, v225, v227
  v_add_u32 v227, 6, v225
  v_cmp_gt_i32 vcc, 0, v225
  s_nop 1
  v_cndmask_b32 v225, v225, v227, vcc
  v_lshrrev_b32 v227, 1, v225
  v_mul_u32_u24 v227, 1152, v227
  v_and_b32 v225, 1, v225
  v_lshl_add_u32 v227, v225, 6, v227
  v_mul_u32_u24 v226, 3456, v226
  v_add_u32 v227, v227, v226
  v_and_b32 v225, 3, v208
  v_lshl_add_u32 v227, v225, 4, v227
  v_subrev_u32 v220, 1024, v227
  v_lshrrev_b32 v225, 2, v208
  v_add_u32 v225, 32, v225
  v_mul_u32_u24 v226, 43, v225
  v_lshrrev_b32 v226, 8, v226
  v_mul_u32_u24 v227, 6, v226
  v_sub_u32 v225, v225, v227
  v_bfe_u32 v227, v226, 1, 1
  v_sub_u32 v225, v225, v227
  v_add_u32 v227, 6, v225
  v_cmp_gt_i32 vcc, 0, v225
  s_nop 1
  v_cndmask_b32 v225, v225, v227, vcc
  v_lshrrev_b32 v227, 1, v225
  v_mul_u32_u24 v227, 1152, v227
  v_and_b32 v225, 1, v225
  v_lshl_add_u32 v227, v225, 6, v227
  v_mul_u32_u24 v226, 3456, v226
  v_add_u32 v227, v227, v226
  v_and_b32 v225, 3, v208
  v_lshl_add_u32 v227, v225, 4, v227
  v_subrev_u32 v221, 2048, v227
  v_lshrrev_b32 v245, 5, v208
  v_mul_u32_u24 v245, 8, v245
  v_bfe_u32 v246, v208, 2, 2
  v_add_u32 v245, v245, v246
  v_mul_u32_u24 v211, 384, v245
  v_bfe_u32 v245, v208, 4, 1
  v_lshlrev_b32 v245, 2, v245
  v_and_b32 v246, 3, v208
  v_add_u32 v245, v245, v246
  v_lshlrev_b32 v246, 3, v245
  v_add_u32 v247, 0xffffffd8, v246
  v_add_u32 v246, 128, v246
  v_cmp_lt_u32 vcc, 4, v245
  s_nop 1
  v_cndmask_b32 v246, v246, v247, vcc
  v_add_u32 v246, s77, v246
  v_bfe_u32 v245, v208, 3, 1
  v_lshl_add_u32 v246, v245, 6, v246
  v_subrev_u32 v247, 384, v246
  v_cmp_le_u32 vcc, 384, v246
  s_nop 1
  v_cndmask_b32 v246, v246, v247, vcc
  v_add_u32 v211, v211, v246
  v_lshrrev_b32 v245, 5, v208
  v_mul_u32_u24 v245, 8, v245
  v_bfe_u32 v246, v208, 2, 2
  v_add_u32 v245, v245, v246
  v_mul_u32_u24 v212, 384, v245
  v_bfe_u32 v245, v208, 4, 1
  v_lshlrev_b32 v245, 2, v245
  v_and_b32 v246, 3, v208
  v_add_u32 v245, v245, v246
  v_lshlrev_b32 v246, 3, v245
  v_add_u32 v247, 0xfffffff0, v246
  v_add_u32 v246, 160, v246
  v_cmp_lt_u32 vcc, 4, v245
  s_nop 1
  v_cndmask_b32 v246, v246, v247, vcc
  v_add_u32 v246, s77, v246
  v_bfe_u32 v245, v208, 3, 1
  v_lshl_add_u32 v246, v245, 6, v246
  v_subrev_u32 v247, 384, v246
  v_cmp_le_u32 vcc, 384, v246
  s_nop 1
  v_cndmask_b32 v246, v246, v247, vcc
  v_add_u32 v212, v212, v246
  v_lshrrev_b32 v245, 5, v208
  v_mul_u32_u24 v245, 8, v245
  v_bfe_u32 v246, v208, 2, 2
  v_add_u32 v245, v245, v246
  v_mul_u32_u24 v213, 384, v245
  v_bfe_u32 v245, v208, 4, 1
  v_lshlrev_b32 v245, 2, v245
  v_and_b32 v246, 3, v208
  v_add_u32 v245, v245, v246
  v_lshlrev_b32 v246, 3, v245
  v_add_u32 v247, 8, v246
  v_add_u32 v246, 256, v246
  v_cmp_lt_u32 vcc, 4, v245
  s_nop 1
  v_cndmask_b32 v246, v246, v247, vcc
  v_add_u32 v246, s77, v246
  v_bfe_u32 v245, v208, 3, 1
  v_lshl_add_u32 v246, v245, 6, v246
  v_subrev_u32 v247, 384, v246
  v_cmp_le_u32 vcc, 384, v246
  s_nop 1
  v_cndmask_b32 v246, v246, v247, vcc
  v_add_u32 v213, v213, v246
  v_lshrrev_b32 v245, 5, v208
  v_mul_u32_u24 v245, 8, v245
  v_bfe_u32 v246, v208, 2, 2
  v_add_u32 v245, v245, v246
  v_mul_u32_u24 v214, 384, v245
  v_bfe_u32 v245, v208, 4, 1
  v_lshlrev_b32 v245, 2, v245
  v_and_b32 v246, 3, v208
  v_add_u32 v245, v245, v246
  v_lshlrev_b32 v246, 3, v245
  v_add_u32 v247, 216, v246
  v_add_u32 v246, 288, v246
  v_cmp_lt_u32 vcc, 4, v245
  s_nop 1
  v_cndmask_b32 v246, v246, v247, vcc
  v_add_u32 v246, s77, v246
  v_bfe_u32 v245, v208, 3, 1
  v_lshl_add_u32 v246, v245, 6, v246
  v_subrev_u32 v247, 384, v246
  v_cmp_le_u32 vcc, 384, v246
  s_nop 1
  v_cndmask_b32 v246, v246, v247, vcc
  v_add_u32 v214, v214, v246
  v_mov_b32 v223, 0xbdd2d3e8
  v_and_b32 v245, 31, v208
  v_subrev_u32 v239, 20, v245
  v_lshlrev_b32 v239, 8, v239
  v_lshrrev_b32 v246, 5, v208
  v_lshl_add_u32 v239, v246, 3, v239
  s_lshl_b32 s84, s46, 6
  s_add_u32 s84, s84, 147456
  v_add_u32 v239, s84, v239
  v_mul_u32_u24 v241, 20, v246
  v_add_u32 v241, v241, v245
  v_lshlrev_b32 v241, 4, v241
  s_mul_i32 s84, s46, 3840
  s_add_u32 s84, s84, 58368
  v_add_u32 v241, s84, v241
  s_lshl_b32 s84, s46, 6
  v_add_u32 v245, s84, v208
  v_min_u32 v246, 239, v245
  v_lshlrev_b32 v243, 4, v246
  v_lshlrev_b32 v237, 2, v246
  v_add_u32 v243, 58368, v243
  v_cmp_lt_u32 vcc, 239, v245
  v_mov_b32 v246, 0x70000000
  s_nop 0
  v_cndmask_b32 v237, v237, v246, vcc
  buffer_store_dword v252, v253, s[40:43], s64 offen sc1
  buffer_store_dword v252, v253, s[40:43], s65 offen sc1
  buffer_store_dword v252, v253, s[40:43], s66 offen sc1
  v_lshlrev_b32 v229, 2, v208
  s_cmp_eq_u32 s46, 0
  s_cselect_b32 s47, 0, 0x70000000
  v_add_u32 v229, s47, v229
  s_lshl_b32 s47, s45, 8
  s_add_u32 s47, s47, s78
  buffer_store_dword v252, v229, s[40:43], s47 offen sc1
  v_mov_b32 v238, 0x3f803f80
  v_mov_b32 v227, 0
  v_mov_b32 v228, 0
  v_mov_b32 v192, 0x3f803f80
  v_mov_b32 v193, 0x3f803f80
  v_mov_b32 v194, 0x3f803f80
  v_mov_b32 v195, 0x3f803f80
  s_waitcnt vmcnt(30)
  ds_read_b128 v[0:3], v209 offset:0
  ds_read_b128 v[4:7], v210 offset:0
  s_waitcnt vmcnt(28)
  ds_read_b128 v[8:11], v209 offset:2048
  ds_read_b128 v[12:15], v210 offset:2048
  s_waitcnt lgkmcnt(3)
  v_mfma_f32_32x32x16_bf16 v[144:159], v[192:195], v[0:3], 0
  v_dot2c_f32_bf16 v227, v0, v0
  v_dot2c_f32_bf16 v228, v1, v1
  v_dot2c_f32_bf16 v227, v2, v2
  v_dot2c_f32_bf16 v228, v3, v3
  s_waitcnt lgkmcnt(2)
  v_mfma_f32_32x32x16_bf16 v[144:159], v[192:195], v[4:7], v[144:159]
  v_dot2c_f32_bf16 v227, v4, v4
  v_dot2c_f32_bf16 v228, v5, v5
  v_dot2c_f32_bf16 v227, v6, v6
  v_dot2c_f32_bf16 v228, v7, v7
  s_add_u32 m0, s83, 28672
  s_add_u32 s71, s81, 896
  buffer_load_dwordx4 v215, s[8:11], s71 offen lds
  buffer_load_dwordx4 v216, s[8:11], s71 offen offset:1024 lds
  s_waitcnt vmcnt(28)
  ds_read_b128 v[16:19], v209 offset:4096
  ds_read_b128 v[20:23], v210 offset:4096
  s_waitcnt lgkmcnt(3)
  v_mfma_f32_32x32x16_bf16 v[144:159], v[192:195], v[8:11], v[144:159]
  v_dot2c_f32_bf16 v227, v8, v8
  v_dot2c_f32_bf16 v228, v9, v9
  v_dot2c_f32_bf16 v227, v10, v10
  v_dot2c_f32_bf16 v228, v11, v11
  s_waitcnt lgkmcnt(2)
  v_mfma_f32_32x32x16_bf16 v[144:159], v[192:195], v[12:15], v[144:159]
  v_dot2c_f32_bf16 v227, v12, v12
  v_dot2c_f32_bf16 v228, v13, v13
  v_dot2c_f32_bf16 v227, v14, v14
  v_dot2c_f32_bf16 v228, v15, v15
  s_add_u32 m0, s83, 30720
  s_add_u32 s71, s81, 960
  buffer_load_dwordx4 v215, s[8:11], s71 offen lds
  buffer_load_dwordx4 v216, s[8:11], s71 offen offset:1024 lds
  s_waitcnt vmcnt(28)
  ds_read_b128 v[24:27], v209 offset:6144
  ds_read_b128 v[28:31], v210 offset:6144
  s_waitcnt lgkmcnt(3)
  v_mfma_f32_32x32x16_bf16 v[144:159], v[192:195], v[16:19], v[144:159]
  v_dot2c_f32_bf16 v227, v16, v16
  v_dot2c_f32_bf16 v228, v17, v17
  v_dot2c_f32_bf16 v227, v18, v18
  v_dot2c_f32_bf16 v228, v19, v19
  s_waitcnt lgkmcnt(2)
  v_mfma_f32_32x32x16_bf16 v[144:159], v[192:195], v[20:23], v[144:159]
  v_dot2c_f32_bf16 v227, v20, v20
  v_dot2c_f32_bf16 v228, v21, v21
  v_dot2c_f32_bf16 v227, v22, v22
  v_dot2c_f32_bf16 v228, v23, v23
  s_add_u32 m0, s83, 32768
  s_add_u32 s71, s81, 1024
  buffer_load_dwordx4 v215, s[8:11], s71 offen lds
  buffer_load_dwordx4 v216, s[8:11], s71 offen offset:1024 lds
  s_waitcnt vmcnt(28)
  ds_read_b128 v[32:35], v209 offset:8192
  ds_read_b128 v[36:39], v210 offset:8192
  s_waitcnt lgkmcnt(3)
  v_mfma_f32_32x32x16_bf16 v[144:159], v[192:195], v[24:27], v[144:159]
  v_dot2c_f32_bf16 v227, v24, v24
  v_dot2c_f32_bf16 v228, v25, v25
  v_dot2c_f32_bf16 v227, v26, v26
  v_dot2c_f32_bf16 v228, v27, v27
  s_waitcnt lgkmcnt(2)
  v_mfma_f32_32x32x16_bf16 v[144:159], v[192:195], v[28:31], v[144:159]
  v_dot2c_f32_bf16 v227, v28, v28
  v_dot2c_f32_bf16 v228, v29, v29
  v_dot2c_f32_bf16 v227, v30, v30
  v_dot2c_f32_bf16 v228, v31, v31
  s_add_u32 m0, s83, 34816
  s_add_u32 s71, s81, 1088
  buffer_load_dwordx4 v215, s[8:11], s71 offen lds
  buffer_load_dwordx4 v216, s[8:11], s71 offen offset:1024 lds
  s_lshl_b32 s47, s46, 6
  v_add_u32 v230, s47, v208
  v_mul_u32_u24 v231, 171, v230
  v_lshrrev_b32 v231, 10, v231
  v_mul_u32_u24 v229, 6, v231
  v_sub_u32 v229, v230, v229
  v_min_u32 v231, 35, v231
  v_mul_u32_u24 v231, 3456, v231
  v_lshrrev_b32 v232, 1, v229
  v_mul_u32_u24 v232, 1152, v232
  v_add_u32 v231, v231, v232
  v_and_b32 v229, 1, v229
  v_lshl_add_u32 v231, v229, 6, v231
  s_mul_i32 s47, s100, 124416
  s_mul_i32 s68, s44, 72
  s_and_b32 s68, s68, 0xffffffc0
  s_add_u32 s47, s47, s68
  buffer_load_dword v232, v231, s[12:15], s47 offen
  s_lshl_b32 s47, s46, 6
  v_add_u32 v230, s47, v208
  s_getpc_b64 s[6:7]
L_pc:
  s_sub_u32 s6, s6, L_pc-recurrent_scan__linear_attn_block__glu_gated_geglu__prompt_kernel
  s_subb_u32 s7, s7, 0
  v_lshlrev_b32 v231, 7, v230
  global_load_dword v232, v231, s[6:7]
  v_add_u32 v231, 32768, v231
  v_min_u32 v231, CODE_BYTES_M4, v231
  global_load_dword v232, v231, s[6:7]
  s_waitcnt vmcnt(31)
  ds_read_b128 v[40:43], v209 offset:10240
  ds_read_b128 v[44:47], v210 offset:10240
  s_waitcnt lgkmcnt(3)
  v_mfma_f32_32x32x16_bf16 v[144:159], v[192:195], v[32:35], v[144:159]
  v_dot2c_f32_bf16 v227, v32, v32
  v_dot2c_f32_bf16 v228, v33, v33
  v_dot2c_f32_bf16 v227, v34, v34
  v_dot2c_f32_bf16 v228, v35, v35
  s_waitcnt lgkmcnt(2)
  v_mfma_f32_32x32x16_bf16 v[144:159], v[192:195], v[36:39], v[144:159]
  v_dot2c_f32_bf16 v227, v36, v36
  v_dot2c_f32_bf16 v228, v37, v37
  v_dot2c_f32_bf16 v227, v38, v38
  v_dot2c_f32_bf16 v228, v39, v39
  s_waitcnt vmcnt(29)
  ds_read_b128 v[48:51], v209 offset:12288
  ds_read_b128 v[52:55], v210 offset:12288
  s_waitcnt lgkmcnt(3)
  v_mfma_f32_32x32x16_bf16 v[144:159], v[192:195], v[40:43], v[144:159]
  v_dot2c_f32_bf16 v227, v40, v40
  v_dot2c_f32_bf16 v228, v41, v41
  v_dot2c_f32_bf16 v227, v42, v42
  v_dot2c_f32_bf16 v228, v43, v43
  s_waitcnt lgkmcnt(2)
  v_mfma_f32_32x32x16_bf16 v[144:159], v[192:195], v[44:47], v[144:159]
  v_dot2c_f32_bf16 v227, v44, v44
  v_dot2c_f32_bf16 v228, v45, v45
  v_dot2c_f32_bf16 v227, v46, v46
  v_dot2c_f32_bf16 v228, v47, v47
  s_waitcnt vmcnt(27)
  ds_read_b128 v[56:59], v209 offset:14336
  ds_read_b128 v[60:63], v210 offset:14336
  s_waitcnt lgkmcnt(3)
  v_mfma_f32_32x32x16_bf16 v[144:159], v[192:195], v[48:51], v[144:159]
  v_dot2c_f32_bf16 v227, v48, v48
  v_dot2c_f32_bf16 v228, v49, v49
  v_dot2c_f32_bf16 v227, v50, v50
  v_dot2c_f32_bf16 v228, v51, v51
  s_waitcnt lgkmcnt(2)
  v_mfma_f32_32x32x16_bf16 v[144:159], v[192:195], v[52:55], v[144:159]
  v_dot2c_f32_bf16 v227, v52, v52
  v_dot2c_f32_bf16 v228, v53, v53
  v_dot2c_f32_bf16 v227, v54, v54
  v_dot2c_f32_bf16 v228, v55, v55
  s_waitcnt vmcnt(25)
  ds_read_b128 v[64:67], v209 offset:16384
  ds_read_b128 v[68:71], v210 offset:16384
  s_waitcnt lgkmcnt(3)
  v_mfma_f32_32x32x16_bf16 v[144:159], v[192:195], v[56:59], v[144:159]
  v_dot2c_f32_bf16 v227, v56, v56
  v_dot2c_f32_bf16 v228, v57, v57
  v_dot2c_f32_bf16 v227, v58, v58
  v_dot2c_f32_bf16 v228, v59, v59
  s_waitcnt lgkmcnt(2)
  v_mfma_f32_32x32x16_bf16 v[144:159], v[192:195], v[60:63], v[144:159]
  v_dot2c_f32_bf16 v227, v60, v60
  v_dot2c_f32_bf16 v228, v61, v61
  v_dot2c_f32_bf16 v227, v62, v62
  v_dot2c_f32_bf16 v228, v63, v63
  s_waitcnt vmcnt(23)
  ds_read_b128 v[72:75], v209 offset:18432
  ds_read_b128 v[76:79], v210 offset:18432
  s_waitcnt lgkmcnt(3)
  v_mfma_f32_32x32x16_bf16 v[144:159], v[192:195], v[64:67], v[144:159]
  v_dot2c_f32_bf16 v227, v64, v64
  v_dot2c_f32_bf16 v228, v65, v65
  v_dot2c_f32_bf16 v227, v66, v66
  v_dot2c_f32_bf16 v228, v67, v67
  s_waitcnt lgkmcnt(2)
  v_mfma_f32_32x32x16_bf16 v[144:159], v[192:195], v[68:71], v[144:159]
  v_dot2c_f32_bf16 v227, v68, v68
  v_dot2c_f32_bf16 v228, v69, v69
  v_dot2c_f32_bf16 v227, v70, v70
  v_dot2c_f32_bf16 v228, v71, v71
  s_waitcnt vmcnt(21)
  ds_read_b128 v[80:83], v209 offset:20480
  ds_read_b128 v[84:87], v210 offset:20480
  s_waitcnt lgkmcnt(3)
  v_mfma_f32_32x32x16_bf16 v[144:159], v[192:195], v[72:75], v[144:159]
  v_dot2c_f32_bf16 v227, v72, v72
  v_dot2c_f32_bf16 v228, v73, v73
  v_dot2c_f32_bf16 v227, v74, v74
  v_dot2c_f32_bf16 v228, v75, v75
  s_waitcnt lgkmcnt(2)
  v_mfma_f32_32x32x16_bf16 v[144:159], v[192:195], v[76:79], v[144:159]
  v_dot2c_f32_bf16 v227, v76, v76
  v_dot2c_f32_bf16 v228, v77, v77
  v_dot2c_f32_bf16 v227, v78, v78
  v_dot2c_f32_bf16 v228, v79, v79
  s_waitcnt vmcnt(19)
  ds_read_b128 v[88:91], v209 offset:22528
  ds_read_b128 v[92:95], v210 offset:22528
  s_waitcnt lgkmcnt(3)
  v_mfma_f32_32x32x16_bf16 v[144:159], v[192:195], v[80:83], v[144:159]
  v_dot2c_f32_bf16 v227, v80, v80
  v_dot2c_f32_bf16 v228, v81, v81
  v_dot2c_f32_bf16 v227, v82, v82
  v_dot2c_f32_bf16 v228, v83, v83
  s_waitcnt lgkmcnt(2)
  v_mfma_f32_32x32x16_bf16 v[144:159], v[192:195], v[84:87], v[144:159]
  v_dot2c_f32_bf16 v227, v84, v84
  v_dot2c_f32_bf16 v228, v85, v85
  v_dot2c_f32_bf16 v227, v86, v86
  v_dot2c_f32_bf16 v228, v87, v87
  s_waitcnt vmcnt(17)
  ds_read_b128 v[96:99], v209 offset:24576
  ds_read_b128 v[100:103], v210 offset:24576
  s_waitcnt lgkmcnt(3)
  v_mfma_f32_32x32x16_bf16 v[144:159], v[192:195], v[88:91], v[144:159]
  v_dot2c_f32_bf16 v227, v88, v88
  v_dot2c_f32_bf16 v228, v89, v89
  v_dot2c_f32_bf16 v227, v90, v90
  v_dot2c_f32_bf16 v228, v91, v91
  s_waitcnt lgkmcnt(2)
  v_mfma_f32_32x32x16_bf16 v[144:159], v[192:195], v[92:95], v[144:159]
  v_dot2c_f32_bf16 v227, v92, v92
  v_dot2c_f32_bf16 v228, v93, v93
  v_dot2c_f32_bf16 v227, v94, v94
  v_dot2c_f32_bf16 v228, v95, v95
  s_waitcnt vmcnt(15)
  ds_read_b128 v[104:107], v209 offset:26624
  ds_read_b128 v[108:111], v210 offset:26624
  s_waitcnt lgkmcnt(3)
  v_mfma_f32_32x32x16_bf16 v[144:159], v[192:195], v[96:99], v[144:159]
  v_dot2c_f32_bf16 v227, v96, v96
  v_dot2c_f32_bf16 v228, v97, v97
  v_dot2c_f32_bf16 v227, v98, v98
  v_dot2c_f32_bf16 v228, v99, v99
  s_waitcnt lgkmcnt(2)
  v_mfma_f32_32x32x16_bf16 v[144:159], v[192:195], v[100:103], v[144:159]
  v_dot2c_f32_bf16 v227, v100, v100
  v_dot2c_f32_bf16 v228, v101, v101
  v_dot2c_f32_bf16 v227, v102, v102
  v_dot2c_f32_bf16 v228, v103, v103
  s_waitcnt vmcnt(9)
  ds_read_b128 v[112:115], v209 offset:28672
  ds_read_b128 v[116:119], v210 offset:28672
  s_waitcnt lgkmcnt(3)
  v_mfma_f32_32x32x16_bf16 v[144:159], v[192:195], v[104:107], v[144:159]
  v_dot2c_f32_bf16 v227, v104, v104
  v_dot2c_f32_bf16 v228, v105, v105
  v_dot2c_f32_bf16 v227, v106, v106
  v_dot2c_f32_bf16 v228, v107, v107
  s_waitcnt lgkmcnt(2)
  v_mfma_f32_32x32x16_bf16 v[144:159], v[192:195], v[108:111], v[144:159]
  v_dot2c_f32_bf16 v227, v108, v108
  v_dot2c_f32_bf16 v228, v109, v109
  v_dot2c_f32_bf16 v227, v110, v110
  v_dot2c_f32_bf16 v228, v111, v111
  s_waitcnt vmcnt(7)
  ds_read_b128 v[120:123], v209 offset:30720
  ds_read_b128 v[124:127], v210 offset:30720
  s_waitcnt lgkmcnt(3)
  v_mfma_f32_32x32x16_bf16 v[144:159], v[192:195], v[112:115], v[144:159]
  v_dot2c_f32_bf16 v227, v112, v112
  v_dot2c_f32_bf16 v228, v113, v113
  v_dot2c_f32_bf16 v227, v114, v114
  v_dot2c_f32_bf16 v228, v115, v115
  s_waitcnt lgkmcnt(2)
  v_mfma_f32_32x32x16_bf16 v[144:159], v[192:195], v[116:119], v[144:159]
  v_dot2c_f32_bf16 v227, v116, v116
  v_dot2c_f32_bf16 v228, v117, v117
  v_dot2c_f32_bf16 v227, v118, v118
  v_dot2c_f32_bf16 v228, v119, v119
  s_waitcnt vmcnt(5)
  ds_read_b128 v[128:131], v209 offset:32768
  ds_read_b128 v[132:135], v210 offset:32768
  s_waitcnt lgkmcnt(3)
  v_mfma_f32_32x32x16_bf16 v[144:159], v[192:195], v[120:123], v[144:159]
  v_dot2c_f32_bf16 v227, v120, v120
  v_dot2c_f32_bf16 v228, v121, v121
  v_dot2c_f32_bf16 v227, v122, v122
  v_dot2c_f32_bf16 v228, v123, v123
  s_waitcnt lgkmcnt(2)
  v_mfma_f32_32x32x16_bf16 v[144:159], v[192:195], v[124:127], v[144:159]
  v_dot2c_f32_bf16 v227, v124, v124
  v_dot2c_f32_bf16 v228, v125, v125
  v_dot2c_f32_bf16 v227, v126, v126
  v_dot2c_f32_bf16 v228, v127, v127
  s_waitcnt vmcnt(3)
  ds_read_b128 v[136:139], v209 offset:34816
  ds_read_b128 v[140:143], v210 offset:34816
  s_waitcnt lgkmcnt(3)
  v_mfma_f32_32x32x16_bf16 v[144:159], v[192:195], v[128:131], v[144:159]
  v_dot2c_f32_bf16 v227, v128, v128
  v_dot2c_f32_bf16 v228, v129, v129
  v_dot2c_f32_bf16 v227, v130, v130
  v_dot2c_f32_bf16 v228, v131, v131
  s_waitcnt lgkmcnt(2)
  v_mfma_f32_32x32x16_bf16 v[144:159], v[192:195], v[132:135], v[144:159]
  v_dot2c_f32_bf16 v227, v132, v132
  v_dot2c_f32_bf16 v228, v133, v133
  v_dot2c_f32_bf16 v227, v134, v134
  v_dot2c_f32_bf16 v228, v135, v135
  s_waitcnt lgkmcnt(1)
  v_mfma_f32_32x32x16_bf16 v[144:159], v[192:195], v[136:139], v[144:159]
  v_dot2c_f32_bf16 v227, v136, v136
  v_dot2c_f32_bf16 v228, v137, v137
  v_dot2c_f32_bf16 v227, v138, v138
  v_dot2c_f32_bf16 v228, v139, v139
  s_waitcnt lgkmcnt(0)
  v_mfma_f32_32x32x16_bf16 v[144:159], v[192:195], v[140:143], v[144:159]
  v_dot2c_f32_bf16 v227, v140, v140
  v_dot2c_f32_bf16 v228, v141, v141
  v_dot2c_f32_bf16 v227, v142, v142
  v_dot2c_f32_bf16 v228, v143, v143
  s_nop 2
  v_add_f32 v227, v227, v228
  v_mov_b32 v228, v227
  s_nop 1
  v_permlane32_swap_b32 v227, v228
  v_add_f32 v227, v227, v228
  v_mul_f32 v225, 0x3ae38e39, v144
  v_mul_f32 v227, 0x3ae38e39, v227
  v_fma_f32 v227, -v225, v225, v227
  v_max_f32 v227, 0, v227
  v_add_f32 v227, 0x3727c5ac, v227
  v_rsq_f32 v240, v227
  s_nop 0
  v_mul_f32 v242, v225, v240
  v_sub_f32 v242, 0, v242
  s_barrier
  s_add_u32 m0, s72, 0
  s_add_u32 s71, s74, 0
  buffer_load_dwordx4 v219, s[12:15], s71 offen offset:0 lds
  buffer_load_dwordx4 v220, s[12:15], s71 offen offset:1024 lds
  buffer_load_dwordx4 v221, s[12:15], s71 offen offset:2048 lds
  s_add_u32 m0, s72, 12288
  s_add_u32 s71, s74, 110592
  buffer_load_dwordx4 v219, s[12:15], s71 offen offset:0 lds
  buffer_load_dwordx4 v220, s[12:15], s71 offen offset:1024 lds
  buffer_load_dwordx4 v221, s[12:15], s71 offen offset:2048 lds
  v_lshlrev_b32 v244, 16, v0
  v_lshlrev_b32 v246, 16, v1
  v_and_b32 v245, 0xffff0000, v0
  v_and_b32 v247, 0xffff0000, v1
  v_pk_fma_f32 v[244:245], v[244:245], v[240:241], v[242:243] op_sel_hi:[1,0,0]
  v_pk_fma_f32 v[246:247], v[246:247], v[240:241], v[242:243] op_sel_hi:[1,0,0]
  v_cvt_pk_bf16_f32 v0, v244, v245
  v_cvt_pk_bf16_f32 v1, v246, v247
  v_lshlrev_b32 v244, 16, v2
  v_lshlrev_b32 v246, 16, v3
  v_and_b32 v245, 0xffff0000, v2
  v_and_b32 v247, 0xffff0000, v3
  v_pk_fma_f32 v[244:245], v[244:245], v[240:241], v[242:243] op_sel_hi:[1,0,0]
  v_pk_fma_f32 v[246:247], v[246:247], v[240:241], v[242:243] op_sel_hi:[1,0,0]
  v_cvt_pk_bf16_f32 v2, v244, v245
  v_cvt_pk_bf16_f32 v3, v246, v247
  v_lshlrev_b32 v244, 16, v4
  v_lshlrev_b32 v246, 16, v5
  v_and_b32 v245, 0xffff0000, v4
  v_and_b32 v247, 0xffff0000, v5
  v_pk_fma_f32 v[244:245], v[244:245], v[240:241], v[242:243] op_sel_hi:[1,0,0]
  v_pk_fma_f32 v[246:247], v[246:247], v[240:241], v[242:243] op_sel_hi:[1,0,0]
  v_cvt_pk_bf16_f32 v4, v244, v245
  v_cvt_pk_bf16_f32 v5, v246, v247
  v_lshlrev_b32 v244, 16, v6
  v_lshlrev_b32 v246, 16, v7
  v_and_b32 v245, 0xffff0000, v6
  v_and_b32 v247, 0xffff0000, v7
  s_add_u32 m0, s72, 24576
  s_add_u32 s71, s74, 221184
  buffer_load_dwordx4 v219, s[12:15], s71 offen offset:0 lds
  buffer_load_dwordx4 v220, s[12:15], s71 offen offset:1024 lds
  buffer_load_dwordx4 v221, s[12:15], s71 offen offset:2048 lds
  v_pk_fma_f32 v[244:245], v[244:245], v[240:241], v[242:243] op_sel_hi:[1,0,0]
  v_pk_fma_f32 v[246:247], v[246:247], v[240:241], v[242:243] op_sel_hi:[1,0,0]
  v_cvt_pk_bf16_f32 v6, v244, v245
  v_cvt_pk_bf16_f32 v7, v246, v247
  v_lshlrev_b32 v244, 16, v8
  v_lshlrev_b32 v246, 16, v9
  v_and_b32 v245, 0xffff0000, v8
  v_and_b32 v247, 0xffff0000, v9
  v_pk_fma_f32 v[244:245], v[244:245], v[240:241], v[242:243] op_sel_hi:[1,0,0]
  v_pk_fma_f32 v[246:247], v[246:247], v[240:241], v[242:243] op_sel_hi:[1,0,0]
  v_cvt_pk_bf16_f32 v8, v244, v245
  v_cvt_pk_bf16_f32 v9, v246, v247
  v_lshlrev_b32 v244, 16, v10
  v_lshlrev_b32 v246, 16, v11
  v_and_b32 v245, 0xffff0000, v10
  v_and_b32 v247, 0xffff0000, v11
  v_pk_fma_f32 v[244:245], v[244:245], v[240:241], v[242:243] op_sel_hi:[1,0,0]
  v_pk_fma_f32 v[246:247], v[246:247], v[240:241], v[242:243] op_sel_hi:[1,0,0]
  v_cvt_pk_bf16_f32 v10, v244, v245
  v_cvt_pk_bf16_f32 v11, v246, v247
  v_lshlrev_b32 v244, 16, v12
  v_lshlrev_b32 v246, 16, v13
  v_and_b32 v245, 0xffff0000, v12
  v_and_b32 v247, 0xffff0000, v13
  v_pk_fma_f32 v[244:245], v[244:245], v[240:241], v[242:243] op_sel_hi:[1,0,0]
  v_pk_fma_f32 v[246:247], v[246:247], v[240:241], v[242:243] op_sel_hi:[1,0,0]
  v_cvt_pk_bf16_f32 v12, v244, v245
  v_cvt_pk_bf16_f32 v13, v246, v247
  v_lshlrev_b32 v244, 16, v14
  v_lshlrev_b32 v246, 16, v15
  v_and_b32 v245, 0xffff0000, v14
  v_and_b32 v247, 0xffff0000, v15
  v_pk_fma_f32 v[244:245], v[244:245], v[240:241], v[242:243] op_sel_hi:[1,0,0]
  v_pk_fma_f32 v[246:247], v[246:247], v[240:241], v[242:243] op_sel_hi:[1,0,0]
  v_cvt_pk_bf16_f32 v14, v244, v245
  v_cvt_pk_bf16_f32 v15, v246, v247
  v_lshlrev_b32 v244, 16, v16
  v_lshlrev_b32 v246, 16, v17
  v_and_b32 v245, 0xffff0000, v16
  v_and_b32 v247, 0xffff0000, v17
  v_pk_fma_f32 v[244:245], v[244:245], v[240:241], v[242:243] op_sel_hi:[1,0,0]
  v_pk_fma_f32 v[246:247], v[246:247], v[240:241], v[242:243] op_sel_hi:[1,0,0]
  v_cvt_pk_bf16_f32 v16, v244, v245
  v_cvt_pk_bf16_f32 v17, v246, v247
  v_lshlrev_b32 v244, 16, v18
  v_lshlrev_b32 v246, 16, v19
  v_and_b32 v245, 0xffff0000, v18
  v_and_b32 v247, 0xffff0000, v19
  v_pk_fma_f32 v[244:245], v[244:245], v[240:241], v[242:243] op_sel_hi:[1,0,0]
  v_pk_fma_f32 v[246:247], v[246:247], v[240:241], v[242:243] op_sel_hi:[1,0,0]
  v_cvt_pk_bf16_f32 v18, v244, v245
  v_cvt_pk_bf16_f32 v19, v246, v247
  v_lshlrev_b32 v244, 16, v20
  v_lshlrev_b32 v246, 16, v21
  s_add_u32 m0, s72, 36864
  s_add_u32 s71, s74, 331776
  buffer_load_dwordx4 v219, s[12:15], s71 offen offset:0 lds
  buffer_load_dwordx4 v220, s[12:15], s71 offen offset:1024 lds
  buffer_load_dwordx4 v221, s[12:15], s71 offen offset:2048 lds
  v_and_b32 v245, 0xffff0000, v20
  v_and_b32 v247, 0xffff0000, v21
  v_pk_fma_f32 v[244:245], v[244:245], v[240:241], v[242:243] op_sel_hi:[1,0,0]
  v_pk_fma_f32 v[246:247], v[246:247], v[240:241], v[242:243] op_sel_hi:[1,0,0]
  v_cvt_pk_bf16_f32 v20, v244, v245
  v_cvt_pk_bf16_f32 v21, v246, v247
  v_lshlrev_b32 v244, 16, v22
  v_lshlrev_b32 v246, 16, v23
  v_and_b32 v245, 0xffff0000, v22
  v_and_b32 v247, 0xffff0000, v23
  v_pk_fma_f32 v[244:245], v[244:245], v[240:241], v[242:243] op_sel_hi:[1,0,0]
  v_pk_fma_f32 v[246:247], v[246:247], v[240:241], v[242:243] op_sel_hi:[1,0,0]
  v_cvt_pk_bf16_f32 v22, v244, v245
  v_cvt_pk_bf16_f32 v23, v246, v247
  v_lshlrev_b32 v244, 16, v24
  v_lshlrev_b32 v246, 16, v25
  v_and_b32 v245, 0xffff0000, v24
  v_and_b32 v247, 0xffff0000, v25
  v_pk_fma_f32 v[244:245], v[244:245], v[240:241], v[242:243] op_sel_hi:[1,0,0]
  v_pk_fma_f32 v[246:247], v[246:247], v[240:241], v[242:243] op_sel_hi:[1,0,0]
  v_cvt_pk_bf16_f32 v24, v244, v245
  v_cvt_pk_bf16_f32 v25, v246, v247
  v_lshlrev_b32 v244, 16, v26
  v_lshlrev_b32 v246, 16, v27
  v_and_b32 v245, 0xffff0000, v26
  v_and_b32 v247, 0xffff0000, v27
  v_pk_fma_f32 v[244:245], v[244:245], v[240:241], v[242:243] op_sel_hi:[1,0,0]
  v_pk_fma_f32 v[246:247], v[246:247], v[240:241], v[242:243] op_sel_hi:[1,0,0]
  v_cvt_pk_bf16_f32 v26, v244, v245
  v_cvt_pk_bf16_f32 v27, v246, v247
  v_lshlrev_b32 v244, 16, v28
  v_lshlrev_b32 v246, 16, v29
  v_and_b32 v245, 0xffff0000, v28
  v_and_b32 v247, 0xffff0000, v29
  v_pk_fma_f32 v[244:245], v[244:245], v[240:241], v[242:243] op_sel_hi:[1,0,0]
  v_pk_fma_f32 v[246:247], v[246:247], v[240:241], v[242:243] op_sel_hi:[1,0,0]
  v_cvt_pk_bf16_f32 v28, v244, v245
  v_cvt_pk_bf16_f32 v29, v246, v247
  v_lshlrev_b32 v244, 16, v30
  v_lshlrev_b32 v246, 16, v31
  v_and_b32 v245, 0xffff0000, v30
  v_and_b32 v247, 0xffff0000, v31
  v_pk_fma_f32 v[244:245], v[244:245], v[240:241], v[242:243] op_sel_hi:[1,0,0]
  v_pk_fma_f32 v[246:247], v[246:247], v[240:241], v[242:243] op_sel_hi:[1,0,0]
  v_cvt_pk_bf16_f32 v30, v244, v245
  v_cvt_pk_bf16_f32 v31, v246, v247
  v_lshlrev_b32 v244, 16, v32
  v_lshlrev_b32 v246, 16, v33
  v_and_b32 v245, 0xffff0000, v32
  v_and_b32 v247, 0xffff0000, v33
  v_pk_fma_f32 v[244:245], v[244:245], v[240:241], v[242:243] op_sel_hi:[1,0,0]
  v_pk_fma_f32 v[246:247], v[246:247], v[240:241], v[242:243] op_sel_hi:[1,0,0]
  v_cvt_pk_bf16_f32 v32, v244, v245
  v_cvt_pk_bf16_f32 v33, v246, v247
  s_add_u32 m0, s72, 49152
  s_add_u32 s71, s74, 442368
  buffer_load_dwordx4 v219, s[12:15], s71 offen offset:0 lds
  buffer_load_dwordx4 v220, s[12:15], s71 offen offset:1024 lds
  buffer_load_dwordx4 v221, s[12:15], s71 offen offset:2048 lds
  v_lshlrev_b32 v244, 16, v34
  v_lshlrev_b32 v246, 16, v35
  v_and_b32 v245, 0xffff0000, v34
  v_and_b32 v247, 0xffff0000, v35
  v_pk_fma_f32 v[244:245], v[244:245], v[240:241], v[242:243] op_sel_hi:[1,0,0]
  v_pk_fma_f32 v[246:247], v[246:247], v[240:241], v[242:243] op_sel_hi:[1,0,0]
  v_cvt_pk_bf16_f32 v34, v244, v245
  v_cvt_pk_bf16_f32 v35, v246, v247
  v_lshlrev_b32 v244, 16, v36
  v_lshlrev_b32 v246, 16, v37
  v_and_b32 v245, 0xffff0000, v36
  v_and_b32 v247, 0xffff0000, v37
  v_pk_fma_f32 v[244:245], v[244:245], v[240:241], v[242:243] op_sel_hi:[1,0,0]
  v_pk_fma_f32 v[246:247], v[246:247], v[240:241], v[242:243] op_sel_hi:[1,0,0]
  v_cvt_pk_bf16_f32 v36, v244, v245
  v_cvt_pk_bf16_f32 v37, v246, v247
  v_lshlrev_b32 v244, 16, v38
  v_lshlrev_b32 v246, 16, v39
  v_and_b32 v245, 0xffff0000, v38
  v_and_b32 v247, 0xffff0000, v39
  v_pk_fma_f32 v[244:245], v[244:245], v[240:241], v[242:243] op_sel_hi:[1,0,0]
  v_pk_fma_f32 v[246:247], v[246:247], v[240:241], v[242:243] op_sel_hi:[1,0,0]
  v_cvt_pk_bf16_f32 v38, v244, v245
  v_cvt_pk_bf16_f32 v39, v246, v247
  v_lshlrev_b32 v244, 16, v40
  v_lshlrev_b32 v246, 16, v41
  v_and_b32 v245, 0xffff0000, v40
  v_and_b32 v247, 0xffff0000, v41
  v_pk_fma_f32 v[244:245], v[244:245], v[240:241], v[242:243] op_sel_hi:[1,0,0]
  v_pk_fma_f32 v[246:247], v[246:247], v[240:241], v[242:243] op_sel_hi:[1,0,0]
  v_cvt_pk_bf16_f32 v40, v244, v245
  v_cvt_pk_bf16_f32 v41, v246, v247
  v_lshlrev_b32 v244, 16, v42
  v_lshlrev_b32 v246, 16, v43
  v_and_b32 v245, 0xffff0000, v42
  v_and_b32 v247, 0xffff0000, v43
  v_pk_fma_f32 v[244:245], v[244:245], v[240:241], v[242:243] op_sel_hi:[1,0,0]
  v_pk_fma_f32 v[246:247], v[246:247], v[240:241], v[242:243] op_sel_hi:[1,0,0]
  v_cvt_pk_bf16_f32 v42, v244, v245
  v_cvt_pk_bf16_f32 v43, v246, v247
  v_lshlrev_b32 v244, 16, v44
  v_lshlrev_b32 v246, 16, v45
  v_and_b32 v245, 0xffff0000, v44
  v_and_b32 v247, 0xffff0000, v45
  v_pk_fma_f32 v[244:245], v[244:245], v[240:241], v[242:243] op_sel_hi:[1,0,0]
  v_pk_fma_f32 v[246:247], v[246:247], v[240:241], v[242:243] op_sel_hi:[1,0,0]
  v_cvt_pk_bf16_f32 v44, v244, v245
  v_cvt_pk_bf16_f32 v45, v246, v247
  v_lshlrev_b32 v244, 16, v46
  v_lshlrev_b32 v246, 16, v47
  v_and_b32 v245, 0xffff0000, v46
  v_and_b32 v247, 0xffff0000, v47
  v_pk_fma_f32 v[244:245], v[244:245], v[240:241], v[242:243] op_sel_hi:[1,0,0]
  v_pk_fma_f32 v[246:247], v[246:247], v[240:241], v[242:243] op_sel_hi:[1,0,0]
  s_add_u32 m0, s72, 61440
  s_add_u32 s71, s74, 552960
  buffer_load_dwordx4 v219, s[12:15], s71 offen offset:0 lds
  buffer_load_dwordx4 v220, s[12:15], s71 offen offset:1024 lds
  buffer_load_dwordx4 v221, s[12:15], s71 offen offset:2048 lds
  v_cvt_pk_bf16_f32 v46, v244, v245
  v_cvt_pk_bf16_f32 v47, v246, v247
  v_lshlrev_b32 v244, 16, v48
  v_lshlrev_b32 v246, 16, v49
  v_and_b32 v245, 0xffff0000, v48
  v_and_b32 v247, 0xffff0000, v49
  v_pk_fma_f32 v[244:245], v[244:245], v[240:241], v[242:243] op_sel_hi:[1,0,0]
  v_pk_fma_f32 v[246:247], v[246:247], v[240:241], v[242:243] op_sel_hi:[1,0,0]
  v_cvt_pk_bf16_f32 v48, v244, v245
  v_cvt_pk_bf16_f32 v49, v246, v247
  v_lshlrev_b32 v244, 16, v50
  v_lshlrev_b32 v246, 16, v51
  v_and_b32 v245, 0xffff0000, v50
  v_and_b32 v247, 0xffff0000, v51
  v_pk_fma_f32 v[244:245], v[244:245], v[240:241], v[242:243] op_sel_hi:[1,0,0]
  v_pk_fma_f32 v[246:247], v[246:247], v[240:241], v[242:243] op_sel_hi:[1,0,0]
  v_cvt_pk_bf16_f32 v50, v244, v245
  v_cvt_pk_bf16_f32 v51, v246, v247
  v_lshlrev_b32 v244, 16, v52
  v_lshlrev_b32 v246, 16, v53
  v_and_b32 v245, 0xffff0000, v52
  v_and_b32 v247, 0xffff0000, v53
  v_pk_fma_f32 v[244:245], v[244:245], v[240:241], v[242:243] op_sel_hi:[1,0,0]
  v_pk_fma_f32 v[246:247], v[246:247], v[240:241], v[242:243] op_sel_hi:[1,0,0]
  v_cvt_pk_bf16_f32 v52, v244, v245
  v_cvt_pk_bf16_f32 v53, v246, v247
  v_lshlrev_b32 v244, 16, v54
  v_lshlrev_b32 v246, 16, v55
  v_and_b32 v245, 0xffff0000, v54
  v_and_b32 v247, 0xffff0000, v55
  v_pk_fma_f32 v[244:245], v[244:245], v[240:241], v[242:243] op_sel_hi:[1,0,0]
  v_pk_fma_f32 v[246:247], v[246:247], v[240:241], v[242:243] op_sel_hi:[1,0,0]
  v_cvt_pk_bf16_f32 v54, v244, v245
  v_cvt_pk_bf16_f32 v55, v246, v247
  v_lshlrev_b32 v244, 16, v56
  v_lshlrev_b32 v246, 16, v57
  v_and_b32 v245, 0xffff0000, v56
  v_and_b32 v247, 0xffff0000, v57
  v_pk_fma_f32 v[244:245], v[244:245], v[240:241], v[242:243] op_sel_hi:[1,0,0]
  v_pk_fma_f32 v[246:247], v[246:247], v[240:241], v[242:243] op_sel_hi:[1,0,0]
  v_cvt_pk_bf16_f32 v56, v244, v245
  v_cvt_pk_bf16_f32 v57, v246, v247
  v_lshlrev_b32 v244, 16, v58
  v_lshlrev_b32 v246, 16, v59
  v_and_b32 v245, 0xffff0000, v58
  v_and_b32 v247, 0xffff0000, v59
  v_pk_fma_f32 v[244:245], v[244:245], v[240:241], v[242:243] op_sel_hi:[1,0,0]
  v_pk_fma_f32 v[246:247], v[246:247], v[240:241], v[242:243] op_sel_hi:[1,0,0]
  v_cvt_pk_bf16_f32 v58, v244, v245
  v_cvt_pk_bf16_f32 v59, v246, v247
  v_lshlrev_b32 v244, 16, v60
  v_lshlrev_b32 v246, 16, v61
  v_and_b32 v245, 0xffff0000, v60
  v_and_b32 v247, 0xffff0000, v61
  v_pk_fma_f32 v[244:245], v[244:245], v[240:241], v[242:243] op_sel_hi:[1,0,0]
  s_add_u32 m0, s72, 73728
  s_add_u32 s71, s74, 663552
  buffer_load_dwordx4 v219, s[12:15], s71 offen offset:0 lds
  buffer_load_dwordx4 v220, s[12:15], s71 offen offset:1024 lds
  buffer_load_dwordx4 v221, s[12:15], s71 offen offset:2048 lds
  v_pk_fma_f32 v[246:247], v[246:247], v[240:241], v[242:243] op_sel_hi:[1,0,0]
  v_cvt_pk_bf16_f32 v60, v244, v245
  v_cvt_pk_bf16_f32 v61, v246, v247
  v_lshlrev_b32 v244, 16, v62
  v_lshlrev_b32 v246, 16, v63
  v_and_b32 v245, 0xffff0000, v62
  v_and_b32 v247, 0xffff0000, v63
  v_pk_fma_f32 v[244:245], v[244:245], v[240:241], v[242:243] op_sel_hi:[1,0,0]
  v_pk_fma_f32 v[246:247], v[246:247], v[240:241], v[242:243] op_sel_hi:[1,0,0]
  v_cvt_pk_bf16_f32 v62, v244, v245
  v_cvt_pk_bf16_f32 v63, v246, v247
  v_lshlrev_b32 v244, 16, v64
  v_lshlrev_b32 v246, 16, v65
  v_and_b32 v245, 0xffff0000, v64
  v_and_b32 v247, 0xffff0000, v65
  v_pk_fma_f32 v[244:245], v[244:245], v[240:241], v[242:243] op_sel_hi:[1,0,0]
  v_pk_fma_f32 v[246:247], v[246:247], v[240:241], v[242:243] op_sel_hi:[1,0,0]
  v_cvt_pk_bf16_f32 v64, v244, v245
  v_cvt_pk_bf16_f32 v65, v246, v247
  v_lshlrev_b32 v244, 16, v66
  v_lshlrev_b32 v246, 16, v67
  v_and_b32 v245, 0xffff0000, v66
  v_and_b32 v247, 0xffff0000, v67
  v_pk_fma_f32 v[244:245], v[244:245], v[240:241], v[242:243] op_sel_hi:[1,0,0]
  v_pk_fma_f32 v[246:247], v[246:247], v[240:241], v[242:243] op_sel_hi:[1,0,0]
  v_cvt_pk_bf16_f32 v66, v244, v245
  v_cvt_pk_bf16_f32 v67, v246, v247
  v_lshlrev_b32 v244, 16, v68
  v_lshlrev_b32 v246, 16, v69
  v_and_b32 v245, 0xffff0000, v68
  v_and_b32 v247, 0xffff0000, v69
  v_pk_fma_f32 v[244:245], v[244:245], v[240:241], v[242:243] op_sel_hi:[1,0,0]
  v_pk_fma_f32 v[246:247], v[246:247], v[240:241], v[242:243] op_sel_hi:[1,0,0]
  v_cvt_pk_bf16_f32 v68, v244, v245
  v_cvt_pk_bf16_f32 v69, v246, v247
  v_lshlrev_b32 v244, 16, v70
  v_lshlrev_b32 v246, 16, v71
  v_and_b32 v245, 0xffff0000, v70
  v_and_b32 v247, 0xffff0000, v71
  v_pk_fma_f32 v[244:245], v[244:245], v[240:241], v[242:243] op_sel_hi:[1,0,0]
  v_pk_fma_f32 v[246:247], v[246:247], v[240:241], v[242:243] op_sel_hi:[1,0,0]
  v_cvt_pk_bf16_f32 v70, v244, v245
  v_cvt_pk_bf16_f32 v71, v246, v247
  v_lshlrev_b32 v244, 16, v72
  v_lshlrev_b32 v246, 16, v73
  v_and_b32 v245, 0xffff0000, v72
  v_and_b32 v247, 0xffff0000, v73
  v_pk_fma_f32 v[244:245], v[244:245], v[240:241], v[242:243] op_sel_hi:[1,0,0]
  v_pk_fma_f32 v[246:247], v[246:247], v[240:241], v[242:243] op_sel_hi:[1,0,0]
  v_cvt_pk_bf16_f32 v72, v244, v245
  v_cvt_pk_bf16_f32 v73, v246, v247
  v_lshlrev_b32 v244, 16, v74
  v_lshlrev_b32 v246, 16, v75
  v_and_b32 v245, 0xffff0000, v74
  s_add_u32 m0, s72, 86016
  s_add_u32 s71, s74, 774144
  buffer_load_dwordx4 v219, s[12:15], s71 offen offset:0 lds
  buffer_load_dwordx4 v220, s[12:15], s71 offen offset:1024 lds
  buffer_load_dwordx4 v221, s[12:15], s71 offen offset:2048 lds
  v_and_b32 v247, 0xffff0000, v75
  v_pk_fma_f32 v[244:245], v[244:245], v[240:241], v[242:243] op_sel_hi:[1,0,0]
  v_pk_fma_f32 v[246:247], v[246:247], v[240:241], v[242:243] op_sel_hi:[1,0,0]
  v_cvt_pk_bf16_f32 v74, v244, v245
  v_cvt_pk_bf16_f32 v75, v246, v247
  v_lshlrev_b32 v244, 16, v76
  v_lshlrev_b32 v246, 16, v77
  v_and_b32 v245, 0xffff0000, v76
  v_and_b32 v247, 0xffff0000, v77
  v_pk_fma_f32 v[244:245], v[244:245], v[240:241], v[242:243] op_sel_hi:[1,0,0]
  v_pk_fma_f32 v[246:247], v[246:247], v[240:241], v[242:243] op_sel_hi:[1,0,0]
  v_cvt_pk_bf16_f32 v76, v244, v245
  v_cvt_pk_bf16_f32 v77, v246, v247
  v_lshlrev_b32 v244, 16, v78
  v_lshlrev_b32 v246, 16, v79
  v_and_b32 v245, 0xffff0000, v78
  v_and_b32 v247, 0xffff0000, v79
  v_pk_fma_f32 v[244:245], v[244:245], v[240:241], v[242:243] op_sel_hi:[1,0,0]
  v_pk_fma_f32 v[246:247], v[246:247], v[240:241], v[242:243] op_sel_hi:[1,0,0]
  v_cvt_pk_bf16_f32 v78, v244, v245
  v_cvt_pk_bf16_f32 v79, v246, v247
  v_lshlrev_b32 v244, 16, v80
  v_lshlrev_b32 v246, 16, v81
  v_and_b32 v245, 0xffff0000, v80
  v_and_b32 v247, 0xffff0000, v81
  v_pk_fma_f32 v[244:245], v[244:245], v[240:241], v[242:243] op_sel_hi:[1,0,0]
  v_pk_fma_f32 v[246:247], v[246:247], v[240:241], v[242:243] op_sel_hi:[1,0,0]
  v_cvt_pk_bf16_f32 v80, v244, v245
  v_cvt_pk_bf16_f32 v81, v246, v247
  v_lshlrev_b32 v244, 16, v82
  v_lshlrev_b32 v246, 16, v83
  v_and_b32 v245, 0xffff0000, v82
  v_and_b32 v247, 0xffff0000, v83
  v_pk_fma_f32 v[244:245], v[244:245], v[240:241], v[242:243] op_sel_hi:[1,0,0]
  v_pk_fma_f32 v[246:247], v[246:247], v[240:241], v[242:243] op_sel_hi:[1,0,0]
  v_cvt_pk_bf16_f32 v82, v244, v245
  v_cvt_pk_bf16_f32 v83, v246, v247
  v_lshlrev_b32 v244, 16, v84
  v_lshlrev_b32 v246, 16, v85
  v_and_b32 v245, 0xffff0000, v84
  v_and_b32 v247, 0xffff0000, v85
  v_pk_fma_f32 v[244:245], v[244:245], v[240:241], v[242:243] op_sel_hi:[1,0,0]
  v_pk_fma_f32 v[246:247], v[246:247], v[240:241], v[242:243] op_sel_hi:[1,0,0]
  v_cvt_pk_bf16_f32 v84, v244, v245
  v_cvt_pk_bf16_f32 v85, v246, v247
  v_lshlrev_b32 v244, 16, v86
  v_lshlrev_b32 v246, 16, v87
  v_and_b32 v245, 0xffff0000, v86
  v_and_b32 v247, 0xffff0000, v87
  v_pk_fma_f32 v[244:245], v[244:245], v[240:241], v[242:243] op_sel_hi:[1,0,0]
  v_pk_fma_f32 v[246:247], v[246:247], v[240:241], v[242:243] op_sel_hi:[1,0,0]
  v_cvt_pk_bf16_f32 v86, v244, v245
  v_cvt_pk_bf16_f32 v87, v246, v247
  v_lshlrev_b32 v244, 16, v88
  s_add_u32 m0, s72, 98304
  s_add_u32 s71, s74, 884736
  buffer_load_dwordx4 v219, s[12:15], s71 offen offset:0 lds
  buffer_load_dwordx4 v220, s[12:15], s71 offen offset:1024 lds
  buffer_load_dwordx4 v221, s[12:15], s71 offen offset:2048 lds
  v_lshlrev_b32 v246, 16, v89
  v_and_b32 v245, 0xffff0000, v88
  v_and_b32 v247, 0xffff0000, v89
  v_pk_fma_f32 v[244:245], v[244:245], v[240:241], v[242:243] op_sel_hi:[1,0,0]
  v_pk_fma_f32 v[246:247], v[246:247], v[240:241], v[242:243] op_sel_hi:[1,0,0]
  v_cvt_pk_bf16_f32 v88, v244, v245
  v_cvt_pk_bf16_f32 v89, v246, v247
  v_lshlrev_b32 v244, 16, v90
  v_lshlrev_b32 v246, 16, v91
  v_and_b32 v245, 0xffff0000, v90
  v_and_b32 v247, 0xffff0000, v91
  v_pk_fma_f32 v[244:245], v[244:245], v[240:241], v[242:243] op_sel_hi:[1,0,0]
  v_pk_fma_f32 v[246:247], v[246:247], v[240:241], v[242:243] op_sel_hi:[1,0,0]
  v_cvt_pk_bf16_f32 v90, v244, v245
  v_cvt_pk_bf16_f32 v91, v246, v247
  v_lshlrev_b32 v244, 16, v92
  v_lshlrev_b32 v246, 16, v93
  v_and_b32 v245, 0xffff0000, v92
  v_and_b32 v247, 0xffff0000, v93
  v_pk_fma_f32 v[244:245], v[244:245], v[240:241], v[242:243] op_sel_hi:[1,0,0]
  v_pk_fma_f32 v[246:247], v[246:247], v[240:241], v[242:243] op_sel_hi:[1,0,0]
  v_cvt_pk_bf16_f32 v92, v244, v245
  v_cvt_pk_bf16_f32 v93, v246, v247
  v_lshlrev_b32 v244, 16, v94
  v_lshlrev_b32 v246, 16, v95
  v_and_b32 v245, 0xffff0000, v94
  v_and_b32 v247, 0xffff0000, v95
  v_pk_fma_f32 v[244:245], v[244:245], v[240:241], v[242:243] op_sel_hi:[1,0,0]
  v_pk_fma_f32 v[246:247], v[246:247], v[240:241], v[242:243] op_sel_hi:[1,0,0]
  v_cvt_pk_bf16_f32 v94, v244, v245
  v_cvt_pk_bf16_f32 v95, v246, v247
  v_lshlrev_b32 v244, 16, v96
  v_lshlrev_b32 v246, 16, v97
  v_and_b32 v245, 0xffff0000, v96
  v_and_b32 v247, 0xffff0000, v97
  v_pk_fma_f32 v[244:245], v[244:245], v[240:241], v[242:243] op_sel_hi:[1,0,0]
  v_pk_fma_f32 v[246:247], v[246:247], v[240:241], v[242:243] op_sel_hi:[1,0,0]
  v_cvt_pk_bf16_f32 v96, v244, v245
  v_cvt_pk_bf16_f32 v97, v246, v247
  v_lshlrev_b32 v244, 16, v98
  v_lshlrev_b32 v246, 16, v99
  v_and_b32 v245, 0xffff0000, v98
  v_and_b32 v247, 0xffff0000, v99
  v_pk_fma_f32 v[244:245], v[244:245], v[240:241], v[242:243] op_sel_hi:[1,0,0]
  v_pk_fma_f32 v[246:247], v[246:247], v[240:241], v[242:243] op_sel_hi:[1,0,0]
  v_cvt_pk_bf16_f32 v98, v244, v245
  v_cvt_pk_bf16_f32 v99, v246, v247
  v_lshlrev_b32 v244, 16, v100
  v_lshlrev_b32 v246, 16, v101
  v_and_b32 v245, 0xffff0000, v100
  v_and_b32 v247, 0xffff0000, v101
  v_pk_fma_f32 v[244:245], v[244:245], v[240:241], v[242:243] op_sel_hi:[1,0,0]
  v_pk_fma_f32 v[246:247], v[246:247], v[240:241], v[242:243] op_sel_hi:[1,0,0]
  v_cvt_pk_bf16_f32 v100, v244, v245
  v_cvt_pk_bf16_f32 v101, v246, v247
  s_add_u32 m0, s72, 110592
  s_add_u32 s71, s74, 995328
  buffer_load_dwordx4 v219, s[12:15], s71 offen offset:0 lds
  buffer_load_dwordx4 v220, s[12:15], s71 offen offset:1024 lds
  buffer_load_dwordx4 v221, s[12:15], s71 offen offset:2048 lds
  v_lshlrev_b32 v244, 16, v102
  v_lshlrev_b32 v246, 16, v103
  v_and_b32 v245, 0xffff0000, v102
  v_and_b32 v247, 0xffff0000, v103
  v_pk_fma_f32 v[244:245], v[244:245], v[240:241], v[242:243] op_sel_hi:[1,0,0]
  v_pk_fma_f32 v[246:247], v[246:247], v[240:241], v[242:243] op_sel_hi:[1,0,0]
  v_cvt_pk_bf16_f32 v102, v244, v245
  v_cvt_pk_bf16_f32 v103, v246, v247
  v_lshlrev_b32 v244, 16, v104
  v_lshlrev_b32 v246, 16, v105
  v_and_b32 v245, 0xffff0000, v104
  v_and_b32 v247, 0xffff0000, v105
  v_pk_fma_f32 v[244:245], v[244:245], v[240:241], v[242:243] op_sel_hi:[1,0,0]
  v_pk_fma_f32 v[246:247], v[246:247], v[240:241], v[242:243] op_sel_hi:[1,0,0]
  v_cvt_pk_bf16_f32 v104, v244, v245
  v_cvt_pk_bf16_f32 v105, v246, v247
  v_lshlrev_b32 v244, 16, v106
  v_lshlrev_b32 v246, 16, v107
  v_and_b32 v245, 0xffff0000, v106
  v_and_b32 v247, 0xffff0000, v107
  v_pk_fma_f32 v[244:245], v[244:245], v[240:241], v[242:243] op_sel_hi:[1,0,0]
  v_pk_fma_f32 v[246:247], v[246:247], v[240:241], v[242:243] op_sel_hi:[1,0,0]
  v_cvt_pk_bf16_f32 v106, v244, v245
  v_cvt_pk_bf16_f32 v107, v246, v247
  v_lshlrev_b32 v244, 16, v108
  v_lshlrev_b32 v246, 16, v109
  v_and_b32 v245, 0xffff0000, v108
  v_and_b32 v247, 0xffff0000, v109
  v_pk_fma_f32 v[244:245], v[244:245], v[240:241], v[242:243] op_sel_hi:[1,0,0]
  v_pk_fma_f32 v[246:247], v[246:247], v[240:241], v[242:243] op_sel_hi:[1,0,0]
  v_cvt_pk_bf16_f32 v108, v244, v245
  v_cvt_pk_bf16_f32 v109, v246, v247
  v_lshlrev_b32 v244, 16, v110
  v_lshlrev_b32 v246, 16, v111
  v_and_b32 v245, 0xffff0000, v110
  v_and_b32 v247, 0xffff0000, v111
  v_pk_fma_f32 v[244:245], v[244:245], v[240:241], v[242:243] op_sel_hi:[1,0,0]
  v_pk_fma_f32 v[246:247], v[246:247], v[240:241], v[242:243] op_sel_hi:[1,0,0]
  v_cvt_pk_bf16_f32 v110, v244, v245
  v_cvt_pk_bf16_f32 v111, v246, v247
  v_lshlrev_b32 v244, 16, v112
  v_lshlrev_b32 v246, 16, v113
  v_and_b32 v245, 0xffff0000, v112
  v_and_b32 v247, 0xffff0000, v113
  v_pk_fma_f32 v[244:245], v[244:245], v[240:241], v[242:243] op_sel_hi:[1,0,0]
  v_pk_fma_f32 v[246:247], v[246:247], v[240:241], v[242:243] op_sel_hi:[1,0,0]
  v_cvt_pk_bf16_f32 v112, v244, v245
  v_cvt_pk_bf16_f32 v113, v246, v247
  v_lshlrev_b32 v244, 16, v114
  v_lshlrev_b32 v246, 16, v115
  v_and_b32 v245, 0xffff0000, v114
  v_and_b32 v247, 0xffff0000, v115
  v_pk_fma_f32 v[244:245], v[244:245], v[240:241], v[242:243] op_sel_hi:[1,0,0]
  v_pk_fma_f32 v[246:247], v[246:247], v[240:241], v[242:243] op_sel_hi:[1,0,0]
  s_add_u32 m0, s72, 122880
  s_add_u32 s71, s74, 1105920
  buffer_load_dwordx4 v219, s[12:15], s71 offen offset:0 lds
  buffer_load_dwordx4 v220, s[12:15], s71 offen offset:1024 lds
  buffer_load_dwordx4 v221, s[12:15], s71 offen offset:2048 lds
  v_cvt_pk_bf16_f32 v114, v244, v245
  v_cvt_pk_bf16_f32 v115, v246, v247
  v_lshlrev_b32 v244, 16, v116
  v_lshlrev_b32 v246, 16, v117
  v_and_b32 v245, 0xffff0000, v116
  v_and_b32 v247, 0xffff0000, v117
  v_pk_fma_f32 v[244:245], v[244:245], v[240:241], v[242:243] op_sel_hi:[1,0,0]
  v_pk_fma_f32 v[246:247], v[246:247], v[240:241], v[242:243] op_sel_hi:[1,0,0]
  v_cvt_pk_bf16_f32 v116, v244, v245
  v_cvt_pk_bf16_f32 v117, v246, v247
  v_lshlrev_b32 v244, 16, v118
  v_lshlrev_b32 v246, 16, v119
  v_and_b32 v245, 0xffff0000, v118
  v_and_b32 v247, 0xffff0000, v119
  v_pk_fma_f32 v[244:245], v[244:245], v[240:241], v[242:243] op_sel_hi:[1,0,0]
  v_pk_fma_f32 v[246:247], v[246:247], v[240:241], v[242:243] op_sel_hi:[1,0,0]
  v_cvt_pk_bf16_f32 v118, v244, v245
  v_cvt_pk_bf16_f32 v119, v246, v247
  v_lshlrev_b32 v244, 16, v120
  v_lshlrev_b32 v246, 16, v121
  v_and_b32 v245, 0xffff0000, v120
  v_and_b32 v247, 0xffff0000, v121
  v_pk_fma_f32 v[244:245], v[244:245], v[240:241], v[242:243] op_sel_hi:[1,0,0]
  v_pk_fma_f32 v[246:247], v[246:247], v[240:241], v[242:243] op_sel_hi:[1,0,0]
  v_cvt_pk_bf16_f32 v120, v244, v245
  v_cvt_pk_bf16_f32 v121, v246, v247
  v_lshlrev_b32 v244, 16, v122
  v_lshlrev_b32 v246, 16, v123
  v_and_b32 v245, 0xffff0000, v122
  v_and_b32 v247, 0xffff0000, v123
  v_pk_fma_f32 v[244:245], v[244:245], v[240:241], v[242:243] op_sel_hi:[1,0,0]
  v_pk_fma_f32 v[246:247], v[246:247], v[240:241], v[242:243] op_sel_hi:[1,0,0]
  v_cvt_pk_bf16_f32 v122, v244, v245
  v_cvt_pk_bf16_f32 v123, v246, v247
  v_lshlrev_b32 v244, 16, v124
  v_lshlrev_b32 v246, 16, v125
  v_and_b32 v245, 0xffff0000, v124
  v_and_b32 v247, 0xffff0000, v125
  v_pk_fma_f32 v[244:245], v[244:245], v[240:241], v[242:243] op_sel_hi:[1,0,0]
  v_pk_fma_f32 v[246:247], v[246:247], v[240:241], v[242:243] op_sel_hi:[1,0,0]
  v_cvt_pk_bf16_f32 v124, v244, v245
  v_cvt_pk_bf16_f32 v125, v246, v247
  v_lshlrev_b32 v244, 16, v126
  v_lshlrev_b32 v246, 16, v127
  v_and_b32 v245, 0xffff0000, v126
  v_and_b32 v247, 0xffff0000, v127
  v_pk_fma_f32 v[244:245], v[244:245], v[240:241], v[242:243] op_sel_hi:[1,0,0]
  v_pk_fma_f32 v[246:247], v[246:247], v[240:241], v[242:243] op_sel_hi:[1,0,0]
  v_cvt_pk_bf16_f32 v126, v244, v245
  v_cvt_pk_bf16_f32 v127, v246, v247
  v_lshlrev_b32 v244, 16, v128
  v_lshlrev_b32 v246, 16, v129
  v_and_b32 v245, 0xffff0000, v128
  v_and_b32 v247, 0xffff0000, v129
  s_add_u32 m0, s72, 135168
  s_add_u32 s71, s74, 1216512
  buffer_load_dwordx4 v219, s[12:15], s71 offen offset:0 lds
  buffer_load_dwordx4 v220, s[12:15], s71 offen offset:1024 lds
  buffer_load_dwordx4 v221, s[12:15], s71 offen offset:2048 lds
  v_pk_fma_f32 v[244:245], v[244:245], v[240:241], v[242:243] op_sel_hi:[1,0,0]
  v_pk_fma_f32 v[246:247], v[246:247], v[240:241], v[242:243] op_sel_hi:[1,0,0]
  v_cvt_pk_bf16_f32 v128, v244, v245
  v_cvt_pk_bf16_f32 v129, v246, v247
  v_lshlrev_b32 v244, 16, v130
  v_lshlrev_b32 v246, 16, v131
  v_and_b32 v245, 0xffff0000, v130
  v_and_b32 v247, 0xffff0000, v131
  v_pk_fma_f32 v[244:245], v[244:245], v[240:241], v[242:243] op_sel_hi:[1,0,0]
  v_pk_fma_f32 v[246:247], v[246:247], v[240:241], v[242:243] op_sel_hi:[1,0,0]
  v_cvt_pk_bf16_f32 v130, v244, v245
  v_cvt_pk_bf16_f32 v131, v246, v247
  v_lshlrev_b32 v244, 16, v132
  v_lshlrev_b32 v246, 16, v133
  v_and_b32 v245, 0xffff0000, v132
  v_and_b32 v247, 0xffff0000, v133
  v_pk_fma_f32 v[244:245], v[244:245], v[240:241], v[242:243] op_sel_hi:[1,0,0]
  v_pk_fma_f32 v[246:247], v[246:247], v[240:241], v[242:243] op_sel_hi:[1,0,0]
  v_cvt_pk_bf16_f32 v132, v244, v245
  v_cvt_pk_bf16_f32 v133, v246, v247
  v_lshlrev_b32 v244, 16, v134
  v_lshlrev_b32 v246, 16, v135
  v_and_b32 v245, 0xffff0000, v134
  v_and_b32 v247, 0xffff0000, v135
  v_pk_fma_f32 v[244:245], v[244:245], v[240:241], v[242:243] op_sel_hi:[1,0,0]
  v_pk_fma_f32 v[246:247], v[246:247], v[240:241], v[242:243] op_sel_hi:[1,0,0]
  v_cvt_pk_bf16_f32 v134, v244, v245
  v_cvt_pk_bf16_f32 v135, v246, v247
  v_lshlrev_b32 v244, 16, v136
  v_lshlrev_b32 v246, 16, v137
  v_and_b32 v245, 0xffff0000, v136
  v_and_b32 v247, 0xffff0000, v137
  v_pk_fma_f32 v[244:245], v[244:245], v[240:241], v[242:243] op_sel_hi:[1,0,0]
  v_pk_fma_f32 v[246:247], v[246:247], v[240:241], v[242:243] op_sel_hi:[1,0,0]
  v_cvt_pk_bf16_f32 v136, v244, v245
  v_cvt_pk_bf16_f32 v137, v246, v247
  v_lshlrev_b32 v244, 16, v138
  v_lshlrev_b32 v246, 16, v139
  v_and_b32 v245, 0xffff0000, v138
  v_and_b32 v247, 0xffff0000, v139
  v_pk_fma_f32 v[244:245], v[244:245], v[240:241], v[242:243] op_sel_hi:[1,0,0]
  v_pk_fma_f32 v[246:247], v[246:247], v[240:241], v[242:243] op_sel_hi:[1,0,0]
  v_cvt_pk_bf16_f32 v138, v244, v245
  v_cvt_pk_bf16_f32 v139, v246, v247
  v_lshlrev_b32 v244, 16, v140
  v_lshlrev_b32 v246, 16, v141
  v_and_b32 v245, 0xffff0000, v140
  v_and_b32 v247, 0xffff0000, v141
  v_pk_fma_f32 v[244:245], v[244:245], v[240:241], v[242:243] op_sel_hi:[1,0,0]
  v_pk_fma_f32 v[246:247], v[246:247], v[240:241], v[242:243] op_sel_hi:[1,0,0]
  v_cvt_pk_bf16_f32 v140, v244, v245
  v_cvt_pk_bf16_f32 v141, v246, v247
  v_lshlrev_b32 v244, 16, v142
  v_lshlrev_b32 v246, 16, v143
  v_and_b32 v245, 0xffff0000, v142
  v_and_b32 v247, 0xffff0000, v143
  v_pk_fma_f32 v[244:245], v[244:245], v[240:241], v[242:243] op_sel_hi:[1,0,0]
  v_pk_fma_f32 v[246:247], v[246:247], v[240:241], v[242:243] op_sel_hi:[1,0,0]
  v_cvt_pk_bf16_f32 v142, v244, v245
  v_cvt_pk_bf16_f32 v143, v246, v247
  s_lshl_b32 s47, s46, 6
  v_add_u32 v248, s47, v208
  v_min_u32 v248, 35, v248
  v_mul_u32_u24 v248, 9216, v248
  s_mul_i32 s101, s100, 331776
  s_mul_i32 s70, s44, 576
  s_add_u32 s70, s70, s101
  s_lshl_b32 s69, s99, 6
  s_add_u32 s70, s70, s69
  s_add_u32 s70, s70, 0
  buffer_load_dword v249, v248, s[20:23], s70 offen
  buffer_load_dword v249, v248, s[24:27], s70 offen
  v_lshrrev_b32 v245, 3, v208
  v_and_b32 v246, 7, v208
  v_bfe_u32 v215, v245, 1, 1
  v_lshlrev_b32 v215, 2, v215
  v_xor_b32 v246, v246, v215
  v_mul_u32_u24 v245, 9216, v245
  v_lshl_add_u32 v215, v246, 4, v245
  v_add_u32 v216, 72704, v215
  v_add_u32 v217, 145408, v215
  s_waitcnt vmcnt(29)
  s_barrier
  v_mov_b32 v255, 1
  s_lshl_b32 s47, s44, 2
  s_add_u32 s47, s47, 64
  buffer_atomic_add v255, v253, s[36:39], s47 offen sc1
  v_mov_b32 v209, v211
  ds_read_b64_tr_b16 a[72:73], v209 offset:0
  ds_read_b64_tr_b16 a[74:75], v209 offset:1536
  v_mov_b32 v210, v212
  ds_read_b64_tr_b16 a[76:77], v210 offset:0
  ds_read_b64_tr_b16 a[78:79], v210 offset:1536
  v_mov_b32 v250, v213
  ds_read_b64_tr_b16 a[80:81], v250 offset:0
  ds_read_b64_tr_b16 a[82:83], v250 offset:1536
  v_mov_b32 v251, v214
  ds_read_b64_tr_b16 a[84:85], v251 offset:0
  ds_read_b64_tr_b16 a[86:87], v251 offset:1536
  s_waitcnt lgkmcnt(4)
  v_mfma_f32_32x32x16_bf16 v[144:159], v[0:3], a[72:75], 0
  ds_read_b64_tr_b16 a[88:89], v209 offset:6144
  ds_read_b64_tr_b16 a[90:91], v209 offset:7680
  v_mfma_f32_32x32x16_bf16 v[160:175], v[0:3], a[76:79], 0
  ds_read_b64_tr_b16 a[92:93], v210 offset:6144
  ds_read_b64_tr_b16 a[94:95], v210 offset:7680
  s_waitcnt lgkmcnt(4)
  v_mfma_f32_32x32x16_bf16 v[176:191], v[0:3], a[80:83], 0
  ds_read_b64_tr_b16 a[72:73], v250 offset:6144
  ds_read_b64_tr_b16 a[74:75], v250 offset:7680
  v_mfma_f32_32x32x16_bf16 v[192:207], v[0:3], a[84:87], 0
  ds_read_b64_tr_b16 a[76:77], v251 offset:6144
  ds_read_b64_tr_b16 a[78:79], v251 offset:7680
  s_waitcnt lgkmcnt(4)
  v_mfma_f32_32x32x16_bf16 v[144:159], v[4:7], a[88:91], v[144:159]
  ds_read_b64_tr_b16 a[80:81], v209 offset:12288
  ds_read_b64_tr_b16 a[82:83], v209 offset:13824
  v_mfma_f32_32x32x16_bf16 v[160:175], v[4:7], a[92:95], v[160:175]
  ds_read_b64_tr_b16 a[84:85], v210 offset:12288
  ds_read_b64_tr_b16 a[86:87], v210 offset:13824
  s_waitcnt lgkmcnt(4)
  v_mfma_f32_32x32x16_bf16 v[176:191], v[4:7], a[72:75], v[176:191]
  ds_read_b64_tr_b16 a[88:89], v250 offset:12288
  ds_read_b64_tr_b16 a[90:91], v250 offset:13824
  v_mfma_f32_32x32x16_bf16 v[192:207], v[4:7], a[76:79], v[192:207]
  ds_read_b64_tr_b16 a[92:93], v251 offset:12288
  ds_read_b64_tr_b16 a[94:95], v251 offset:13824
  s_waitcnt lgkmcnt(4)
  v_mfma_f32_32x32x16_bf16 v[144:159], v[8:11], a[80:83], v[144:159]
  ds_read_b64_tr_b16 a[72:73], v209 offset:18432
  ds_read_b64_tr_b16 a[74:75], v209 offset:19968
  v_mfma_f32_32x32x16_bf16 v[160:175], v[8:11], a[84:87], v[160:175]
  ds_read_b64_tr_b16 a[76:77], v210 offset:18432
  ds_read_b64_tr_b16 a[78:79], v210 offset:19968
  s_waitcnt lgkmcnt(4)
  v_mfma_f32_32x32x16_bf16 v[176:191], v[8:11], a[88:91], v[176:191]
  ds_read_b64_tr_b16 a[80:81], v250 offset:18432
  ds_read_b64_tr_b16 a[82:83], v250 offset:19968
  v_mfma_f32_32x32x16_bf16 v[192:207], v[8:11], a[92:95], v[192:207]
  ds_read_b64_tr_b16 a[84:85], v251 offset:18432
  ds_read_b64_tr_b16 a[86:87], v251 offset:19968
  s_waitcnt lgkmcnt(4)
  v_mfma_f32_32x32x16_bf16 v[144:159], v[12:15], a[72:75], v[144:159]
  ds_read_b64_tr_b16 a[88:89], v209 offset:24576
  ds_read_b64_tr_b16 a[90:91], v209 offset:26112
  v_mfma_f32_32x32x16_bf16 v[160:175], v[12:15], a[76:79], v[160:175]
  ds_read_b64_tr_b16 a[92:93], v210 offset:24576
  ds_read_b64_tr_b16 a[94:95], v210 offset:26112
  s_waitcnt lgkmcnt(4)
  v_mfma_f32_32x32x16_bf16 v[176:191], v[12:15], a[80:83], v[176:191]
  ds_read_b64_tr_b16 a[72:73], v250 offset:24576
  ds_read_b64_tr_b16 a[74:75], v250 offset:26112
  v_mfma_f32_32x32x16_bf16 v[192:207], v[12:15], a[84:87], v[192:207]
  s_waitcnt vmcnt(24)
  s_barrier
  ds_read_b64_tr_b16 a[76:77], v251 offset:24576
  ds_read_b64_tr_b16 a[78:79], v251 offset:26112
  s_add_u32 m0, s72, 0
  s_add_u32 s71, s74, 1327104
  s_waitcnt lgkmcnt(4)
  v_mfma_f32_32x32x16_bf16 v[144:159], v[16:19], a[88:91], v[144:159]
  ds_read_b64_tr_b16 a[80:81], v209 offset:30720
  ds_read_b64_tr_b16 a[82:83], v209 offset:32256
  buffer_load_dwordx4 v219, s[12:15], s71 offen offset:0 lds
  v_mfma_f32_32x32x16_bf16 v[160:175], v[16:19], a[92:95], v[160:175]
  ds_read_b64_tr_b16 a[84:85], v210 offset:30720
  ds_read_b64_tr_b16 a[86:87], v210 offset:32256
  s_waitcnt lgkmcnt(4)
  v_mfma_f32_32x32x16_bf16 v[176:191], v[16:19], a[72:75], v[176:191]
  ds_read_b64_tr_b16 a[88:89], v250 offset:30720
  ds_read_b64_tr_b16 a[90:91], v250 offset:32256
  buffer_load_dwordx4 v220, s[12:15], s71 offen offset:1024 lds
  v_mfma_f32_32x32x16_bf16 v[192:207], v[16:19], a[76:79], v[192:207]
  ds_read_b64_tr_b16 a[92:93], v251 offset:30720
  ds_read_b64_tr_b16 a[94:95], v251 offset:32256
  s_waitcnt lgkmcnt(4)
  v_mfma_f32_32x32x16_bf16 v[144:159], v[20:23], a[80:83], v[144:159]
  ds_read_b64_tr_b16 a[72:73], v209 offset:36864
  ds_read_b64_tr_b16 a[74:75], v209 offset:38400
  buffer_load_dwordx4 v221, s[12:15], s71 offen offset:2048 lds
  v_mfma_f32_32x32x16_bf16 v[160:175], v[20:23], a[84:87], v[160:175]
  ds_read_b64_tr_b16 a[76:77], v210 offset:36864
  ds_read_b64_tr_b16 a[78:79], v210 offset:38400
  s_add_u32 m0, s72, 12288
  s_add_u32 s71, s74, 1437696
  s_waitcnt lgkmcnt(4)
  v_mfma_f32_32x32x16_bf16 v[176:191], v[20:23], a[88:91], v[176:191]
  ds_read_b64_tr_b16 a[80:81], v250 offset:36864
  ds_read_b64_tr_b16 a[82:83], v250 offset:38400
  buffer_load_dwordx4 v219, s[12:15], s71 offen offset:0 lds
  v_mfma_f32_32x32x16_bf16 v[192:207], v[20:23], a[92:95], v[192:207]
  ds_read_b64_tr_b16 a[84:85], v251 offset:36864
  ds_read_b64_tr_b16 a[86:87], v251 offset:38400
  s_waitcnt lgkmcnt(4)
  v_mfma_f32_32x32x16_bf16 v[144:159], v[24:27], a[72:75], v[144:159]
  ds_read_b64_tr_b16 a[88:89], v209 offset:43008
  ds_read_b64_tr_b16 a[90:91], v209 offset:44544
  buffer_load_dwordx4 v220, s[12:15], s71 offen offset:1024 lds
  v_mfma_f32_32x32x16_bf16 v[160:175], v[24:27], a[76:79], v[160:175]
  ds_read_b64_tr_b16 a[92:93], v210 offset:43008
  ds_read_b64_tr_b16 a[94:95], v210 offset:44544
  s_waitcnt lgkmcnt(4)
  v_mfma_f32_32x32x16_bf16 v[176:191], v[24:27], a[80:83], v[176:191]
  ds_read_b64_tr_b16 a[72:73], v250 offset:43008
  ds_read_b64_tr_b16 a[74:75], v250 offset:44544
  buffer_load_dwordx4 v221, s[12:15], s71 offen offset:2048 lds
  v_mfma_f32_32x32x16_bf16 v[192:207], v[24:27], a[84:87], v[192:207]
  ds_read_b64_tr_b16 a[76:77], v251 offset:43008
  ds_read_b64_tr_b16 a[78:79], v251 offset:44544
  s_waitcnt lgkmcnt(4)
  v_mfma_f32_32x32x16_bf16 v[144:159], v[28:31], a[88:91], v[144:159]
  ds_read_b64_tr_b16 a[80:81], v209 offset:49152
  ds_read_b64_tr_b16 a[82:83], v209 offset:50688
  v_mfma_f32_32x32x16_bf16 v[160:175], v[28:31], a[92:95], v[160:175]
  ds_read_b64_tr_b16 a[84:85], v210 offset:49152
  ds_read_b64_tr_b16 a[86:87], v210 offset:50688
  s_waitcnt lgkmcnt(4)
  v_mfma_f32_32x32x16_bf16 v[176:191], v[28:31], a[72:75], v[176:191]
  ds_read_b64_tr_b16 a[88:89], v250 offset:49152
  ds_read_b64_tr_b16 a[90:91], v250 offset:50688
  v_mfma_f32_32x32x16_bf16 v[192:207], v[28:31], a[76:79], v[192:207]
  s_waitcnt vmcnt(24)
  s_barrier
  ds_read_b64_tr_b16 a[92:93], v251 offset:49152
  ds_read_b64_tr_b16 a[94:95], v251 offset:50688
  s_add_u32 m0, s72, 24576
  s_add_u32 s71, s74, 1548288
  s_waitcnt lgkmcnt(4)
  v_mfma_f32_32x32x16_bf16 v[144:159], v[32:35], a[80:83], v[144:159]
  ds_read_b64_tr_b16 a[72:73], v209 offset:55296
  ds_read_b64_tr_b16 a[74:75], v209 offset:56832
  buffer_load_dwordx4 v219, s[12:15], s71 offen offset:0 lds
  v_mfma_f32_32x32x16_bf16 v[160:175], v[32:35], a[84:87], v[160:175]
  ds_read_b64_tr_b16 a[76:77], v210 offset:55296
  ds_read_b64_tr_b16 a[78:79], v210 offset:56832
  s_waitcnt lgkmcnt(4)
  v_mfma_f32_32x32x16_bf16 v[176:191], v[32:35], a[88:91], v[176:191]
  ds_read_b64_tr_b16 a[80:81], v250 offset:55296
  ds_read_b64_tr_b16 a[82:83], v250 offset:56832
  buffer_load_dwordx4 v220, s[12:15], s71 offen offset:1024 lds
  v_mfma_f32_32x32x16_bf16 v[192:207], v[32:35], a[92:95], v[192:207]
  ds_read_b64_tr_b16 a[84:85], v251 offset:55296
  ds_read_b64_tr_b16 a[86:87], v251 offset:56832
  s_waitcnt lgkmcnt(4)
  v_mfma_f32_32x32x16_bf16 v[144:159], v[36:39], a[72:75], v[144:159]
  ds_read_b64_tr_b16 a[88:89], v209 offset:61440
  ds_read_b64_tr_b16 a[90:91], v209 offset:62976
  buffer_load_dwordx4 v221, s[12:15], s71 offen offset:2048 lds
  v_mfma_f32_32x32x16_bf16 v[160:175], v[36:39], a[76:79], v[160:175]
  ds_read_b64_tr_b16 a[92:93], v210 offset:61440
  ds_read_b64_tr_b16 a[94:95], v210 offset:62976
  s_add_u32 m0, s72, 36864
  s_add_u32 s71, s74, 1658880
  s_waitcnt lgkmcnt(4)
  v_mfma_f32_32x32x16_bf16 v[176:191], v[36:39], a[80:83], v[176:191]
  ds_read_b64_tr_b16 a[72:73], v250 offset:61440
  ds_read_b64_tr_b16 a[74:75], v250 offset:62976
  buffer_load_dwordx4 v219, s[12:15], s71 offen offset:0 lds
  v_mfma_f32_32x32x16_bf16 v[192:207], v[36:39], a[84:87], v[192:207]
  ds_read_b64_tr_b16 a[76:77], v251 offset:61440
  ds_read_b64_tr_b16 a[78:79], v251 offset:62976
  s_waitcnt lgkmcnt(4)
  v_mfma_f32_32x32x16_bf16 v[144:159], v[40:43], a[88:91], v[144:159]
  v_add_u32 v209, 67584, v211
  ds_read_b64_tr_b16 a[80:81], v209 offset:0
  ds_read_b64_tr_b16 a[82:83], v209 offset:1536
  buffer_load_dwordx4 v220, s[12:15], s71 offen offset:1024 lds
  v_mfma_f32_32x32x16_bf16 v[160:175], v[40:43], a[92:95], v[160:175]
  v_add_u32 v210, 67584, v212
  ds_read_b64_tr_b16 a[84:85], v210 offset:0
  ds_read_b64_tr_b16 a[86:87], v210 offset:1536
  s_waitcnt lgkmcnt(4)
  v_mfma_f32_32x32x16_bf16 v[176:191], v[40:43], a[72:75], v[176:191]
  v_add_u32 v250, 67584, v213
  ds_read_b64_tr_b16 a[88:89], v250 offset:0
  ds_read_b64_tr_b16 a[90:91], v250 offset:1536
  buffer_load_dwordx4 v221, s[12:15], s71 offen offset:2048 lds
  v_mfma_f32_32x32x16_bf16 v[192:207], v[40:43], a[76:79], v[192:207]
  v_add_u32 v251, 67584, v214
  ds_read_b64_tr_b16 a[92:93], v251 offset:0
  ds_read_b64_tr_b16 a[94:95], v251 offset:1536
  s_waitcnt lgkmcnt(4)
  v_mfma_f32_32x32x16_bf16 v[144:159], v[44:47], a[80:83], v[144:159]
  ds_read_b64_tr_b16 a[72:73], v209 offset:6144
  ds_read_b64_tr_b16 a[74:75], v209 offset:7680
  v_mfma_f32_32x32x16_bf16 v[160:175], v[44:47], a[84:87], v[160:175]
  ds_read_b64_tr_b16 a[76:77], v210 offset:6144
  ds_read_b64_tr_b16 a[78:79], v210 offset:7680
  s_waitcnt lgkmcnt(4)
  v_mfma_f32_32x32x16_bf16 v[176:191], v[44:47], a[88:91], v[176:191]
  ds_read_b64_tr_b16 a[80:81], v250 offset:6144
  ds_read_b64_tr_b16 a[82:83], v250 offset:7680
  v_mfma_f32_32x32x16_bf16 v[192:207], v[44:47], a[92:95], v[192:207]
  s_waitcnt vmcnt(24)
  s_barrier
  ds_read_b64_tr_b16 a[84:85], v251 offset:6144
  ds_read_b64_tr_b16 a[86:87], v251 offset:7680
  s_add_u32 m0, s72, 49152
  s_add_u32 s71, s74, 1769472
  s_waitcnt lgkmcnt(4)
  v_mfma_f32_32x32x16_bf16 v[144:159], v[48:51], a[72:75], v[144:159]
  ds_read_b64_tr_b16 a[88:89], v209 offset:12288
  ds_read_b64_tr_b16 a[90:91], v209 offset:13824
  buffer_load_dwordx4 v219, s[12:15], s71 offen offset:0 lds
  v_mfma_f32_32x32x16_bf16 v[160:175], v[48:51], a[76:79], v[160:175]
  ds_read_b64_tr_b16 a[92:93], v210 offset:12288
  ds_read_b64_tr_b16 a[94:95], v210 offset:13824
  s_waitcnt lgkmcnt(4)
  v_mfma_f32_32x32x16_bf16 v[176:191], v[48:51], a[80:83], v[176:191]
  ds_read_b64_tr_b16 a[72:73], v250 offset:12288
  ds_read_b64_tr_b16 a[74:75], v250 offset:13824
  buffer_load_dwordx4 v220, s[12:15], s71 offen offset:1024 lds
  v_mfma_f32_32x32x16_bf16 v[192:207], v[48:51], a[84:87], v[192:207]
  ds_read_b64_tr_b16 a[76:77], v251 offset:12288
  ds_read_b64_tr_b16 a[78:79], v251 offset:13824
  s_waitcnt lgkmcnt(4)
  v_mfma_f32_32x32x16_bf16 v[144:159], v[52:55], a[88:91], v[144:159]
  ds_read_b64_tr_b16 a[80:81], v209 offset:18432
  ds_read_b64_tr_b16 a[82:83], v209 offset:19968
  buffer_load_dwordx4 v221, s[12:15], s71 offen offset:2048 lds
  v_mfma_f32_32x32x16_bf16 v[160:175], v[52:55], a[92:95], v[160:175]
  ds_read_b64_tr_b16 a[84:85], v210 offset:18432
  ds_read_b64_tr_b16 a[86:87], v210 offset:19968
  s_add_u32 m0, s72, 61440
  s_add_u32 s71, s74, 1880064
  s_waitcnt lgkmcnt(4)
  v_mfma_f32_32x32x16_bf16 v[176:191], v[52:55], a[72:75], v[176:191]
  ds_read_b64_tr_b16 a[88:89], v250 offset:18432
  ds_read_b64_tr_b16 a[90:91], v250 offset:19968
  buffer_load_dwordx4 v219, s[12:15], s71 offen offset:0 lds
  v_mfma_f32_32x32x16_bf16 v[192:207], v[52:55], a[76:79], v[192:207]
  ds_read_b64_tr_b16 a[92:93], v251 offset:18432
  ds_read_b64_tr_b16 a[94:95], v251 offset:19968
  s_waitcnt lgkmcnt(4)
  v_mfma_f32_32x32x16_bf16 v[144:159], v[56:59], a[80:83], v[144:159]
  ds_read_b64_tr_b16 a[72:73], v209 offset:24576
  ds_read_b64_tr_b16 a[74:75], v209 offset:26112
  buffer_load_dwordx4 v220, s[12:15], s71 offen offset:1024 lds
  v_mfma_f32_32x32x16_bf16 v[160:175], v[56:59], a[84:87], v[160:175]
  ds_read_b64_tr_b16 a[76:77], v210 offset:24576
  ds_read_b64_tr_b16 a[78:79], v210 offset:26112
  s_waitcnt lgkmcnt(4)
  v_mfma_f32_32x32x16_bf16 v[176:191], v[56:59], a[88:91], v[176:191]
  ds_read_b64_tr_b16 a[80:81], v250 offset:24576
  ds_read_b64_tr_b16 a[82:83], v250 offset:26112
  buffer_load_dwordx4 v221, s[12:15], s71 offen offset:2048 lds
  v_mfma_f32_32x32x16_bf16 v[192:207], v[56:59], a[92:95], v[192:207]
  ds_read_b64_tr_b16 a[84:85], v251 offset:24576
  ds_read_b64_tr_b16 a[86:87], v251 offset:26112
  s_waitcnt lgkmcnt(4)
  v_mfma_f32_32x32x16_bf16 v[144:159], v[60:63], a[72:75], v[144:159]
  ds_read_b64_tr_b16 a[88:89], v209 offset:30720
  ds_read_b64_tr_b16 a[90:91], v209 offset:32256
  v_mfma_f32_32x32x16_bf16 v[160:175], v[60:63], a[76:79], v[160:175]
  ds_read_b64_tr_b16 a[92:93], v210 offset:30720
  ds_read_b64_tr_b16 a[94:95], v210 offset:32256
  s_waitcnt lgkmcnt(4)
  v_mfma_f32_32x32x16_bf16 v[176:191], v[60:63], a[80:83], v[176:191]
  ds_read_b64_tr_b16 a[72:73], v250 offset:30720
  ds_read_b64_tr_b16 a[74:75], v250 offset:32256
  s_mul_i32 s70, s44, 576
  v_mfma_f32_32x32x16_bf16 v[192:207], v[60:63], a[84:87], v[192:207]
  s_waitcnt vmcnt(24)
  s_barrier
  ds_read_b64_tr_b16 a[76:77], v251 offset:30720
  ds_read_b64_tr_b16 a[78:79], v251 offset:32256
  s_add_u32 m0, s72, 73728
  s_add_u32 s71, s75, 0
  s_waitcnt lgkmcnt(4)
  v_mfma_f32_32x32x16_bf16 v[144:159], v[64:67], a[88:91], v[144:159]
  ds_read_b64_tr_b16 a[80:81], v209 offset:36864
  ds_read_b64_tr_b16 a[82:83], v209 offset:38400
  buffer_load_dwordx4 v215, s[20:23], s71 offen offset:0 lds
  s_add_u32 s70, s70, s101
  v_mfma_f32_32x32x16_bf16 v[160:175], v[64:67], a[92:95], v[160:175]
  ds_read_b64_tr_b16 a[84:85], v210 offset:36864
  ds_read_b64_tr_b16 a[86:87], v210 offset:38400
  s_waitcnt lgkmcnt(4)
  v_mfma_f32_32x32x16_bf16 v[176:191], v[64:67], a[72:75], v[176:191]
  ds_read_b64_tr_b16 a[88:89], v250 offset:36864
  ds_read_b64_tr_b16 a[90:91], v250 offset:38400
  buffer_load_dwordx4 v216, s[20:23], s71 offen offset:1024 lds
  s_lshl_b32 s69, s99, 6
  v_mfma_f32_32x32x16_bf16 v[192:207], v[64:67], a[76:79], v[192:207]
  ds_read_b64_tr_b16 a[92:93], v251 offset:36864
  ds_read_b64_tr_b16 a[94:95], v251 offset:38400
  s_waitcnt lgkmcnt(4)
  v_mfma_f32_32x32x16_bf16 v[144:159], v[68:71], a[80:83], v[144:159]
  ds_read_b64_tr_b16 a[72:73], v209 offset:43008
  ds_read_b64_tr_b16 a[74:75], v209 offset:44544
  buffer_load_dwordx4 v217, s[20:23], s71 offen offset:2048 lds
  s_add_u32 s70, s70, s69
  v_mfma_f32_32x32x16_bf16 v[160:175], v[68:71], a[84:87], v[160:175]
  ds_read_b64_tr_b16 a[76:77], v210 offset:43008
  ds_read_b64_tr_b16 a[78:79], v210 offset:44544
  s_add_u32 m0, s72, 86016
  s_add_u32 s71, s75, 884736
  s_waitcnt lgkmcnt(4)
  v_mfma_f32_32x32x16_bf16 v[176:191], v[68:71], a[88:91], v[176:191]
  ds_read_b64_tr_b16 a[80:81], v250 offset:43008
  ds_read_b64_tr_b16 a[82:83], v250 offset:44544
  buffer_load_dwordx4 v215, s[20:23], s71 offen offset:0 lds
  s_add_u32 s70, s70, 128
  v_mfma_f32_32x32x16_bf16 v[192:207], v[68:71], a[92:95], v[192:207]
  ds_read_b64_tr_b16 a[84:85], v251 offset:43008
  ds_read_b64_tr_b16 a[86:87], v251 offset:44544
  s_waitcnt lgkmcnt(4)
  v_mfma_f32_32x32x16_bf16 v[144:159], v[72:75], a[72:75], v[144:159]
  ds_read_b64_tr_b16 a[88:89], v209 offset:49152
  ds_read_b64_tr_b16 a[90:91], v209 offset:50688
  buffer_load_dwordx4 v216, s[20:23], s71 offen offset:1024 lds
  buffer_load_dword v249, v248, s[20:23], s70 offen
  v_mfma_f32_32x32x16_bf16 v[160:175], v[72:75], a[76:79], v[160:175]
  ds_read_b64_tr_b16 a[92:93], v210 offset:49152
  ds_read_b64_tr_b16 a[94:95], v210 offset:50688
  s_waitcnt lgkmcnt(4)
  v_mfma_f32_32x32x16_bf16 v[176:191], v[72:75], a[80:83], v[176:191]
  ds_read_b64_tr_b16 a[72:73], v250 offset:49152
  ds_read_b64_tr_b16 a[74:75], v250 offset:50688
  buffer_load_dwordx4 v217, s[20:23], s71 offen offset:2048 lds
  buffer_load_dword v249, v248, s[24:27], s70 offen
  v_mfma_f32_32x32x16_bf16 v[192:207], v[72:75], a[84:87], v[192:207]
  ds_read_b64_tr_b16 a[76:77], v251 offset:49152
  ds_read_b64_tr_b16 a[78:79], v251 offset:50688
  s_waitcnt lgkmcnt(4)
  v_mfma_f32_32x32x16_bf16 v[144:159], v[76:79], a[88:91], v[144:159]
  ds_read_b64_tr_b16 a[80:81], v209 offset:55296
  ds_read_b64_tr_b16 a[82:83], v209 offset:56832
  v_mfma_f32_32x32x16_bf16 v[160:175], v[76:79], a[92:95], v[160:175]
  ds_read_b64_tr_b16 a[84:85], v210 offset:55296
  ds_read_b64_tr_b16 a[86:87], v210 offset:56832
  s_waitcnt lgkmcnt(4)
  v_mfma_f32_32x32x16_bf16 v[176:191], v[76:79], a[72:75], v[176:191]
  ds_read_b64_tr_b16 a[88:89], v250 offset:55296
  ds_read_b64_tr_b16 a[90:91], v250 offset:56832
  v_mfma_f32_32x32x16_bf16 v[192:207], v[76:79], a[76:79], v[192:207]
  s_waitcnt vmcnt(20)
  s_barrier
  ds_read_b64_tr_b16 a[92:93], v251 offset:55296
  ds_read_b64_tr_b16 a[94:95], v251 offset:56832
  s_add_u32 m0, s72, 98304
  s_add_u32 s71, s75, 1769472
  s_waitcnt lgkmcnt(4)
  v_mfma_f32_32x32x16_bf16 v[144:159], v[80:83], a[80:83], v[144:159]
  ds_read_b64_tr_b16 a[72:73], v209 offset:61440
  ds_read_b64_tr_b16 a[74:75], v209 offset:62976
  buffer_load_dwordx4 v215, s[20:23], s71 offen offset:0 lds
  v_mfma_f32_32x32x16_bf16 v[160:175], v[80:83], a[84:87], v[160:175]
  ds_read_b64_tr_b16 a[76:77], v210 offset:61440
  ds_read_b64_tr_b16 a[78:79], v210 offset:62976
  s_waitcnt lgkmcnt(4)
  v_mfma_f32_32x32x16_bf16 v[176:191], v[80:83], a[88:91], v[176:191]
  ds_read_b64_tr_b16 a[80:81], v250 offset:61440
  ds_read_b64_tr_b16 a[82:83], v250 offset:62976
  buffer_load_dwordx4 v216, s[20:23], s71 offen offset:1024 lds
  v_mfma_f32_32x32x16_bf16 v[192:207], v[80:83], a[92:95], v[192:207]
  ds_read_b64_tr_b16 a[84:85], v251 offset:61440
  ds_read_b64_tr_b16 a[86:87], v251 offset:62976
  s_waitcnt lgkmcnt(4)
  v_mfma_f32_32x32x16_bf16 v[144:159], v[84:87], a[72:75], v[144:159]
  v_add_u32 v209, 135168, v211
  ds_read_b64_tr_b16 a[88:89], v209 offset:0
  ds_read_b64_tr_b16 a[90:91], v209 offset:1536
  buffer_load_dwordx4 v217, s[20:23], s71 offen offset:2048 lds
  v_mfma_f32_32x32x16_bf16 v[160:175], v[84:87], a[76:79], v[160:175]
  v_add_u32 v210, 135168, v212
  ds_read_b64_tr_b16 a[92:93], v210 offset:0
  ds_read_b64_tr_b16 a[94:95], v210 offset:1536
  s_add_u32 m0, s72, 110592
  s_add_u32 s71, s75, 2654208
  s_waitcnt lgkmcnt(4)
  v_mfma_f32_32x32x16_bf16 v[176:191], v[84:87], a[80:83], v[176:191]
  v_add_u32 v250, 135168, v213
  ds_read_b64_tr_b16 a[72:73], v250 offset:0
  ds_read_b64_tr_b16 a[74:75], v250 offset:1536
  buffer_load_dwordx4 v215, s[20:23], s71 offen offset:0 lds
  v_mfma_f32_32x32x16_bf16 v[192:207], v[84:87], a[84:87], v[192:207]
  v_add_u32 v251, 135168, v214
  ds_read_b64_tr_b16 a[76:77], v251 offset:0
  ds_read_b64_tr_b16 a[78:79], v251 offset:1536
  s_waitcnt lgkmcnt(4)
  v_mfma_f32_32x32x16_bf16 v[144:159], v[88:91], a[88:91], v[144:159]
  ds_read_b64_tr_b16 a[80:81], v209 offset:6144
  ds_read_b64_tr_b16 a[82:83], v209 offset:7680
  buffer_load_dwordx4 v216, s[20:23], s71 offen offset:1024 lds
  v_mfma_f32_32x32x16_bf16 v[160:175], v[88:91], a[92:95], v[160:175]
  ds_read_b64_tr_b16 a[84:85], v210 offset:6144
  ds_read_b64_tr_b16 a[86:87], v210 offset:7680
  s_waitcnt lgkmcnt(4)
  v_mfma_f32_32x32x16_bf16 v[176:191], v[88:91], a[72:75], v[176:191]
  ds_read_b64_tr_b16 a[88:89], v250 offset:6144
  ds_read_b64_tr_b16 a[90:91], v250 offset:7680
  buffer_load_dwordx4 v217, s[20:23], s71 offen offset:2048 lds
  v_mfma_f32_32x32x16_bf16 v[192:207], v[88:91], a[76:79], v[192:207]
  ds_read_b64_tr_b16 a[92:93], v251 offset:6144
  ds_read_b64_tr_b16 a[94:95], v251 offset:7680
  s_waitcnt lgkmcnt(4)
  v_mfma_f32_32x32x16_bf16 v[144:159], v[92:95], a[80:83], v[144:159]
  v_mov_b32 v209, v211
  ds_read_b64_tr_b16 a[72:73], v209 offset:0
  ds_read_b64_tr_b16 a[74:75], v209 offset:1536
  v_mfma_f32_32x32x16_bf16 v[160:175], v[92:95], a[84:87], v[160:175]
  ds_read_b64_tr_b16 a[76:77], v209 offset:6144
  ds_read_b64_tr_b16 a[78:79], v209 offset:7680
  s_waitcnt lgkmcnt(4)
  v_mfma_f32_32x32x16_bf16 v[176:191], v[92:95], a[88:91], v[176:191]
  ds_read_b64_tr_b16 a[80:81], v209 offset:12288
  ds_read_b64_tr_b16 a[82:83], v209 offset:13824
  v_mfma_f32_32x32x16_bf16 v[192:207], v[92:95], a[92:95], v[192:207]
  s_waitcnt vmcnt(14)
  s_barrier
  ds_read_b64_tr_b16 a[84:85], v209 offset:18432
  ds_read_b64_tr_b16 a[86:87], v209 offset:19968
  s_add_u32 m0, s72, 122880
  s_add_u32 s71, s75, 3538944
  s_waitcnt lgkmcnt(4)
  v_mfma_f32_32x32x16_bf16 v[144:159], v[96:99], a[72:75], v[144:159]
  ds_read_b64_tr_b16 a[88:89], v209 offset:24576
  ds_read_b64_tr_b16 a[90:91], v209 offset:26112
  buffer_load_dwordx4 v215, s[20:23], s71 offen offset:0 lds
  v_mfma_f32_32x32x16_bf16 v[144:159], v[100:103], a[76:79], v[144:159]
  ds_read_b64_tr_b16 a[92:93], v209 offset:30720
  ds_read_b64_tr_b16 a[94:95], v209 offset:32256
  s_waitcnt lgkmcnt(4)
  v_mfma_f32_32x32x16_bf16 v[144:159], v[104:107], a[80:83], v[144:159]
  ds_read_b64_tr_b16 a[72:73], v209 offset:36864
  ds_read_b64_tr_b16 a[74:75], v209 offset:38400
  buffer_load_dwordx4 v216, s[20:23], s71 offen offset:1024 lds
  v_mfma_f32_32x32x16_bf16 v[144:159], v[108:111], a[84:87], v[144:159]
  ds_read_b64_tr_b16 a[76:77], v209 offset:43008
  ds_read_b64_tr_b16 a[78:79], v209 offset:44544
  s_waitcnt lgkmcnt(4)
  v_mfma_f32_32x32x16_bf16 v[144:159], v[112:115], a[88:91], v[144:159]
  ds_read_b64_tr_b16 a[80:81], v209 offset:49152
  ds_read_b64_tr_b16 a[82:83], v209 offset:50688
  buffer_load_dwordx4 v217, s[20:23], s71 offen offset:2048 lds
  v_mfma_f32_32x32x16_bf16 v[144:159], v[116:119], a[92:95], v[144:159]
  ds_read_b64_tr_b16 a[84:85], v209 offset:55296
  ds_read_b64_tr_b16 a[86:87], v209 offset:56832
  s_add_u32 m0, s72, 135168
  s_add_u32 s71, s75, 4423680
  s_waitcnt lgkmcnt(4)
  v_mfma_f32_32x32x16_bf16 v[144:159], v[120:123], a[72:75], v[144:159]
  ds_read_b64_tr_b16 a[88:89], v209 offset:61440
  ds_read_b64_tr_b16 a[90:91], v209 offset:62976
  buffer_load_dwordx4 v215, s[20:23], s71 offen offset:0 lds
  v_mfma_f32_32x32x16_bf16 v[144:159], v[124:127], a[76:79], v[144:159]
  v_add_u32 v209, 67584, v211
  ds_read_b64_tr_b16 a[92:93], v209 offset:0
  ds_read_b64_tr_b16 a[94:95], v209 offset:1536
  s_waitcnt lgkmcnt(4)
  v_mfma_f32_32x32x16_bf16 v[144:159], v[128:131], a[80:83], v[144:159]
  v_mov_b32 v210, v212
  ds_read_b64_tr_b16 a[72:73], v210 offset:0
  ds_read_b64_tr_b16 a[74:75], v210 offset:1536
  buffer_load_dwordx4 v216, s[20:23], s71 offen offset:1024 lds
  v_mfma_f32_32x32x16_bf16 v[144:159], v[132:135], a[84:87], v[144:159]
  ds_read_b64_tr_b16 a[76:77], v210 offset:6144
  ds_read_b64_tr_b16 a[78:79], v210 offset:7680
  s_waitcnt lgkmcnt(4)
  v_mfma_f32_32x32x16_bf16 v[144:159], v[136:139], a[88:91], v[144:159]
  ds_read_b64_tr_b16 a[80:81], v210 offset:12288
  ds_read_b64_tr_b16 a[82:83], v210 offset:13824
  buffer_load_dwordx4 v217, s[20:23], s71 offen offset:2048 lds
  v_mfma_f32_32x32x16_bf16 v[144:159], v[140:143], a[92:95], v[144:159]
  ds_read_b64_tr_b16 a[84:85], v210 offset:18432
  ds_read_b64_tr_b16 a[86:87], v210 offset:19968
  s_waitcnt lgkmcnt(4)
  v_mfma_f32_32x32x16_bf16 v[160:175], v[96:99], a[72:75], v[160:175]
  ds_read_b64_tr_b16 a[88:89], v210 offset:24576
  ds_read_b64_tr_b16 a[90:91], v210 offset:26112
  v_mfma_f32_32x32x16_bf16 v[160:175], v[100:103], a[76:79], v[160:175]
  ds_read_b64_tr_b16 a[92:93], v210 offset:30720
  ds_read_b64_tr_b16 a[94:95], v210 offset:32256
  s_waitcnt lgkmcnt(4)
  v_mfma_f32_32x32x16_bf16 v[160:175], v[104:107], a[80:83], v[160:175]
  ds_read_b64_tr_b16 a[72:73], v210 offset:36864
  ds_read_b64_tr_b16 a[74:75], v210 offset:38400
  v_mul_f32 v233, 0x3fb8aa3b, v144
  v_mul_f32 v235, 0x3fb8aa3b, v145
  v_exp_f32 v233, v233 clamp
  v_mfma_f32_32x32x16_bf16 v[160:175], v[108:111], a[84:87], v[160:175]
  s_barrier
  ds_read_b64_tr_b16 a[76:77], v210 offset:43008
  ds_read_b64_tr_b16 a[78:79], v210 offset:44544
  s_waitcnt lgkmcnt(4)
  v_mfma_f32_32x32x16_bf16 v[160:175], v[112:115], a[88:91], v[160:175]
  ds_read_b64_tr_b16 a[80:81], v210 offset:49152
  ds_read_b64_tr_b16 a[82:83], v210 offset:50688
  v_exp_f32 v235, v235 clamp
  v_max_f32 v234, 0, v144
  v_max_f32 v236, 0, v145
  v_add_f32 v233, 0x358637bd, v233
  v_add_f32 v235, 0x358637bd, v235
  v_mfma_f32_32x32x16_bf16 v[160:175], v[116:119], a[92:95], v[160:175]
  ds_read_b64_tr_b16 a[84:85], v210 offset:55296
  ds_read_b64_tr_b16 a[86:87], v210 offset:56832
  v_add_f32 v144, v234, v233
  v_add_f32 v145, v236, v235
  v_mul_f32 v233, 0x3fb8aa3b, v146
  s_waitcnt lgkmcnt(4)
  v_mfma_f32_32x32x16_bf16 v[160:175], v[120:123], a[72:75], v[160:175]
  ds_read_b64_tr_b16 a[88:89], v210 offset:61440
  ds_read_b64_tr_b16 a[90:91], v210 offset:62976
  v_mul_f32 v235, 0x3fb8aa3b, v147
  v_exp_f32 v233, v233 clamp
  v_exp_f32 v235, v235 clamp
  v_mfma_f32_32x32x16_bf16 v[160:175], v[124:127], a[76:79], v[160:175]
  v_add_u32 v210, 67584, v212
  ds_read_b64_tr_b16 a[92:93], v210 offset:0
  ds_read_b64_tr_b16 a[94:95], v210 offset:1536
  v_max_f32 v234, 0, v146
  v_max_f32 v236, 0, v147
  s_waitcnt lgkmcnt(4)
  v_mfma_f32_32x32x16_bf16 v[160:175], v[128:131], a[80:83], v[160:175]
  v_mov_b32 v250, v213
  ds_read_b64_tr_b16 a[72:73], v250 offset:0
  ds_read_b64_tr_b16 a[74:75], v250 offset:1536
  v_add_f32 v233, 0x358637bd, v233
  v_add_f32 v235, 0x358637bd, v235
  v_add_f32 v146, v234, v233
  v_add_f32 v147, v236, v235
  v_mfma_f32_32x32x16_bf16 v[160:175], v[132:135], a[84:87], v[160:175]
  ds_read_b64_tr_b16 a[76:77], v250 offset:6144
  ds_read_b64_tr_b16 a[78:79], v250 offset:7680
  v_mul_f32 v233, 0x3fb8aa3b, v148
  v_mul_f32 v235, 0x3fb8aa3b, v149
  v_exp_f32 v233, v233 clamp
  s_waitcnt lgkmcnt(4)
  v_mfma_f32_32x32x16_bf16 v[160:175], v[136:139], a[88:91], v[160:175]
  ds_read_b64_tr_b16 a[80:81], v250 offset:12288
  ds_read_b64_tr_b16 a[82:83], v250 offset:13824
  v_exp_f32 v235, v235 clamp
  v_max_f32 v234, 0, v148
  v_max_f32 v236, 0, v149
  v_mfma_f32_32x32x16_bf16 v[160:175], v[140:143], a[92:95], v[160:175]
  ds_read_b64_tr_b16 a[84:85], v250 offset:18432
  ds_read_b64_tr_b16 a[86:87], v250 offset:19968
  v_add_f32 v233, 0x358637bd, v233
  v_add_f32 v235, 0x358637bd, v235
  v_add_f32 v148, v234, v233
  s_waitcnt lgkmcnt(4)
  v_mfma_f32_32x32x16_bf16 v[176:191], v[96:99], a[72:75], v[176:191]
  ds_read_b64_tr_b16 a[88:89], v250 offset:24576
  ds_read_b64_tr_b16 a[90:91], v250 offset:26112
  v_add_f32 v149, v236, v235
  v_mul_f32 v233, 0x3fb8aa3b, v150
  v_mul_f32 v235, 0x3fb8aa3b, v151
  v_lshrrev_b32 v245, 5, v208
  v_mfma_f32_32x32x16_bf16 v[176:191], v[100:103], a[76:79], v[176:191]
  ds_read_b64_tr_b16 a[92:93], v250 offset:30720
  ds_read_b64_tr_b16 a[94:95], v250 offset:32256
  v_exp_f32 v233, v233 clamp
  v_exp_f32 v235, v235 clamp
  s_waitcnt lgkmcnt(4)
  v_mfma_f32_32x32x16_bf16 v[176:191], v[104:107], a[80:83], v[176:191]
  ds_read_b64_tr_b16 a[72:73], v250 offset:36864
  ds_read_b64_tr_b16 a[74:75], v250 offset:38400
  v_max_f32 v234, 0, v150
  v_max_f32 v236, 0, v151
  v_add_f32 v233, 0x358637bd, v233
  v_add_f32 v235, 0x358637bd, v235
  v_mfma_f32_32x32x16_bf16 v[176:191], v[108:111], a[84:87], v[176:191]
  ds_read_b64_tr_b16 a[76:77], v250 offset:43008
  ds_read_b64_tr_b16 a[78:79], v250 offset:44544
  v_add_f32 v150, v234, v233
  v_add_f32 v151, v236, v235
  v_mul_f32 v233, 0x3fb8aa3b, v152
  s_waitcnt lgkmcnt(4)
  v_mfma_f32_32x32x16_bf16 v[176:191], v[112:115], a[88:91], v[176:191]
  ds_read_b64_tr_b16 a[80:81], v250 offset:49152
  ds_read_b64_tr_b16 a[82:83], v250 offset:50688
  v_mul_f32 v235, 0x3fb8aa3b, v153
  v_exp_f32 v233, v233 clamp
  v_mul_u32_u24 v245, 8, v245
  v_mfma_f32_32x32x16_bf16 v[176:191], v[116:119], a[92:95], v[176:191]
  ds_read_b64_tr_b16 a[84:85], v250 offset:55296
  ds_read_b64_tr_b16 a[86:87], v250 offset:56832
  v_exp_f32 v235, v235 clamp
  v_max_f32 v234, 0, v152
  s_waitcnt lgkmcnt(4)
  v_mfma_f32_32x32x16_bf16 v[176:191], v[120:123], a[72:75], v[176:191]
  ds_read_b64_tr_b16 a[88:89], v250 offset:61440
  ds_read_b64_tr_b16 a[90:91], v250 offset:62976
  v_max_f32 v236, 0, v153
  v_add_f32 v233, 0x358637bd, v233
  v_add_f32 v235, 0x358637bd, v235
  v_add_f32 v152, v234, v233
  v_mfma_f32_32x32x16_bf16 v[176:191], v[124:127], a[76:79], v[176:191]
  s_waitcnt vmcnt(17)
  s_barrier
  v_add_u32 v250, 67584, v213
  ds_read_b64_tr_b16 a[92:93], v250 offset:0
  ds_read_b64_tr_b16 a[94:95], v250 offset:1536
  s_waitcnt lgkmcnt(4)
  v_mfma_f32_32x32x16_bf16 v[176:191], v[128:131], a[80:83], v[176:191]
  v_mov_b32 v251, v214
  ds_read_b64_tr_b16 a[72:73], v251 offset:0
  ds_read_b64_tr_b16 a[74:75], v251 offset:1536
  v_add_f32 v153, v236, v235
  v_mul_f32 v233, 0x3fb8aa3b, v154
  v_mul_f32 v235, 0x3fb8aa3b, v155
  v_exp_f32 v233, v233 clamp
  v_mfma_f32_32x32x16_bf16 v[176:191], v[132:135], a[84:87], v[176:191]
  ds_read_b64_tr_b16 a[76:77], v251 offset:6144
  ds_read_b64_tr_b16 a[78:79], v251 offset:7680
  v_exp_f32 v235, v235 clamp
  v_max_f32 v234, 0, v154
  v_max_f32 v236, 0, v155
  v_add_f32 v233, 0x358637bd, v233
  s_waitcnt lgkmcnt(4)
  v_mfma_f32_32x32x16_bf16 v[176:191], v[136:139], a[88:91], v[176:191]
  ds_read_b64_tr_b16 a[80:81], v251 offset:12288
  ds_read_b64_tr_b16 a[82:83], v251 offset:13824
  v_add_f32 v235, 0x358637bd, v235
  v_add_f32 v154, v234, v233
  v_add_f32 v155, v236, v235
  v_mul_f32 v233, 0x3fb8aa3b, v156
  v_mfma_f32_32x32x16_bf16 v[176:191], v[140:143], a[92:95], v[176:191]
  ds_read_b64_tr_b16 a[84:85], v251 offset:18432
  ds_read_b64_tr_b16 a[86:87], v251 offset:19968
  v_mul_f32 v235, 0x3fb8aa3b, v157
  v_exp_f32 v233, v233 clamp
  s_waitcnt lgkmcnt(4)
  v_mfma_f32_32x32x16_bf16 v[192:207], v[96:99], a[72:75], v[192:207]
  ds_read_b64_tr_b16 a[88:89], v251 offset:24576
  ds_read_b64_tr_b16 a[90:91], v251 offset:26112
  v_exp_f32 v235, v235 clamp
  v_max_f32 v234, 0, v156
  v_max_f32 v236, 0, v157
  v_mfma_f32_32x32x16_bf16 v[192:207], v[100:103], a[76:79], v[192:207]
  ds_read_b64_tr_b16 a[92:93], v251 offset:30720
  ds_read_b64_tr_b16 a[94:95], v251 offset:32256
  v_add_f32 v233, 0x358637bd, v233
  v_add_f32 v235, 0x358637bd, v235
  v_add_f32 v156, v234, v233
  s_waitcnt lgkmcnt(4)
  v_mfma_f32_32x32x16_bf16 v[192:207], v[104:107], a[80:83], v[192:207]
  ds_read_b64_tr_b16 a[72:73], v251 offset:36864
  ds_read_b64_tr_b16 a[74:75], v251 offset:38400
  v_add_f32 v157, v236, v235
  v_mul_f32 v233, 0x3fb8aa3b, v158
  v_mul_f32 v235, 0x3fb8aa3b, v159
  v_exp_f32 v233, v233 clamp
  v_mfma_f32_32x32x16_bf16 v[192:207], v[108:111], a[84:87], v[192:207]
  ds_read_b64_tr_b16 a[76:77], v251 offset:43008
  ds_read_b64_tr_b16 a[78:79], v251 offset:44544
  v_exp_f32 v235, v235 clamp
  v_bfe_u32 v246, v208, 2, 2
  s_waitcnt lgkmcnt(4)
  v_mfma_f32_32x32x16_bf16 v[192:207], v[112:115], a[88:91], v[192:207]
  ds_read_b64_tr_b16 a[80:81], v251 offset:49152
  ds_read_b64_tr_b16 a[82:83], v251 offset:50688
  v_add_u32 v245, v245, v246
  v_mul_u32_u24 v211, 128, v245
  v_max_f32 v234, 0, v158
  v_bfe_u32 v245, v208, 4, 1
  v_max_f32 v236, 0, v159
  v_add_f32 v233, 0x358637bd, v233
  v_mfma_f32_32x32x16_bf16 v[192:207], v[116:119], a[92:95], v[192:207]
  ds_read_b64_tr_b16 a[84:85], v251 offset:55296
  ds_read_b64_tr_b16 a[86:87], v251 offset:56832
  v_lshlrev_b32 v245, 5, v245
  v_and_b32 v246, 3, v208
  v_lshl_add_u32 v245, v246, 3, v245
  v_add_f32 v235, 0x358637bd, v235
  v_add_f32 v158, v234, v233
  v_bfe_u32 v246, v208, 3, 1
  v_lshlrev_b32 v246, 6, v246
  v_xor_b32 v245, v245, v246
  v_add_u32 v211, v211, v245
  s_waitcnt lgkmcnt(4)
  v_mfma_f32_32x32x16_bf16 v[192:207], v[120:123], a[72:75], v[192:207]
  ds_read_b64_tr_b16 a[88:89], v251 offset:61440
  ds_read_b64_tr_b16 a[90:91], v251 offset:62976
  v_add_f32 v159, v236, v235
  v_cvt_pk_bf16_f32 v233, v144, v145
  v_accvgpr_write_b32 a200, v233
  v_cvt_pk_bf16_f32 v235, v146, v147
  v_accvgpr_write_b32 a201, v235
  v_cvt_pk_bf16_f32 v233, v148, v149
  v_mfma_f32_32x32x16_bf16 v[192:207], v[124:127], a[76:79], v[192:207]
  v_add_u32 v251, 67584, v214
  ds_read_b64_tr_b16 a[92:93], v251 offset:0
  ds_read_b64_tr_b16 a[94:95], v251 offset:1536
  v_accvgpr_write_b32 a202, v233
  v_cvt_pk_bf16_f32 v235, v150, v151
  v_accvgpr_write_b32 a203, v235
  s_waitcnt lgkmcnt(4)
  v_mfma_f32_32x32x16_bf16 v[192:207], v[128:131], a[80:83], v[192:207]
  v_add_u32 v209, 73728, v211
  ds_read_b64_tr_b16 a[72:73], v209 offset:0
  ds_read_b64_tr_b16 a[74:75], v209 offset:512
  buffer_load_dword v251, v252, s[36:39], s0 offen sc1
  v_cvt_pk_bf16_f32 v233, v152, v153
  v_accvgpr_write_b32 a204, v233
  v_cvt_pk_bf16_f32 v235, v154, v155
  v_accvgpr_write_b32 a205, v235
  v_mfma_f32_32x32x16_bf16 v[192:207], v[132:135], a[84:87], v[192:207]
  ds_read_b64_tr_b16 a[76:77], v209 offset:2048
  ds_read_b64_tr_b16 a[78:79], v209 offset:2560
  v_cvt_pk_bf16_f32 v233, v156, v157
  v_accvgpr_write_b32 a206, v233
  v_cvt_pk_bf16_f32 v235, v158, v159
  s_waitcnt lgkmcnt(4)
  v_mfma_f32_32x32x16_bf16 v[192:207], v[136:139], a[88:91], v[192:207]
  ds_read_b64_tr_b16 a[80:81], v209 offset:4096
  ds_read_b64_tr_b16 a[82:83], v209 offset:4608
  v_accvgpr_write_b32 a207, v235
  s_mov_b64 exec, s[90:91]
  ds_write_b64 v239, a[200:201] offset:0
  ds_write_b64 v239, a[202:203] offset:16
  ds_write_b64 v239, a[204:205] offset:32
  ds_write_b64 v239, a[206:207] offset:48
  s_mov_b64 exec, -1
  v_mfma_f32_32x32x16_bf16 v[192:207], v[140:143], a[92:95], v[192:207]
  s_waitcnt vmcnt(7)
  s_barrier
  ds_read_b64_tr_b16 a[84:85], v209 offset:6144
  ds_read_b64_tr_b16 a[86:87], v209 offset:6656
  s_add_u32 m0, s72, 0
  s_add_u32 s71, s75, 0
  s_waitcnt lgkmcnt(8)
  v_mfma_f32_32x32x16_bf16 v[144:159], a[72:75], v[0:3], 0
  ds_read_b64_tr_b16 a[88:89], v209 offset:8192
  ds_read_b64_tr_b16 a[90:91], v209 offset:8704
  buffer_load_dwordx4 v215, s[24:27], s71 offen offset:0 lds
  v_mul_f32 v233, 0x3fb8aa3b, v160
  v_mul_f32 v235, 0x3fb8aa3b, v161
  v_exp_f32 v233, v233 clamp
  v_mfma_f32_32x32x16_bf16 v[144:159], a[76:79], v[4:7], v[144:159]
  ds_read_b64_tr_b16 a[92:93], v209 offset:10240
  ds_read_b64_tr_b16 a[94:95], v209 offset:10752
  v_exp_f32 v235, v235 clamp
  v_max_f32 v234, 0, v160
  v_max_f32 v236, 0, v161
  v_add_f32 v233, 0x358637bd, v233
  s_waitcnt lgkmcnt(4)
  v_mfma_f32_32x32x16_bf16 v[144:159], a[80:83], v[8:11], v[144:159]
  ds_read_b64_tr_b16 a[72:73], v209 offset:12288
  ds_read_b64_tr_b16 a[74:75], v209 offset:12800
  buffer_load_dwordx4 v216, s[24:27], s71 offen offset:1024 lds
  v_add_f32 v235, 0x358637bd, v235
  v_add_f32 v160, v234, v233
  v_add_f32 v161, v236, v235
  v_mul_f32 v233, 0x3fb8aa3b, v162
  v_mfma_f32_32x32x16_bf16 v[144:159], a[84:87], v[12:15], v[144:159]
  ds_read_b64_tr_b16 a[76:77], v209 offset:14336
  ds_read_b64_tr_b16 a[78:79], v209 offset:14848
  v_mul_f32 v235, 0x3fb8aa3b, v163
  v_exp_f32 v233, v233 clamp
  v_exp_f32 v235, v235 clamp
  s_waitcnt lgkmcnt(4)
  v_mfma_f32_32x32x16_bf16 v[144:159], a[88:91], v[16:19], v[144:159]
  ds_read_b64_tr_b16 a[80:81], v209 offset:16384
  ds_read_b64_tr_b16 a[82:83], v209 offset:16896
  buffer_load_dwordx4 v217, s[24:27], s71 offen offset:2048 lds
  v_max_f32 v234, 0, v162
  v_max_f32 v236, 0, v163
  v_add_f32 v233, 0x358637bd, v233
  v_add_f32 v235, 0x358637bd, v235
  v_mfma_f32_32x32x16_bf16 v[144:159], a[92:95], v[20:23], v[144:159]
  ds_read_b64_tr_b16 a[84:85], v209 offset:18432
  ds_read_b64_tr_b16 a[86:87], v209 offset:18944
  s_add_u32 m0, s72, 12288
  s_add_u32 s71, s75, 884736
  v_add_f32 v162, v234, v233
  v_add_f32 v163, v236, v235
  v_mul_f32 v233, 0x3fb8aa3b, v164
  v_mul_f32 v235, 0x3fb8aa3b, v165
  v_exp_f32 v233, v233 clamp
  v_exp_f32 v235, v235 clamp
  v_max_f32 v234, 0, v164
  v_max_f32 v236, 0, v165
  v_add_f32 v233, 0x358637bd, v233
  v_add_f32 v235, 0x358637bd, v235
  v_add_f32 v164, v234, v233
  v_add_f32 v165, v236, v235
  v_mul_f32 v233, 0x3fb8aa3b, v166
  v_mul_f32 v235, 0x3fb8aa3b, v167
  v_exp_f32 v233, v233 clamp
  v_exp_f32 v235, v235 clamp
  v_max_f32 v234, 0, v166
  v_max_f32 v236, 0, v167
  v_add_f32 v233, 0x358637bd, v233
  v_add_f32 v235, 0x358637bd, v235
  v_add_f32 v166, v234, v233
  v_add_f32 v167, v236, v235
  v_mul_f32 v233, 0x3fb8aa3b, v168
  v_mul_f32 v235, 0x3fb8aa3b, v169
  v_exp_f32 v233, v233 clamp
  v_exp_f32 v235, v235 clamp
  v_max_f32 v234, 0, v168
  v_max_f32 v236, 0, v169
  v_add_f32 v233, 0x358637bd, v233
  v_add_f32 v235, 0x358637bd, v235
  v_add_f32 v168, v234, v233
  v_add_f32 v169, v236, v235
  v_mul_f32 v233, 0x3fb8aa3b, v170
  v_mul_f32 v235, 0x3fb8aa3b, v171
  v_exp_f32 v233, v233 clamp
  v_exp_f32 v235, v235 clamp
  v_max_f32 v234, 0, v170
  v_max_f32 v236, 0, v171
  v_add_f32 v233, 0x358637bd, v233
  v_add_f32 v235, 0x358637bd, v235
  v_add_f32 v170, v234, v233
  v_add_f32 v171, v236, v235
  v_mul_f32 v233, 0x3fb8aa3b, v172
  v_mul_f32 v235, 0x3fb8aa3b, v173
  v_exp_f32 v233, v233 clamp
  v_exp_f32 v235, v235 clamp
  v_max_f32 v234, 0, v172
  v_max_f32 v236, 0, v173
  v_add_f32 v233, 0x358637bd, v233
  v_add_f32 v235, 0x358637bd, v235
  v_add_f32 v172, v234, v233
  v_add_f32 v173, v236, v235
  v_mul_f32 v233, 0x3fb8aa3b, v174
  v_mul_f32 v235, 0x3fb8aa3b, v175
  v_exp_f32 v233, v233 clamp
  v_exp_f32 v235, v235 clamp
  v_max_f32 v234, 0, v174
  v_max_f32 v236, 0, v175
  v_add_f32 v233, 0x358637bd, v233
  v_add_f32 v235, 0x358637bd, v235
  v_add_f32 v174, v234, v233
  v_add_f32 v175, v236, v235
  v_cvt_pk_bf16_f32 v233, v160, v161
  v_accvgpr_write_b32 a208, v233
  v_cvt_pk_bf16_f32 v235, v162, v163
  v_accvgpr_write_b32 a209, v235
  v_cvt_pk_bf16_f32 v233, v164, v165
  v_accvgpr_write_b32 a210, v233
  v_cvt_pk_bf16_f32 v235, v166, v167
  v_accvgpr_write_b32 a211, v235
  v_cvt_pk_bf16_f32 v233, v168, v169
  v_accvgpr_write_b32 a212, v233
  v_cvt_pk_bf16_f32 v235, v170, v171
  v_accvgpr_write_b32 a213, v235
  v_cvt_pk_bf16_f32 v233, v172, v173
  v_accvgpr_write_b32 a214, v233
  v_cvt_pk_bf16_f32 v235, v174, v175
  v_accvgpr_write_b32 a215, v235
  s_mov_b64 exec, s[90:91]
  ds_write_b64 v239, a[208:209] offset:3072
  ds_write_b64 v239, a[210:211] offset:3088
  ds_write_b64 v239, a[212:213] offset:3104
  ds_write_b64 v239, a[214:215] offset:3120
  s_mov_b64 exec, -1
  s_waitcnt lgkmcnt(8)
  v_mfma_f32_32x32x16_bf16 v[144:159], a[72:75], v[24:27], v[144:159]
  ds_read_b64_tr_b16 a[88:89], v209 offset:20480
  ds_read_b64_tr_b16 a[90:91], v209 offset:20992
  buffer_load_dwordx4 v215, s[24:27], s71 offen offset:0 lds
  v_mul_f32 v233, 0x3fb8aa3b, v176
  v_mul_f32 v235, 0x3fb8aa3b, v177
  v_exp_f32 v233, v233 clamp
  v_mfma_f32_32x32x16_bf16 v[144:159], a[76:79], v[28:31], v[144:159]
  ds_read_b64_tr_b16 a[92:93], v209 offset:22528
  ds_read_b64_tr_b16 a[94:95], v209 offset:23040
  v_exp_f32 v235, v235 clamp
  v_max_f32 v234, 0, v176
  v_max_f32 v236, 0, v177
  v_add_f32 v233, 0x358637bd, v233
  s_waitcnt lgkmcnt(8)
  v_mfma_f32_32x32x16_bf16 v[144:159], a[80:83], v[32:35], v[144:159]
  ds_read_b64_tr_b16 a[72:73], v209 offset:24576
  ds_read_b64_tr_b16 a[74:75], v209 offset:25088
  buffer_load_dwordx4 v216, s[24:27], s71 offen offset:1024 lds
  v_add_f32 v235, 0x358637bd, v235
  v_add_f32 v234, v234, v233
  v_add_f32 v236, v236, v235
  v_cndmask_b32 v176, v176, v234, s[90:91]
  v_mfma_f32_32x32x16_bf16 v[144:159], a[84:87], v[36:39], v[144:159]
  ds_read_b64_tr_b16 a[76:77], v209 offset:26624
  ds_read_b64_tr_b16 a[78:79], v209 offset:27136
  v_cndmask_b32 v177, v177, v236, s[90:91]
  v_mul_f32 v233, 0x3fb8aa3b, v178
  v_mul_f32 v235, 0x3fb8aa3b, v179
  v_exp_f32 v233, v233 clamp
  s_waitcnt lgkmcnt(4)
  v_mfma_f32_32x32x16_bf16 v[144:159], a[88:91], v[40:43], v[144:159]
  ds_read_b64_tr_b16 a[80:81], v209 offset:28672
  ds_read_b64_tr_b16 a[82:83], v209 offset:29184
  buffer_load_dwordx4 v217, s[24:27], s71 offen offset:2048 lds
  v_exp_f32 v235, v235 clamp
  v_max_f32 v234, 0, v178
  v_max_f32 v236, 0, v179
  v_mfma_f32_32x32x16_bf16 v[144:159], a[92:95], v[44:47], v[144:159]
  ds_read_b64_tr_b16 a[84:85], v209 offset:30720
  ds_read_b64_tr_b16 a[86:87], v209 offset:31232
  s_add_u32 m0, s72, 24576
  s_add_u32 s71, s75, 1769472
  v_add_f32 v233, 0x358637bd, v233
  v_add_f32 v235, 0x358637bd, v235
  v_add_f32 v234, v234, v233
  s_waitcnt lgkmcnt(4)
  v_mfma_f32_32x32x16_bf16 v[144:159], a[72:75], v[48:51], v[144:159]
  ds_read_b64_tr_b16 a[88:89], v209 offset:32768
  ds_read_b64_tr_b16 a[90:91], v209 offset:33280
  buffer_load_dwordx4 v215, s[24:27], s71 offen offset:0 lds
  v_add_f32 v236, v236, v235
  v_cndmask_b32 v178, v178, v234, s[90:91]
  v_cndmask_b32 v179, v179, v236, s[90:91]
  v_mul_f32 v233, 0x3fb8aa3b, v180
  v_mfma_f32_32x32x16_bf16 v[144:159], a[76:79], v[52:55], v[144:159]
  ds_read_b64_tr_b16 a[92:93], v209 offset:34816
  ds_read_b64_tr_b16 a[94:95], v209 offset:35328
  v_mul_f32 v235, 0x3fb8aa3b, v181
  v_exp_f32 v233, v233 clamp
  v_exp_f32 v235, v235 clamp
  s_waitcnt lgkmcnt(4)
  v_mfma_f32_32x32x16_bf16 v[144:159], a[80:83], v[56:59], v[144:159]
  ds_read_b64_tr_b16 a[72:73], v209 offset:36864
  ds_read_b64_tr_b16 a[74:75], v209 offset:37376
  buffer_load_dwordx4 v216, s[24:27], s71 offen offset:1024 lds
  v_max_f32 v234, 0, v180
  v_max_f32 v236, 0, v181
  v_add_f32 v233, 0x358637bd, v233
  v_add_f32 v235, 0x358637bd, v235
  v_mfma_f32_32x32x16_bf16 v[144:159], a[84:87], v[60:63], v[144:159]
  ds_read_b64_tr_b16 a[76:77], v209 offset:38912
  ds_read_b64_tr_b16 a[78:79], v209 offset:39424
  v_add_f32 v234, v234, v233
  v_add_f32 v236, v236, v235
  v_cndmask_b32 v180, v180, v234, s[90:91]
  v_cndmask_b32 v181, v181, v236, s[90:91]
  v_mul_f32 v233, 0x3fb8aa3b, v182
  s_waitcnt lgkmcnt(4)
  v_mfma_f32_32x32x16_bf16 v[144:159], a[88:91], v[64:67], v[144:159]
  ds_read_b64_tr_b16 a[80:81], v209 offset:40960
  ds_read_b64_tr_b16 a[82:83], v209 offset:41472
  buffer_load_dwordx4 v217, s[24:27], s71 offen offset:2048 lds
  v_mul_f32 v235, 0x3fb8aa3b, v183
  v_exp_f32 v233, v233 clamp
  v_mfma_f32_32x32x16_bf16 v[144:159], a[92:95], v[68:71], v[144:159]
  s_waitcnt vmcnt(10)
  s_barrier
  ds_read_b64_tr_b16 a[84:85], v209 offset:43008
  ds_read_b64_tr_b16 a[86:87], v209 offset:43520
  s_add_u32 m0, s72, 36864
  s_add_u32 s71, s75, 2654208
  s_waitcnt lgkmcnt(4)
  v_mfma_f32_32x32x16_bf16 v[144:159], a[72:75], v[72:75], v[144:159]
  ds_read_b64_tr_b16 a[88:89], v209 offset:45056
  ds_read_b64_tr_b16 a[90:91], v209 offset:45568
  buffer_load_dwordx4 v215, s[24:27], s71 offen offset:0 lds
  v_exp_f32 v235, v235 clamp
  v_max_f32 v234, 0, v182
  v_max_f32 v236, 0, v183
  v_mfma_f32_32x32x16_bf16 v[144:159], a[76:79], v[76:79], v[144:159]
  ds_read_b64_tr_b16 a[92:93], v209 offset:47104
  ds_read_b64_tr_b16 a[94:95], v209 offset:47616
  v_add_f32 v233, 0x358637bd, v233
  v_add_f32 v235, 0x358637bd, v235
  v_add_f32 v234, v234, v233
  v_add_f32 v236, v236, v235
  v_cndmask_b32 v182, v182, v234, s[90:91]
  s_waitcnt lgkmcnt(4)
  v_mfma_f32_32x32x16_bf16 v[144:159], a[80:83], v[80:83], v[144:159]
  ds_read_b64_tr_b16 a[72:73], v209 offset:49152
  ds_read_b64_tr_b16 a[74:75], v209 offset:49664
  buffer_load_dwordx4 v216, s[24:27], s71 offen offset:1024 lds
  v_cndmask_b32 v183, v183, v236, s[90:91]
  v_mul_f32 v233, 0x3fb8aa3b, v184
  v_mul_f32 v235, 0x3fb8aa3b, v185
  v_exp_f32 v233, v233 clamp
  v_exp_f32 v235, v235 clamp
  v_max_f32 v234, 0, v184
  v_max_f32 v236, 0, v185
  v_add_f32 v233, 0x358637bd, v233
  v_add_f32 v235, 0x358637bd, v235
  v_add_f32 v234, v234, v233
  v_add_f32 v236, v236, v235
  v_cndmask_b32 v184, v184, v234, s[90:91]
  v_cndmask_b32 v185, v185, v236, s[90:91]
  v_mul_f32 v233, 0x3fb8aa3b, v186
  v_mul_f32 v235, 0x3fb8aa3b, v187
  v_exp_f32 v233, v233 clamp
  v_exp_f32 v235, v235 clamp
  v_max_f32 v234, 0, v186
  v_max_f32 v236, 0, v187
  v_add_f32 v233, 0x358637bd, v233
  v_add_f32 v235, 0x358637bd, v235
  v_add_f32 v234, v234, v233
  v_add_f32 v236, v236, v235
  v_cndmask_b32 v186, v186, v234, s[90:91]
  v_cndmask_b32 v187, v187, v236, s[90:91]
  v_mul_f32 v233, 0x3fb8aa3b, v188
  v_mul_f32 v235, 0x3fb8aa3b, v189
  v_exp_f32 v233, v233 clamp
  v_exp_f32 v235, v235 clamp
  v_max_f32 v234, 0, v188
  v_max_f32 v236, 0, v189
  v_add_f32 v233, 0x358637bd, v233
  v_add_f32 v235, 0x358637bd, v235
  v_add_f32 v234, v234, v233
  v_add_f32 v236, v236, v235
  v_cndmask_b32 v188, v188, v234, s[90:91]
  v_cndmask_b32 v189, v189, v236, s[90:91]
  v_mul_f32 v233, 0x3fb8aa3b, v190
  v_mul_f32 v235, 0x3fb8aa3b, v191
  v_exp_f32 v233, v233 clamp
  v_exp_f32 v235, v235 clamp
  v_max_f32 v234, 0, v190
  v_max_f32 v236, 0, v191
  v_add_f32 v233, 0x358637bd, v233
  v_add_f32 v235, 0x358637bd, v235
  v_add_f32 v234, v234, v233
  v_add_f32 v236, v236, v235
  v_cndmask_b32 v190, v190, v234, s[90:91]
  v_cndmask_b32 v191, v191, v236, s[90:91]
  v_cvt_pk_bf16_f32 v233, v176, v177
  v_cndmask_b32 v233, v233, v238, s[86:87]
  v_accvgpr_write_b32 a216, v233
  v_cvt_pk_bf16_f32 v235, v178, v179
  v_cndmask_b32 v235, v235, v238, s[86:87]
  v_accvgpr_write_b32 a217, v235
  v_cvt_pk_bf16_f32 v233, v180, v181
  v_cndmask_b32 v233, v233, v238, s[86:87]
  v_accvgpr_write_b32 a218, v233
  v_cvt_pk_bf16_f32 v235, v182, v183
  v_cndmask_b32 v235, v235, v238, s[86:87]
  v_accvgpr_write_b32 a219, v235
  v_cvt_pk_bf16_f32 v233, v184, v185
  v_cndmask_b32 v233, v233, v238, s[86:87]
  v_accvgpr_write_b32 a220, v233
  v_cvt_pk_bf16_f32 v235, v186, v187
  v_cndmask_b32 v235, v235, v238, s[86:87]
  v_accvgpr_write_b32 a221, v235
  v_cvt_pk_bf16_f32 v233, v188, v189
  v_cndmask_b32 v233, v233, v238, s[86:87]
  v_accvgpr_write_b32 a222, v233
  v_cvt_pk_bf16_f32 v235, v190, v191
  v_cndmask_b32 v235, v235, v238, s[86:87]
  v_accvgpr_write_b32 a223, v235
  s_mov_b64 exec, s[90:91]
  ds_write_b64 v239, a[216:217] offset:6144
  ds_write_b64 v239, a[218:219] offset:6160
  ds_write_b64 v239, a[220:221] offset:6176
  ds_write_b64 v239, a[222:223] offset:6192
  s_mov_b64 exec, -1
  v_mfma_f32_32x32x16_bf16 v[144:159], a[84:87], v[84:87], v[144:159]
  ds_read_b64_tr_b16 a[76:77], v209 offset:51200
  ds_read_b64_tr_b16 a[78:79], v209 offset:51712
  v_cvt_pk_bf16_f32 v233, v192, v193
  v_cndmask_b32 v233, v233, v238, s[88:89]
  v_accvgpr_write_b32 a224, v233
  v_cvt_pk_bf16_f32 v235, v194, v195
  v_cndmask_b32 v235, v235, v238, s[88:89]
  s_waitcnt lgkmcnt(8)
  v_mfma_f32_32x32x16_bf16 v[144:159], a[88:91], v[88:91], v[144:159]
  ds_read_b64_tr_b16 a[80:81], v209 offset:53248
  ds_read_b64_tr_b16 a[82:83], v209 offset:53760
  buffer_load_dwordx4 v217, s[24:27], s71 offen offset:2048 lds
  v_accvgpr_write_b32 a225, v235
  v_cvt_pk_bf16_f32 v233, v196, v197
  v_cndmask_b32 v233, v233, v238, s[88:89]
  v_accvgpr_write_b32 a226, v233
  v_mfma_f32_32x32x16_bf16 v[144:159], a[92:95], v[92:95], v[144:159]
  ds_read_b64_tr_b16 a[84:85], v209 offset:55296
  ds_read_b64_tr_b16 a[86:87], v209 offset:55808
  v_cvt_pk_bf16_f32 v235, v198, v199
  v_cndmask_b32 v235, v235, v238, s[88:89]
  v_accvgpr_write_b32 a227, v235
  v_cvt_pk_bf16_f32 v233, v200, v201
  v_cndmask_b32 v233, v233, v238, s[88:89]
  s_waitcnt lgkmcnt(4)
  v_mfma_f32_32x32x16_bf16 v[144:159], a[72:75], v[96:99], v[144:159]
  ds_read_b64_tr_b16 a[88:89], v209 offset:57344
  ds_read_b64_tr_b16 a[90:91], v209 offset:57856
  v_accvgpr_write_b32 a228, v233
  v_cvt_pk_bf16_f32 v235, v202, v203
  v_cndmask_b32 v235, v235, v238, s[88:89]
  v_accvgpr_write_b32 a229, v235
  v_mfma_f32_32x32x16_bf16 v[144:159], a[76:79], v[100:103], v[144:159]
  ds_read_b64_tr_b16 a[92:93], v209 offset:59392
  ds_read_b64_tr_b16 a[94:95], v209 offset:59904
  v_cvt_pk_bf16_f32 v233, v204, v205
  v_cndmask_b32 v233, v233, v238, s[88:89]
  v_accvgpr_write_b32 a230, v233
  v_cvt_pk_bf16_f32 v235, v206, v207
  v_cndmask_b32 v235, v235, v238, s[88:89]
  v_accvgpr_write_b32 a231, v235
  s_waitcnt lgkmcnt(4)
  v_mfma_f32_32x32x16_bf16 v[144:159], a[80:83], v[104:107], v[144:159]
  ds_read_b64_tr_b16 a[72:73], v209 offset:61440
  ds_read_b64_tr_b16 a[74:75], v209 offset:61952
  v_xor_b32 v212, 64, v211
  v_lshrrev_b32 v245, 5, v208
  v_mul_u32_u24 v245, 8, v245
  v_bfe_u32 v246, v208, 2, 2
  v_mfma_f32_32x32x16_bf16 v[144:159], a[84:87], v[108:111], v[144:159]
  ds_read_b64_tr_b16 a[76:77], v209 offset:63488
  ds_read_b64_tr_b16 a[78:79], v209 offset:64000
  v_add_u32 v245, v245, v246
  v_mul_u32_u24 v213, 64, v245
  s_waitcnt lgkmcnt(4)
  v_mfma_f32_32x32x16_bf16 v[144:159], a[88:91], v[112:115], v[144:159]
  v_add_u32 v209, 139264, v211
  ds_read_b64_tr_b16 a[80:81], v209 offset:0
  ds_read_b64_tr_b16 a[82:83], v209 offset:512
  v_mfma_f32_32x32x16_bf16 a[168:183], a[200:203], a[216:219], 0
  v_mfma_f32_32x32x16_bf16 a[168:183], a[204:207], a[220:223], a[168:183]
  v_mfma_f32_32x32x16_bf16 a[184:199], a[208:211], a[224:227], 0
  v_mfma_f32_32x32x16_bf16 a[184:199], a[212:215], a[228:231], a[184:199]
  v_mfma_f32_32x32x16_bf16 v[144:159], a[92:95], v[116:119], v[144:159]
  ds_read_b64_tr_b16 a[84:85], v209 offset:2048
  ds_read_b64_tr_b16 a[86:87], v209 offset:2560
  s_waitcnt lgkmcnt(4)
  v_mfma_f32_32x32x16_bf16 v[144:159], a[72:75], v[120:123], v[144:159]
  ds_read_b64_tr_b16 a[88:89], v209 offset:4096
  ds_read_b64_tr_b16 a[90:91], v209 offset:4608
  v_bfe_u32 v245, v208, 4, 1
  v_mfma_f32_32x32x16_bf16 v[144:159], a[76:79], v[124:127], v[144:159]
  ds_read_b64_tr_b16 a[92:93], v209 offset:6144
  ds_read_b64_tr_b16 a[94:95], v209 offset:6656
  s_waitcnt lgkmcnt(4)
  v_mfma_f32_32x32x16_bf16 v[144:159], a[80:83], v[128:131], v[144:159]
  v_add_u32 v210, 73728, v212
  ds_read_b64_tr_b16 a[72:73], v210 offset:0
  ds_read_b64_tr_b16 a[74:75], v210 offset:512
  s_mov_b64 exec, s[92:93]
  ds_write_b128 v241, a[168:171] offset:0
  ds_write_b128 v241, a[172:175] offset:640
  ds_write_b128 v241, a[176:179] offset:1280
  s_mov_b64 exec, -1
  v_mfma_f32_32x32x16_bf16 v[144:159], a[84:87], v[132:135], v[144:159]
  ds_read_b64_tr_b16 a[76:77], v210 offset:2048
  ds_read_b64_tr_b16 a[78:79], v210 offset:2560
  s_mov_b64 exec, s[92:93]
  ds_write_b128 v241, a[184:187] offset:1920
  ds_write_b128 v241, a[188:191] offset:2560
  ds_write_b128 v241, a[192:195] offset:3200
  s_mov_b64 exec, -1
  s_waitcnt lgkmcnt(10)
  v_mfma_f32_32x32x16_bf16 v[144:159], a[88:91], v[136:139], v[144:159]
  ds_read_b64_tr_b16 a[80:81], v210 offset:4096
  ds_read_b64_tr_b16 a[82:83], v210 offset:4608
  s_waitcnt vmcnt(12)
  v_cmp_gt_u32 vcc, 16, v251
  s_nop 3
  s_cbranch_vccnz L_slow0
L_ret0:
  v_mfma_f32_32x32x16_bf16 v[144:159], a[92:95], v[140:143], v[144:159]
  s_waitcnt lgkmcnt(0)
  s_barrier
  ds_read_b64_tr_b16 a[84:85], v210 offset:6144
  ds_read_b64_tr_b16 a[86:87], v210 offset:6656
  v_mfma_f32_32x32x16_bf16 v[160:175], a[72:75], v[0:3], 0
  ds_read_b64_tr_b16 a[88:89], v210 offset:8192
  ds_read_b64_tr_b16 a[90:91], v210 offset:8704
  ds_read_b128 a[200:203], v243 offset:0
  ds_read_b128 a[204:207], v243 offset:3840
  ds_read_b128 a[208:211], v243 offset:7680
  v_lshlrev_b32 v245, 5, v245
  v_mfma_f32_32x32x16_bf16 v[160:175], a[76:79], v[4:7], v[160:175]
  ds_read_b64_tr_b16 a[92:93], v210 offset:10240
  ds_read_b64_tr_b16 a[94:95], v210 offset:10752
  ds_read_b128 a[212:215], v243 offset:11520
  s_waitcnt lgkmcnt(5)
  v_accvgpr_read_b32 v225, a200
  v_mfma_f32_32x32x16_bf16 v[160:175], a[80:83], v[8:11], v[160:175]
  ds_read_b64_tr_b16 a[72:73], v210 offset:12288
  ds_read_b64_tr_b16 a[74:75], v210 offset:12800
  v_accvgpr_read_b32 v226, a201
  v_accvgpr_read_b32 v227, a202
  v_mfma_f32_32x32x16_bf16 v[160:175], a[84:87], v[12:15], v[160:175]
  ds_read_b64_tr_b16 a[76:77], v210 offset:14336
  ds_read_b64_tr_b16 a[78:79], v210 offset:14848
  v_mul_f32 v229, v144, v144
  v_mul_f32 v230, v145, v145
  v_fmaak_f32 v229, v229, v223, 0xc0135761
  s_waitcnt lgkmcnt(5)
  v_mfma_f32_32x32x16_bf16 v[160:175], a[88:91], v[16:19], v[160:175]
  ds_read_b64_tr_b16 a[80:81], v210 offset:16384
  ds_read_b64_tr_b16 a[82:83], v210 offset:16896
  v_fmaak_f32 v230, v230, v223, 0xc0135761
  v_mul_f32 v229, v229, v144
  v_mul_f32 v230, v230, v145
  v_accvgpr_read_b32 v228, a203
  v_mfma_f32_32x32x16_bf16 v[160:175], a[92:95], v[20:23], v[160:175]
  ds_read_b64_tr_b16 a[84:85], v210 offset:18432
  ds_read_b64_tr_b16 a[86:87], v210 offset:18944
  v_accvgpr_read_b32 v233, a204
  v_exp_f32 v229, v229
  s_waitcnt lgkmcnt(4)
  v_mfma_f32_32x32x16_bf16 v[160:175], a[72:75], v[24:27], v[160:175]
  ds_read_b64_tr_b16 a[88:89], v210 offset:20480
  ds_read_b64_tr_b16 a[90:91], v210 offset:20992
  v_accvgpr_read_b32 v234, a205
  v_accvgpr_read_b32 v235, a206
  v_exp_f32 v230, v230
  v_mfma_f32_32x32x16_bf16 v[160:175], a[76:79], v[28:31], v[160:175]
  ds_read_b64_tr_b16 a[92:93], v210 offset:22528
  ds_read_b64_tr_b16 a[94:95], v210 offset:23040
  v_accvgpr_read_b32 v236, a207
  v_add_f32 v225, v225, v233
  v_add_f32 v226, v226, v234
  s_waitcnt lgkmcnt(4)
  v_mfma_f32_32x32x16_bf16 v[160:175], a[80:83], v[32:35], v[160:175]
  ds_read_b64_tr_b16 a[72:73], v210 offset:24576
  ds_read_b64_tr_b16 a[74:75], v210 offset:25088
  v_add_f32 v227, v227, v235
  v_add_f32 v228, v228, v236
  v_add_f32 v229, 1.0, v229
  v_add_f32 v230, 1.0, v230
  v_mfma_f32_32x32x16_bf16 v[160:175], a[84:87], v[36:39], v[160:175]
  ds_read_b64_tr_b16 a[76:77], v210 offset:26624
  ds_read_b64_tr_b16 a[78:79], v210 offset:27136
  v_accvgpr_read_b32 v233, a208
  v_accvgpr_read_b32 v234, a209
  v_accvgpr_read_b32 v235, a210
  s_waitcnt lgkmcnt(4)
  v_mfma_f32_32x32x16_bf16 v[160:175], a[88:91], v[40:43], v[160:175]
  ds_read_b64_tr_b16 a[80:81], v210 offset:28672
  ds_read_b64_tr_b16 a[82:83], v210 offset:29184
  v_accvgpr_read_b32 v236, a211
  v_add_f32 v225, v225, v233
  v_rcp_f32 v229, v229
  v_mfma_f32_32x32x16_bf16 v[160:175], a[92:95], v[44:47], v[160:175]
  ds_read_b64_tr_b16 a[84:85], v210 offset:30720
  ds_read_b64_tr_b16 a[86:87], v210 offset:31232
  v_add_f32 v226, v226, v234
  v_add_f32 v227, v227, v235
  v_add_f32 v228, v228, v236
  s_waitcnt lgkmcnt(4)
  v_mfma_f32_32x32x16_bf16 v[160:175], a[72:75], v[48:51], v[160:175]
  ds_read_b64_tr_b16 a[88:89], v210 offset:32768
  ds_read_b64_tr_b16 a[90:91], v210 offset:33280
  v_accvgpr_read_b32 v233, a212
  v_accvgpr_read_b32 v234, a213
  v_rcp_f32 v230, v230
  v_mfma_f32_32x32x16_bf16 v[160:175], a[76:79], v[52:55], v[160:175]
  ds_read_b64_tr_b16 a[92:93], v210 offset:34816
  ds_read_b64_tr_b16 a[94:95], v210 offset:35328
  v_accvgpr_read_b32 v235, a214
  v_accvgpr_read_b32 v236, a215
  v_mul_f32 v144, v144, v229
  s_waitcnt lgkmcnt(4)
  v_mfma_f32_32x32x16_bf16 v[160:175], a[80:83], v[56:59], v[160:175]
  ds_read_b64_tr_b16 a[72:73], v210 offset:36864
  ds_read_b64_tr_b16 a[74:75], v210 offset:37376
  v_add_f32 v225, v225, v233
  v_add_f32 v226, v226, v234
  v_add_f32 v227, v227, v235
  v_mul_f32 v145, v145, v230
  v_mfma_f32_32x32x16_bf16 v[160:175], a[84:87], v[60:63], v[160:175]
  ds_read_b64_tr_b16 a[76:77], v210 offset:38912
  ds_read_b64_tr_b16 a[78:79], v210 offset:39424
  v_add_f32 v228, v228, v236
  buffer_atomic_add_f32 v225, v237, s[40:43], s78 offen offset:0
  buffer_atomic_add_f32 v226, v237, s[40:43], s78 offen offset:1024
  buffer_atomic_add_f32 v227, v237, s[40:43], s78 offen offset:2048
  buffer_atomic_add_f32 v228, v237, s[40:43], s78 offen offset:3072
  s_waitcnt lgkmcnt(4)
  v_mfma_f32_32x32x16_bf16 v[160:175], a[88:91], v[64:67], v[160:175]
  ds_read_b64_tr_b16 a[80:81], v210 offset:40960
  ds_read_b64_tr_b16 a[82:83], v210 offset:41472
  v_mul_f32 v229, v146, v146
  v_mul_f32 v230, v147, v147
  v_fmaak_f32 v229, v229, v223, 0xc0135761
  v_fmaak_f32 v230, v230, v223, 0xc0135761
  v_mfma_f32_32x32x16_bf16 v[160:175], a[92:95], v[68:71], v[160:175]
  s_waitcnt vmcnt(13)
  s_barrier
  ds_read_b64_tr_b16 a[84:85], v210 offset:43008
  ds_read_b64_tr_b16 a[86:87], v210 offset:43520
  s_add_u32 m0, s72, 49152
  s_add_u32 s71, s75, 3538944
  s_waitcnt lgkmcnt(4)
  v_mfma_f32_32x32x16_bf16 v[160:175], a[72:75], v[72:75], v[160:175]
  ds_read_b64_tr_b16 a[88:89], v210 offset:45056
  ds_read_b64_tr_b16 a[90:91], v210 offset:45568
  buffer_load_dwordx4 v215, s[24:27], s71 offen offset:0 lds
  v_mul_f32 v229, v229, v146
  v_mul_f32 v230, v230, v147
  v_mfma_f32_32x32x16_bf16 v[160:175], a[76:79], v[76:79], v[160:175]
  ds_read_b64_tr_b16 a[92:93], v210 offset:47104
  ds_read_b64_tr_b16 a[94:95], v210 offset:47616
  v_exp_f32 v229, v229
  v_and_b32 v246, 3, v208
  s_waitcnt lgkmcnt(4)
  v_mfma_f32_32x32x16_bf16 v[160:175], a[80:83], v[80:83], v[160:175]
  ds_read_b64_tr_b16 a[72:73], v210 offset:49152
  ds_read_b64_tr_b16 a[74:75], v210 offset:49664
  buffer_load_dwordx4 v216, s[24:27], s71 offen offset:1024 lds
  v_exp_f32 v230, v230
  v_mfma_f32_32x32x16_bf16 v[160:175], a[84:87], v[84:87], v[160:175]
  ds_read_b64_tr_b16 a[76:77], v210 offset:51200
  ds_read_b64_tr_b16 a[78:79], v210 offset:51712
  v_add_f32 v229, 1.0, v229
  v_add_f32 v230, 1.0, v230
  v_lshl_add_u32 v245, v246, 3, v245
  s_waitcnt lgkmcnt(4)
  v_mfma_f32_32x32x16_bf16 v[160:175], a[88:91], v[88:91], v[160:175]
  ds_read_b64_tr_b16 a[80:81], v210 offset:53248
  ds_read_b64_tr_b16 a[82:83], v210 offset:53760
  v_rcp_f32 v229, v229
  v_rcp_f32 v230, v230
  v_mfma_f32_32x32x16_bf16 v[160:175], a[92:95], v[92:95], v[160:175]
  ds_read_b64_tr_b16 a[84:85], v210 offset:55296
  ds_read_b64_tr_b16 a[86:87], v210 offset:55808
  buffer_load_dwordx4 v217, s[24:27], s71 offen offset:2048 lds
  v_mul_f32 v146, v146, v229
  v_add_u32 v213, v213, v245
  s_waitcnt lgkmcnt(4)
  v_mfma_f32_32x32x16_bf16 v[160:175], a[72:75], v[96:99], v[160:175]
  ds_read_b64_tr_b16 a[88:89], v210 offset:57344
  ds_read_b64_tr_b16 a[90:91], v210 offset:57856
  v_mul_f32 v147, v147, v230
  v_mul_f32 v229, v148, v148
  v_mul_f32 v230, v149, v149
  v_fmaak_f32 v229, v229, v223, 0xc0135761
  v_mfma_f32_32x32x16_bf16 v[160:175], a[76:79], v[100:103], v[160:175]
  ds_read_b64_tr_b16 a[92:93], v210 offset:59392
  ds_read_b64_tr_b16 a[94:95], v210 offset:59904
  s_add_u32 m0, s72, 61440
  s_add_u32 s71, s75, 4423680
  v_fmaak_f32 v230, v230, v223, 0xc0135761
  s_waitcnt lgkmcnt(4)
  v_mfma_f32_32x32x16_bf16 v[160:175], a[80:83], v[104:107], v[160:175]
  ds_read_b64_tr_b16 a[72:73], v210 offset:61440
  ds_read_b64_tr_b16 a[74:75], v210 offset:61952
  buffer_load_dwordx4 v215, s[24:27], s71 offen offset:0 lds
  v_mul_f32 v229, v229, v148
  v_mul_f32 v230, v230, v149
  v_mfma_f32_32x32x16_bf16 v[160:175], a[84:87], v[108:111], v[160:175]
  ds_read_b64_tr_b16 a[76:77], v210 offset:63488
  ds_read_b64_tr_b16 a[78:79], v210 offset:64000
  v_exp_f32 v229, v229
  v_lshrrev_b32 v245, 5, v208
  s_waitcnt lgkmcnt(4)
  v_mfma_f32_32x32x16_bf16 v[160:175], a[88:91], v[112:115], v[160:175]
  v_add_u32 v210, 139264, v212
  ds_read_b64_tr_b16 a[80:81], v210 offset:0
  ds_read_b64_tr_b16 a[82:83], v210 offset:512
  v_exp_f32 v230, v230
  v_add_f32 v229, 1.0, v229
  v_mfma_f32_32x32x16_bf16 v[160:175], a[92:95], v[116:119], v[160:175]
  ds_read_b64_tr_b16 a[84:85], v210 offset:2048
  ds_read_b64_tr_b16 a[86:87], v210 offset:2560
  buffer_load_dwordx4 v216, s[24:27], s71 offen offset:1024 lds
  v_add_f32 v230, 1.0, v230
  s_waitcnt lgkmcnt(4)
  v_mfma_f32_32x32x16_bf16 v[160:175], a[72:75], v[120:123], v[160:175]
  ds_read_b64_tr_b16 a[88:89], v210 offset:4096
  ds_read_b64_tr_b16 a[90:91], v210 offset:4608
  v_rcp_f32 v229, v229
  v_rcp_f32 v230, v230
  v_mfma_f32_32x32x16_bf16 v[160:175], a[76:79], v[124:127], v[160:175]
  ds_read_b64_tr_b16 a[92:93], v210 offset:6144
  ds_read_b64_tr_b16 a[94:95], v210 offset:6656
  v_mul_f32 v148, v148, v229
  v_mul_f32 v149, v149, v230
  v_mul_f32 v229, v150, v150
  s_waitcnt lgkmcnt(4)
  v_mfma_f32_32x32x16_bf16 v[160:175], a[80:83], v[128:131], v[160:175]
  v_mov_b32 v209, v211
  ds_read_b64_tr_b16 a[72:73], v209 offset:0
  ds_read_b64_tr_b16 a[74:75], v209 offset:512
  buffer_load_dwordx4 v217, s[24:27], s71 offen offset:2048 lds
  v_mul_f32 v230, v151, v151
  v_mfma_f32_32x32x16_bf16 v[160:175], a[84:87], v[132:135], v[160:175]
  ds_read_b64_tr_b16 a[76:77], v209 offset:2048
  ds_read_b64_tr_b16 a[78:79], v209 offset:2560
  v_fmaak_f32 v229, v229, v223, 0xc0135761
  v_fmaak_f32 v230, v230, v223, 0xc0135761
  v_mul_f32 v229, v229, v150
  s_waitcnt lgkmcnt(4)
  v_mfma_f32_32x32x16_bf16 v[160:175], a[88:91], v[136:139], v[160:175]
  ds_read_b64_tr_b16 a[80:81], v209 offset:4096
  ds_read_b64_tr_b16 a[82:83], v209 offset:4608
  s_add_u32 m0, s72, 73728
  s_add_u32 s71, s75, 128
  v_mul_f32 v230, v230, v151
  v_mfma_f32_32x32x16_bf16 v[160:175], a[92:95], v[140:143], v[160:175]
  s_waitcnt vmcnt(10)
  s_barrier
  ds_read_b64_tr_b16 a[84:85], v209 offset:6144
  ds_read_b64_tr_b16 a[86:87], v209 offset:6656
  buffer_load_dwordx4 v215, s[20:23], s71 offen offset:0 lds
  s_waitcnt lgkmcnt(4)
  v_mfma_f32_32x32x16_bf16 v[176:191], a[72:75], v[0:3], 0
  ds_read_b64_tr_b16 a[88:89], v209 offset:8192
  ds_read_b64_tr_b16 a[90:91], v209 offset:8704
  v_exp_f32 v229, v229
  v_exp_f32 v230, v230
  v_mfma_f32_32x32x16_bf16 v[176:191], a[76:79], v[4:7], v[176:191]
  ds_read_b64_tr_b16 a[92:93], v209 offset:10240
  ds_read_b64_tr_b16 a[94:95], v209 offset:10752
  v_add_f32 v229, 1.0, v229
  v_add_f32 v230, 1.0, v230
  v_mul_u32_u24 v245, 4, v245
  s_waitcnt lgkmcnt(4)
  v_mfma_f32_32x32x16_bf16 v[176:191], a[80:83], v[8:11], v[176:191]
  ds_read_b64_tr_b16 a[72:73], v209 offset:12288
  ds_read_b64_tr_b16 a[74:75], v209 offset:12800
  buffer_load_dwordx4 v216, s[20:23], s71 offen offset:1024 lds
  v_rcp_f32 v229, v229
  v_mfma_f32_32x32x16_bf16 v[176:191], a[84:87], v[12:15], v[176:191]
  ds_read_b64_tr_b16 a[76:77], v209 offset:14336
  ds_read_b64_tr_b16 a[78:79], v209 offset:14848
  v_rcp_f32 v230, v230
  v_mul_f32 v150, v150, v229
  s_waitcnt lgkmcnt(4)
  v_mfma_f32_32x32x16_bf16 v[176:191], a[88:91], v[16:19], v[176:191]
  ds_read_b64_tr_b16 a[80:81], v209 offset:16384
  ds_read_b64_tr_b16 a[82:83], v209 offset:16896
  v_mul_f32 v151, v151, v230
  v_mul_f32 v229, v152, v152
  v_mul_f32 v230, v153, v153
  v_fmaak_f32 v229, v229, v223, 0xc0135761
  v_mfma_f32_32x32x16_bf16 v[176:191], a[92:95], v[20:23], v[176:191]
  ds_read_b64_tr_b16 a[84:85], v209 offset:18432
  ds_read_b64_tr_b16 a[86:87], v209 offset:18944
  buffer_load_dwordx4 v217, s[20:23], s71 offen offset:2048 lds
  v_fmaak_f32 v230, v230, v223, 0xc0135761
  v_mul_f32 v229, v229, v152
  v_mul_f32 v230, v230, v153
  s_waitcnt lgkmcnt(4)
  v_mfma_f32_32x32x16_bf16 v[176:191], a[72:75], v[24:27], v[176:191]
  ds_read_b64_tr_b16 a[88:89], v209 offset:20480
  ds_read_b64_tr_b16 a[90:91], v209 offset:20992
  v_exp_f32 v229, v229
  v_exp_f32 v230, v230
  v_mfma_f32_32x32x16_bf16 v[176:191], a[76:79], v[28:31], v[176:191]
  ds_read_b64_tr_b16 a[92:93], v209 offset:22528
  ds_read_b64_tr_b16 a[94:95], v209 offset:23040
  s_add_u32 m0, s72, 86016
  s_add_u32 s71, s75, 884864
  v_add_f32 v229, 1.0, v229
  v_add_f32 v230, 1.0, v230
  s_waitcnt lgkmcnt(4)
  v_mfma_f32_32x32x16_bf16 v[176:191], a[80:83], v[32:35], v[176:191]
  ds_read_b64_tr_b16 a[72:73], v209 offset:24576
  ds_read_b64_tr_b16 a[74:75], v209 offset:25088
  buffer_load_dwordx4 v215, s[20:23], s71 offen offset:0 lds
  v_rcp_f32 v229, v229
  v_rcp_f32 v230, v230
  v_mfma_f32_32x32x16_bf16 v[176:191], a[84:87], v[36:39], v[176:191]
  ds_read_b64_tr_b16 a[76:77], v209 offset:26624
  ds_read_b64_tr_b16 a[78:79], v209 offset:27136
  v_mul_f32 v152, v152, v229
  v_mul_f32 v153, v153, v230
  v_mul_f32 v229, v154, v154
  v_mul_f32 v230, v155, v155
  s_waitcnt lgkmcnt(4)
  v_mfma_f32_32x32x16_bf16 v[176:191], a[88:91], v[40:43], v[176:191]
  ds_read_b64_tr_b16 a[80:81], v209 offset:28672
  ds_read_b64_tr_b16 a[82:83], v209 offset:29184
  v_fmaak_f32 v229, v229, v223, 0xc0135761
  v_fmaak_f32 v230, v230, v223, 0xc0135761
  v_mul_f32 v229, v229, v154
  v_mul_f32 v230, v230, v155
  v_mfma_f32_32x32x16_bf16 v[176:191], a[92:95], v[44:47], v[176:191]
  ds_read_b64_tr_b16 a[84:85], v209 offset:30720
  ds_read_b64_tr_b16 a[86:87], v209 offset:31232
  buffer_load_dwordx4 v216, s[20:23], s71 offen offset:1024 lds
  v_exp_f32 v229, v229
  s_waitcnt lgkmcnt(4)
  v_mfma_f32_32x32x16_bf16 v[176:191], a[72:75], v[48:51], v[176:191]
  ds_read_b64_tr_b16 a[88:89], v209 offset:32768
  ds_read_b64_tr_b16 a[90:91], v209 offset:33280
  v_exp_f32 v230, v230
  v_add_f32 v229, 1.0, v229
  v_add_f32 v230, 1.0, v230
  v_mfma_f32_32x32x16_bf16 v[176:191], a[76:79], v[52:55], v[176:191]
  ds_read_b64_tr_b16 a[92:93], v209 offset:34816
  ds_read_b64_tr_b16 a[94:95], v209 offset:35328
  v_rcp_f32 v229, v229
  v_rcp_f32 v230, v230
  s_waitcnt lgkmcnt(4)
  v_mfma_f32_32x32x16_bf16 v[176:191], a[80:83], v[56:59], v[176:191]
  ds_read_b64_tr_b16 a[72:73], v209 offset:36864
  ds_read_b64_tr_b16 a[74:75], v209 offset:37376
  buffer_load_dwordx4 v217, s[20:23], s71 offen offset:2048 lds
  v_mul_f32 v154, v154, v229
  v_mul_f32 v155, v155, v230
  v_mul_f32 v229, v156, v156
  v_mfma_f32_32x32x16_bf16 v[176:191], a[84:87], v[60:63], v[176:191]
  ds_read_b64_tr_b16 a[76:77], v209 offset:38912
  ds_read_b64_tr_b16 a[78:79], v209 offset:39424
  v_mul_f32 v230, v157, v157
  v_fmaak_f32 v229, v229, v223, 0xc0135761
  v_fmaak_f32 v230, v230, v223, 0xc0135761
  v_mul_f32 v229, v229, v156
  s_waitcnt lgkmcnt(4)
  v_mfma_f32_32x32x16_bf16 v[176:191], a[88:91], v[64:67], v[176:191]
  ds_read_b64_tr_b16 a[80:81], v209 offset:40960
  ds_read_b64_tr_b16 a[82:83], v209 offset:41472
  s_add_u32 m0, s72, 98304
  s_add_u32 s71, s75, 1769600
  v_mul_f32 v230, v230, v157
  v_exp_f32 v229, v229
  v_mfma_f32_32x32x16_bf16 v[176:191], a[92:95], v[68:71], v[176:191]
  s_waitcnt vmcnt(6)
  s_barrier
  ds_read_b64_tr_b16 a[84:85], v209 offset:43008
  ds_read_b64_tr_b16 a[86:87], v209 offset:43520
  buffer_load_dwordx4 v215, s[20:23], s71 offen offset:0 lds
  v_mov_b32 v255, 1
  s_lshl_b32 s84, s44, 2
  buffer_atomic_add v255, v253, s[36:39], s84 offen sc1
  s_waitcnt lgkmcnt(4)
  v_mfma_f32_32x32x16_bf16 v[176:191], a[72:75], v[72:75], v[176:191]
  ds_read_b64_tr_b16 a[88:89], v209 offset:45056
  ds_read_b64_tr_b16 a[90:91], v209 offset:45568
  v_exp_f32 v230, v230
  v_add_f32 v229, 1.0, v229
  v_add_f32 v230, 1.0, v230
  v_rcp_f32 v229, v229
  v_mfma_f32_32x32x16_bf16 v[176:191], a[76:79], v[76:79], v[176:191]
  ds_read_b64_tr_b16 a[92:93], v209 offset:47104
  ds_read_b64_tr_b16 a[94:95], v209 offset:47616
  v_rcp_f32 v230, v230
  v_mul_f32 v156, v156, v229
  v_mul_f32 v157, v157, v230
  v_mul_f32 v229, v158, v158
  s_waitcnt lgkmcnt(4)
  v_mfma_f32_32x32x16_bf16 v[176:191], a[80:83], v[80:83], v[176:191]
  ds_read_b64_tr_b16 a[72:73], v209 offset:49152
  ds_read_b64_tr_b16 a[74:75], v209 offset:49664
  buffer_load_dwordx4 v216, s[20:23], s71 offen offset:1024 lds
  v_mul_f32 v230, v159, v159
  v_fmaak_f32 v229, v229, v223, 0xc0135761
  v_fmaak_f32 v230, v230, v223, 0xc0135761
  v_mfma_f32_32x32x16_bf16 v[176:191], a[84:87], v[84:87], v[176:191]
  ds_read_b64_tr_b16 a[76:77], v209 offset:51200
  ds_read_b64_tr_b16 a[78:79], v209 offset:51712
  v_mul_f32 v229, v229, v158
  v_mul_f32 v230, v230, v159
  v_exp_f32 v229, v229
  s_waitcnt lgkmcnt(4)
  v_mfma_f32_32x32x16_bf16 v[176:191], a[88:91], v[88:91], v[176:191]
  ds_read_b64_tr_b16 a[80:81], v209 offset:53248
  ds_read_b64_tr_b16 a[82:83], v209 offset:53760
  v_exp_f32 v230, v230
  v_add_f32 v229, 1.0, v229
  v_add_f32 v230, 1.0, v230
  v_mfma_f32_32x32x16_bf16 v[176:191], a[92:95], v[92:95], v[176:191]
  ds_read_b64_tr_b16 a[84:85], v209 offset:55296
  ds_read_b64_tr_b16 a[86:87], v209 offset:55808
  buffer_load_dwordx4 v217, s[20:23], s71 offen offset:2048 lds
  v_rcp_f32 v229, v229
  v_rcp_f32 v230, v230
  v_mul_f32 v158, v158, v229
  v_mul_f32 v159, v159, v230
  s_waitcnt lgkmcnt(4)
  v_mfma_f32_32x32x16_bf16 v[176:191], a[72:75], v[96:99], v[176:191]
  ds_read_b64_tr_b16 a[88:89], v209 offset:57344
  ds_read_b64_tr_b16 a[90:91], v209 offset:57856
  v_bfe_u32 v246, v208, 2, 2
  v_mfma_f32_32x32x16_bf16 v[176:191], a[76:79], v[100:103], v[176:191]
  ds_read_b64_tr_b16 a[92:93], v209 offset:59392
  ds_read_b64_tr_b16 a[94:95], v209 offset:59904
  s_add_u32 m0, s72, 110592
  s_add_u32 s71, s75, 2654336
  v_mul_f32 v229, v160, v160
  s_waitcnt lgkmcnt(4)
  v_mfma_f32_32x32x16_bf16 v[176:191], a[80:83], v[104:107], v[176:191]
  ds_read_b64_tr_b16 a[72:73], v209 offset:61440
  ds_read_b64_tr_b16 a[74:75], v209 offset:61952
  buffer_load_dwordx4 v215, s[20:23], s71 offen offset:0 lds
  v_mul_f32 v230, v161, v161
  v_mul_f32 v225, v162, v162
  v_mfma_f32_32x32x16_bf16 v[176:191], a[84:87], v[108:111], v[176:191]
  ds_read_b64_tr_b16 a[76:77], v209 offset:63488
  ds_read_b64_tr_b16 a[78:79], v209 offset:64000
  v_mul_f32 v226, v163, v163
  v_fmaak_f32 v229, v229, v223, 0xc0135761
  v_fmaak_f32 v230, v230, v223, 0xc0135761
  s_waitcnt lgkmcnt(4)
  v_mfma_f32_32x32x16_bf16 v[176:191], a[88:91], v[112:115], v[176:191]
  v_add_u32 v209, 65536, v211
  ds_read_b64_tr_b16 a[80:81], v209 offset:0
  ds_read_b64_tr_b16 a[82:83], v209 offset:512
  v_fmaak_f32 v225, v225, v223, 0xc0135761
  v_fmaak_f32 v226, v226, v223, 0xc0135761
  v_mul_f32 v229, v229, v160
  v_mfma_f32_32x32x16_bf16 v[176:191], a[92:95], v[116:119], v[176:191]
  ds_read_b64_tr_b16 a[84:85], v209 offset:2048
  ds_read_b64_tr_b16 a[86:87], v209 offset:2560
  buffer_load_dwordx4 v216, s[20:23], s71 offen offset:1024 lds
  v_mul_f32 v230, v230, v161
  s_waitcnt lgkmcnt(4)
  v_mfma_f32_32x32x16_bf16 v[176:191], a[72:75], v[120:123], v[176:191]
  ds_read_b64_tr_b16 a[88:89], v209 offset:4096
  ds_read_b64_tr_b16 a[90:91], v209 offset:4608
  v_mul_f32 v225, v225, v162
  v_mul_f32 v226, v226, v163
  v_exp_f32 v229, v229
  v_mfma_f32_32x32x16_bf16 v[176:191], a[76:79], v[124:127], v[176:191]
  ds_read_b64_tr_b16 a[92:93], v209 offset:6144
  ds_read_b64_tr_b16 a[94:95], v209 offset:6656
  v_exp_f32 v230, v230
  v_add_u32 v245, v245, v246
  s_waitcnt lgkmcnt(4)
  v_mfma_f32_32x32x16_bf16 v[176:191], a[80:83], v[128:131], v[176:191]
  v_mov_b32 v210, v212
  ds_read_b64_tr_b16 a[72:73], v210 offset:0
  ds_read_b64_tr_b16 a[74:75], v210 offset:512
  buffer_load_dwordx4 v217, s[20:23], s71 offen offset:2048 lds
  v_mfma_f32_32x32x16_bf16 v[176:191], a[84:87], v[132:135], v[176:191]
  ds_read_b64_tr_b16 a[76:77], v210 offset:2048
  ds_read_b64_tr_b16 a[78:79], v210 offset:2560
  v_exp_f32 v225, v225
  s_waitcnt lgkmcnt(4)
  v_mfma_f32_32x32x16_bf16 v[176:191], a[88:91], v[136:139], v[176:191]
  ds_read_b64_tr_b16 a[80:81], v210 offset:4096
  ds_read_b64_tr_b16 a[82:83], v210 offset:4608
  s_add_u32 m0, s72, 122880
  s_add_u32 s71, s75, 3539072
  v_exp_f32 v226, v226
  v_mfma_f32_32x32x16_bf16 v[176:191], a[92:95], v[140:143], v[176:191]
  ds_read_b64_tr_b16 a[84:85], v210 offset:6144
  ds_read_b64_tr_b16 a[86:87], v210 offset:6656
  buffer_load_dwordx4 v215, s[20:23], s71 offen offset:0 lds
  v_add_f32 v229, 1.0, v229
  s_waitcnt lgkmcnt(4)
  v_mfma_f32_32x32x16_bf16 v[192:207], a[72:75], v[0:3], 0
  ds_read_b64_tr_b16 a[88:89], v210 offset:8192
  ds_read_b64_tr_b16 a[90:91], v210 offset:8704
  v_add_f32 v230, 1.0, v230
  v_add_f32 v225, 1.0, v225
  v_add_f32 v226, 1.0, v226
  v_mfma_f32_32x32x16_bf16 v[192:207], a[76:79], v[4:7], v[192:207]
  ds_read_b64_tr_b16 a[92:93], v210 offset:10240
  ds_read_b64_tr_b16 a[94:95], v210 offset:10752
  v_rcp_f32 v229, v229
  s_mul_i32 s70, s44, 576
  s_waitcnt lgkmcnt(4)
  v_mfma_f32_32x32x16_bf16 v[192:207], a[80:83], v[8:11], v[192:207]
  ds_read_b64_tr_b16 a[72:73], v210 offset:12288
  ds_read_b64_tr_b16 a[74:75], v210 offset:12800
  buffer_load_dwordx4 v216, s[20:23], s71 offen offset:1024 lds
  v_rcp_f32 v230, v230
  v_mfma_f32_32x32x16_bf16 v[192:207], a[84:87], v[12:15], v[192:207]
  ds_read_b64_tr_b16 a[76:77], v210 offset:14336
  ds_read_b64_tr_b16 a[78:79], v210 offset:14848
  v_rcp_f32 v225, v225
  v_mul_f32 v144, v144, v176
  s_waitcnt lgkmcnt(4)
  v_mfma_f32_32x32x16_bf16 v[192:207], a[88:91], v[16:19], v[192:207]
  ds_read_b64_tr_b16 a[80:81], v210 offset:16384
  ds_read_b64_tr_b16 a[82:83], v210 offset:16896
  v_rcp_f32 v226, v226
  v_mul_f32 v160, v160, v229
  v_mul_f32 v161, v161, v230
  v_mfma_f32_32x32x16_bf16 v[192:207], a[92:95], v[20:23], v[192:207]
  ds_read_b64_tr_b16 a[84:85], v210 offset:18432
  ds_read_b64_tr_b16 a[86:87], v210 offset:18944
  buffer_load_dwordx4 v217, s[20:23], s71 offen offset:2048 lds
  v_mul_f32 v162, v162, v225
  s_waitcnt lgkmcnt(4)
  v_mfma_f32_32x32x16_bf16 v[192:207], a[72:75], v[24:27], v[192:207]
  ds_read_b64_tr_b16 a[88:89], v210 offset:20480
  ds_read_b64_tr_b16 a[90:91], v210 offset:20992
  v_mul_f32 v163, v163, v226
  v_mul_f32 v229, v164, v164
  v_mul_f32 v230, v165, v165
  v_mul_f32 v225, v166, v166
  v_mfma_f32_32x32x16_bf16 v[192:207], a[76:79], v[28:31], v[192:207]
  ds_read_b64_tr_b16 a[92:93], v210 offset:22528
  ds_read_b64_tr_b16 a[94:95], v210 offset:23040
  s_add_u32 m0, s72, 135168
  s_add_u32 s71, s75, 4423808
  v_mul_f32 v226, v167, v167
  s_waitcnt lgkmcnt(4)
  v_mfma_f32_32x32x16_bf16 v[192:207], a[80:83], v[32:35], v[192:207]
  ds_read_b64_tr_b16 a[72:73], v210 offset:24576
  ds_read_b64_tr_b16 a[74:75], v210 offset:25088
  buffer_load_dwordx4 v215, s[20:23], s71 offen offset:0 lds
  v_fmaak_f32 v229, v229, v223, 0xc0135761
  v_fmaak_f32 v230, v230, v223, 0xc0135761
  v_mfma_f32_32x32x16_bf16 v[192:207], a[84:87], v[36:39], v[192:207]
  ds_read_b64_tr_b16 a[76:77], v210 offset:26624
  ds_read_b64_tr_b16 a[78:79], v210 offset:27136
  v_fmaak_f32 v225, v225, v223, 0xc0135761
  v_fmaak_f32 v226, v226, v223, 0xc0135761
  v_mul_f32 v229, v229, v164
  s_waitcnt lgkmcnt(4)
  v_mfma_f32_32x32x16_bf16 v[192:207], a[88:91], v[40:43], v[192:207]
  ds_read_b64_tr_b16 a[80:81], v210 offset:28672
  ds_read_b64_tr_b16 a[82:83], v210 offset:29184
  v_mul_f32 v230, v230, v165
  v_mul_f32 v225, v225, v166
  v_mul_f32 v226, v226, v167
  v_mul_f32 v145, v145, v177
  v_mfma_f32_32x32x16_bf16 v[192:207], a[92:95], v[44:47], v[192:207]
  ds_read_b64_tr_b16 a[84:85], v210 offset:30720
  ds_read_b64_tr_b16 a[86:87], v210 offset:31232
  buffer_load_dwordx4 v216, s[20:23], s71 offen offset:1024 lds
  s_add_u32 s70, s70, s101
  s_waitcnt lgkmcnt(4)
  v_mfma_f32_32x32x16_bf16 v[192:207], a[72:75], v[48:51], v[192:207]
  ds_read_b64_tr_b16 a[88:89], v210 offset:32768
  ds_read_b64_tr_b16 a[90:91], v210 offset:33280
  v_exp_f32 v229, v229
  v_exp_f32 v230, v230
  v_mfma_f32_32x32x16_bf16 v[192:207], a[76:79], v[52:55], v[192:207]
  ds_read_b64_tr_b16 a[92:93], v210 offset:34816
  ds_read_b64_tr_b16 a[94:95], v210 offset:35328
  v_exp_f32 v225, v225
  s_lshl_b32 s69, s99, 6
  s_waitcnt lgkmcnt(4)
  v_mfma_f32_32x32x16_bf16 v[192:207], a[80:83], v[56:59], v[192:207]
  ds_read_b64_tr_b16 a[72:73], v210 offset:36864
  ds_read_b64_tr_b16 a[74:75], v210 offset:37376
  buffer_load_dwordx4 v217, s[20:23], s71 offen offset:2048 lds
  s_add_u32 s70, s70, s69
  v_exp_f32 v226, v226
  v_add_f32 v229, 1.0, v229
  s_add_u32 s70, s70, 256
  buffer_load_dword v249, v248, s[20:23], s70 offen
  buffer_load_dword v249, v248, s[24:27], s70 offen
  v_mfma_f32_32x32x16_bf16 v[192:207], a[84:87], v[60:63], v[192:207]
  ds_read_b64_tr_b16 a[76:77], v210 offset:38912
  ds_read_b64_tr_b16 a[78:79], v210 offset:39424
  v_add_f32 v230, 1.0, v230
  v_add_f32 v225, 1.0, v225
  v_add_f32 v226, 1.0, v226
  s_waitcnt lgkmcnt(4)
  v_mfma_f32_32x32x16_bf16 v[192:207], a[88:91], v[64:67], v[192:207]
  ds_read_b64_tr_b16 a[80:81], v210 offset:40960
  ds_read_b64_tr_b16 a[82:83], v210 offset:41472
  v_rcp_f32 v229, v229
  v_rcp_f32 v230, v230
  v_mfma_f32_32x32x16_bf16 v[192:207], a[92:95], v[68:71], v[192:207]
  s_waitcnt vmcnt(18)
  s_barrier
  ds_read_b64_tr_b16 a[84:85], v210 offset:43008
  ds_read_b64_tr_b16 a[86:87], v210 offset:43520
  s_add_u32 m0, s72, 0
  s_add_u32 s71, s75, 128
  s_waitcnt lgkmcnt(4)
  v_mfma_f32_32x32x16_bf16 v[192:207], a[72:75], v[72:75], v[192:207]
  ds_read_b64_tr_b16 a[88:89], v210 offset:45056
  ds_read_b64_tr_b16 a[90:91], v210 offset:45568
  buffer_load_dwordx4 v215, s[24:27], s71 offen offset:0 lds
  v_rcp_f32 v225, v225
  v_rcp_f32 v226, v226
  v_mfma_f32_32x32x16_bf16 v[192:207], a[76:79], v[76:79], v[192:207]
  ds_read_b64_tr_b16 a[92:93], v210 offset:47104
  ds_read_b64_tr_b16 a[94:95], v210 offset:47616
  v_mul_f32 v164, v164, v229
  v_mul_f32 v165, v165, v230
  v_mul_f32 v166, v166, v225
  v_mul_f32 v167, v167, v226
  v_mul_f32 v229, v168, v168
  s_waitcnt lgkmcnt(4)
  v_mfma_f32_32x32x16_bf16 v[192:207], a[80:83], v[80:83], v[192:207]
  ds_read_b64_tr_b16 a[72:73], v210 offset:49152
  ds_read_b64_tr_b16 a[74:75], v210 offset:49664
  v_mul_f32 v230, v169, v169
  v_mul_f32 v225, v170, v170
  v_mul_f32 v226, v171, v171
  v_fmaak_f32 v229, v229, v223, 0xc0135761
  v_fmaak_f32 v230, v230, v223, 0xc0135761
  v_mfma_f32_32x32x16_bf16 v[192:207], a[84:87], v[84:87], v[192:207]
  ds_read_b64_tr_b16 a[76:77], v210 offset:51200
  ds_read_b64_tr_b16 a[78:79], v210 offset:51712
  buffer_load_dwordx4 v216, s[24:27], s71 offen offset:1024 lds
  v_fmaak_f32 v225, v225, v223, 0xc0135761
  v_fmaak_f32 v226, v226, v223, 0xc0135761
  v_mul_f32 v229, v229, v168
  s_waitcnt lgkmcnt(4)
  v_mfma_f32_32x32x16_bf16 v[192:207], a[88:91], v[88:91], v[192:207]
  ds_read_b64_tr_b16 a[80:81], v210 offset:53248
  ds_read_b64_tr_b16 a[82:83], v210 offset:53760
  v_mul_f32 v230, v230, v169
  v_mul_f32 v225, v225, v170
  v_mul_f32 v226, v226, v171
  v_exp_f32 v229, v229
  v_mfma_f32_32x32x16_bf16 v[192:207], a[92:95], v[92:95], v[192:207]
  ds_read_b64_tr_b16 a[84:85], v210 offset:55296
  ds_read_b64_tr_b16 a[86:87], v210 offset:55808
  v_exp_f32 v230, v230
  v_cvt_pk_bf16_f32 v231, v144, v145
  s_waitcnt lgkmcnt(4)
  v_mfma_f32_32x32x16_bf16 v[192:207], a[72:75], v[96:99], v[192:207]
  ds_read_b64_tr_b16 a[88:89], v210 offset:57344
  ds_read_b64_tr_b16 a[90:91], v210 offset:57856
  buffer_load_dwordx4 v217, s[24:27], s71 offen offset:2048 lds
  v_exp_f32 v225, v225
  v_exp_f32 v226, v226
  v_mfma_f32_32x32x16_bf16 v[192:207], a[76:79], v[100:103], v[192:207]
  ds_read_b64_tr_b16 a[92:93], v210 offset:59392
  ds_read_b64_tr_b16 a[94:95], v210 offset:59904
  v_add_f32 v229, 1.0, v229
  v_add_f32 v230, 1.0, v230
  v_add_f32 v225, 1.0, v225
  s_waitcnt lgkmcnt(4)
  v_mfma_f32_32x32x16_bf16 v[192:207], a[80:83], v[104:107], v[192:207]
  ds_read_b64_tr_b16 a[72:73], v210 offset:61440
  ds_read_b64_tr_b16 a[74:75], v210 offset:61952
  s_add_u32 m0, s72, 12288
  s_add_u32 s71, s75, 884864
  v_add_f32 v226, 1.0, v226
  v_rcp_f32 v229, v229
  v_accvgpr_write_b32 a0, v231
  v_mfma_f32_32x32x16_bf16 v[192:207], a[84:87], v[108:111], v[192:207]
  ds_read_b64_tr_b16 a[76:77], v210 offset:63488
  ds_read_b64_tr_b16 a[78:79], v210 offset:64000
  buffer_load_dwordx4 v215, s[24:27], s71 offen offset:0 lds
  v_mul_f32 v146, v146, v178
  v_mul_f32 v147, v147, v179
  v_cvt_pk_bf16_f32 v232, v146, v147
  s_waitcnt lgkmcnt(4)
  v_mfma_f32_32x32x16_bf16 v[192:207], a[88:91], v[112:115], v[192:207]
  v_add_u32 v210, 65536, v212
  ds_read_b64_tr_b16 a[80:81], v210 offset:0
  ds_read_b64_tr_b16 a[82:83], v210 offset:512
  v_rcp_f32 v230, v230
  v_accvgpr_write_b32 a1, v232
  v_rcp_f32 v225, v225
  v_mfma_f32_32x32x16_bf16 v[192:207], a[92:95], v[116:119], v[192:207]
  ds_read_b64_tr_b16 a[84:85], v210 offset:2048
  ds_read_b64_tr_b16 a[86:87], v210 offset:2560
  v_mul_f32 v148, v148, v180
  v_mul_f32 v149, v149, v181
  v_cvt_pk_bf16_f32 v231, v148, v149
  v_rcp_f32 v226, v226
  s_waitcnt lgkmcnt(4)
  v_mfma_f32_32x32x16_bf16 v[192:207], a[72:75], v[120:123], v[192:207]
  ds_read_b64_tr_b16 a[88:89], v210 offset:4096
  ds_read_b64_tr_b16 a[90:91], v210 offset:4608
  buffer_load_dwordx4 v216, s[24:27], s71 offen offset:1024 lds
  v_accvgpr_write_b32 a2, v231
  v_mul_f32 v150, v150, v182
  v_mul_f32 v151, v151, v183
  v_mul_f32 v168, v168, v229
  v_mfma_f32_32x32x16_bf16 v[192:207], a[76:79], v[124:127], v[192:207]
  ds_read_b64_tr_b16 a[92:93], v210 offset:6144
  ds_read_b64_tr_b16 a[94:95], v210 offset:6656
  v_cvt_pk_bf16_f32 v232, v150, v151
  v_accvgpr_write_b32 a3, v232
  s_add_u32 s81, s60, 0
  v_mul_f32 v169, v169, v230
  v_mul_f32 v170, v170, v225
  s_waitcnt lgkmcnt(4)
  v_mfma_f32_32x32x16_bf16 v[192:207], a[80:83], v[128:131], v[192:207]
  ds_read_b64_tr_b16 a[72:73], v209 offset:8192
  ds_read_b64_tr_b16 a[74:75], v209 offset:8704
  buffer_store_dwordx4 a[0:3], v224, s[40:43], s81 offen sc1
  v_mul_f32 v152, v152, v184
  v_mul_f32 v153, v153, v185
  v_cvt_pk_bf16_f32 v231, v152, v153
  v_mul_f32 v171, v171, v226
  v_mul_f32 v229, v172, v172
  v_mfma_f32_32x32x16_bf16 v[192:207], a[84:87], v[132:135], v[192:207]
  ds_read_b64_tr_b16 a[76:77], v209 offset:10240
  ds_read_b64_tr_b16 a[78:79], v209 offset:10752
  buffer_load_dwordx4 v217, s[24:27], s71 offen offset:2048 lds
  v_accvgpr_write_b32 a4, v231
  v_mul_f32 v154, v154, v186
  v_mul_f32 v155, v155, v187
  s_waitcnt lgkmcnt(4)
  v_mfma_f32_32x32x16_bf16 v[192:207], a[88:91], v[136:139], v[192:207]
  ds_read_b64_tr_b16 a[80:81], v209 offset:12288
  ds_read_b64_tr_b16 a[82:83], v209 offset:12800
  v_cvt_pk_bf16_f32 v232, v154, v155
  v_accvgpr_write_b32 a5, v232
  v_mul_f32 v156, v156, v188
  v_mul_f32 v157, v157, v189
  v_cvt_pk_bf16_f32 v231, v156, v157
  v_mul_f32 v230, v173, v173
  v_accvgpr_write_b32 a6, v231
  v_mul_f32 v158, v158, v190
  v_mul_f32 v159, v159, v191
  v_cvt_pk_bf16_f32 v232, v158, v159
  v_accvgpr_write_b32 a7, v232
  s_add_u32 s81, s60, 1024
  buffer_store_dwordx4 a[4:7], v224, s[40:43], s81 offen sc1
  v_mfma_f32_32x32x16_bf16 v[192:207], a[92:95], v[140:143], v[192:207]
  s_waitcnt vmcnt(16)
  s_barrier
  ds_read_b64_tr_b16 a[84:85], v209 offset:14336
  ds_read_b64_tr_b16 a[86:87], v209 offset:14848
  s_add_u32 m0, s72, 24576
  s_add_u32 s71, s75, 1769600
  s_waitcnt lgkmcnt(4)
  v_mfma_f32_32x32x16_bf16 v[144:159], a[72:75], v[0:3], 0
  ds_read_b64_tr_b16 a[88:89], v209 offset:16384
  ds_read_b64_tr_b16 a[90:91], v209 offset:16896
  buffer_load_dwordx4 v215, s[24:27], s71 offen offset:0 lds
  v_mul_f32 v225, v174, v174
  v_mul_f32 v226, v175, v175
  v_fmaak_f32 v229, v229, v223, 0xc0135761
  v_fmaak_f32 v230, v230, v223, 0xc0135761
  v_mfma_f32_32x32x16_bf16 v[144:159], a[76:79], v[4:7], v[144:159]
  ds_read_b64_tr_b16 a[92:93], v209 offset:18432
  ds_read_b64_tr_b16 a[94:95], v209 offset:18944
  v_fmaak_f32 v225, v225, v223, 0xc0135761
  v_fmaak_f32 v226, v226, v223, 0xc0135761
  v_mul_f32 v229, v229, v172
  v_mul_f32 v230, v230, v173
  v_mul_f32 v225, v225, v174
  s_waitcnt lgkmcnt(4)
  v_mfma_f32_32x32x16_bf16 v[144:159], a[80:83], v[8:11], v[144:159]
  ds_read_b64_tr_b16 a[72:73], v209 offset:20480
  ds_read_b64_tr_b16 a[74:75], v209 offset:20992
  v_mul_f32 v226, v226, v175
  v_exp_f32 v229, v229
  v_exp_f32 v230, v230
  v_exp_f32 v225, v225
  v_exp_f32 v226, v226
  v_add_f32 v229, 1.0, v229
  v_add_f32 v230, 1.0, v230
  v_add_f32 v225, 1.0, v225
  v_add_f32 v226, 1.0, v226
  v_rcp_f32 v229, v229
  v_rcp_f32 v230, v230
  v_rcp_f32 v225, v225
  v_rcp_f32 v226, v226
  v_mul_f32 v172, v172, v229
  v_mul_f32 v173, v173, v230
  v_mul_f32 v174, v174, v225
  v_mul_f32 v175, v175, v226
  v_mfma_f32_32x32x16_bf16 v[144:159], a[84:87], v[12:15], v[144:159]
  ds_read_b64_tr_b16 a[76:77], v209 offset:22528
  ds_read_b64_tr_b16 a[78:79], v209 offset:23040
  buffer_load_dwordx4 v216, s[24:27], s71 offen offset:1024 lds
  v_mul_u32_u24 v214, 128, v245
  s_waitcnt lgkmcnt(4)
  v_mfma_f32_32x32x16_bf16 v[144:159], a[88:91], v[16:19], v[144:159]
  ds_read_b64_tr_b16 a[80:81], v209 offset:24576
  ds_read_b64_tr_b16 a[82:83], v209 offset:25088
  v_mul_f32 v160, v160, v192
  v_mul_f32 v161, v161, v193
  v_bfe_u32 v245, v208, 4, 1
  v_lshlrev_b32 v245, 5, v245
  v_mfma_f32_32x32x16_bf16 v[144:159], a[92:95], v[20:23], v[144:159]
  ds_read_b64_tr_b16 a[84:85], v209 offset:26624
  ds_read_b64_tr_b16 a[86:87], v209 offset:27136
  v_cvt_pk_bf16_f32 v231, v160, v161
  s_waitcnt lgkmcnt(4)
  v_mfma_f32_32x32x16_bf16 v[144:159], a[72:75], v[24:27], v[144:159]
  ds_read_b64_tr_b16 a[88:89], v209 offset:28672
  ds_read_b64_tr_b16 a[90:91], v209 offset:29184
  buffer_load_dwordx4 v217, s[24:27], s71 offen offset:2048 lds
  v_accvgpr_write_b32 a8, v231
  v_mfma_f32_32x32x16_bf16 v[144:159], a[76:79], v[28:31], v[144:159]
  ds_read_b64_tr_b16 a[92:93], v209 offset:30720
  ds_read_b64_tr_b16 a[94:95], v209 offset:31232
  v_mul_f32 v162, v162, v194
  s_waitcnt lgkmcnt(4)
  v_mfma_f32_32x32x16_bf16 v[144:159], a[80:83], v[32:35], v[144:159]
  ds_read_b64_tr_b16 a[72:73], v209 offset:32768
  ds_read_b64_tr_b16 a[74:75], v209 offset:33280
  s_add_u32 m0, s72, 36864
  s_add_u32 s71, s75, 2654336
  v_mul_f32 v163, v163, v195
  v_mfma_f32_32x32x16_bf16 v[144:159], a[84:87], v[36:39], v[144:159]
  ds_read_b64_tr_b16 a[76:77], v209 offset:34816
  ds_read_b64_tr_b16 a[78:79], v209 offset:35328
  buffer_load_dwordx4 v215, s[24:27], s71 offen offset:0 lds
  v_cvt_pk_bf16_f32 v232, v162, v163
  s_waitcnt lgkmcnt(4)
  v_mfma_f32_32x32x16_bf16 v[144:159], a[88:91], v[40:43], v[144:159]
  ds_read_b64_tr_b16 a[80:81], v209 offset:36864
  ds_read_b64_tr_b16 a[82:83], v209 offset:37376
  v_accvgpr_write_b32 a9, v232
  v_mul_f32 v164, v164, v196
  v_mfma_f32_32x32x16_bf16 v[144:159], a[92:95], v[44:47], v[144:159]
  ds_read_b64_tr_b16 a[84:85], v209 offset:38912
  ds_read_b64_tr_b16 a[86:87], v209 offset:39424
  v_mul_f32 v165, v165, v197
  s_waitcnt lgkmcnt(4)
  v_mfma_f32_32x32x16_bf16 v[144:159], a[72:75], v[48:51], v[144:159]
  ds_read_b64_tr_b16 a[88:89], v209 offset:40960
  ds_read_b64_tr_b16 a[90:91], v209 offset:41472
  buffer_load_dwordx4 v216, s[24:27], s71 offen offset:1024 lds
  v_cvt_pk_bf16_f32 v231, v164, v165
  v_mfma_f32_32x32x16_bf16 v[144:159], a[76:79], v[52:55], v[144:159]
  ds_read_b64_tr_b16 a[92:93], v209 offset:43008
  ds_read_b64_tr_b16 a[94:95], v209 offset:43520
  v_accvgpr_write_b32 a10, v231
  s_waitcnt lgkmcnt(4)
  v_mfma_f32_32x32x16_bf16 v[144:159], a[80:83], v[56:59], v[144:159]
  ds_read_b64_tr_b16 a[72:73], v209 offset:45056
  ds_read_b64_tr_b16 a[74:75], v209 offset:45568
  v_mul_f32 v166, v166, v198
  v_mul_f32 v167, v167, v199
  v_mfma_f32_32x32x16_bf16 v[144:159], a[84:87], v[60:63], v[144:159]
  ds_read_b64_tr_b16 a[76:77], v209 offset:47104
  ds_read_b64_tr_b16 a[78:79], v209 offset:47616
  buffer_load_dwordx4 v217, s[24:27], s71 offen offset:2048 lds
  v_cvt_pk_bf16_f32 v232, v166, v167
  s_waitcnt lgkmcnt(4)
  v_mfma_f32_32x32x16_bf16 v[144:159], a[88:91], v[64:67], v[144:159]
  ds_read_b64_tr_b16 a[80:81], v209 offset:49152
  ds_read_b64_tr_b16 a[82:83], v209 offset:49664
  v_accvgpr_write_b32 a11, v232
  v_mfma_f32_32x32x16_bf16 v[144:159], a[92:95], v[68:71], v[144:159]
  s_waitcnt vmcnt(16)
  s_barrier
  ds_read_b64_tr_b16 a[84:85], v209 offset:51200
  ds_read_b64_tr_b16 a[86:87], v209 offset:51712
  s_add_u32 m0, s72, 49152
  s_add_u32 s71, s75, 3539072
  s_waitcnt lgkmcnt(4)
  v_mfma_f32_32x32x16_bf16 v[144:159], a[72:75], v[72:75], v[144:159]
  ds_read_b64_tr_b16 a[88:89], v209 offset:53248
  ds_read_b64_tr_b16 a[90:91], v209 offset:53760
  buffer_load_dwordx4 v215, s[24:27], s71 offen offset:0 lds
  s_add_u32 s81, s60, 2048
  buffer_store_dwordx4 a[8:11], v224, s[40:43], s81 offen sc1
  v_mfma_f32_32x32x16_bf16 v[144:159], a[76:79], v[76:79], v[144:159]
  ds_read_b64_tr_b16 a[92:93], v209 offset:55296
  ds_read_b64_tr_b16 a[94:95], v209 offset:55808
  v_mul_f32 v168, v168, v200
  v_mul_f32 v169, v169, v201
  s_waitcnt lgkmcnt(4)
  v_mfma_f32_32x32x16_bf16 v[144:159], a[80:83], v[80:83], v[144:159]
  ds_read_b64_tr_b16 a[72:73], v209 offset:57344
  ds_read_b64_tr_b16 a[74:75], v209 offset:57856
  v_cvt_pk_bf16_f32 v231, v168, v169
  v_and_b32 v246, 3, v208
  v_mfma_f32_32x32x16_bf16 v[144:159], a[84:87], v[84:87], v[144:159]
  ds_read_b64_tr_b16 a[76:77], v209 offset:59392
  ds_read_b64_tr_b16 a[78:79], v209 offset:59904
  buffer_load_dwordx4 v216, s[24:27], s71 offen offset:1024 lds
  v_accvgpr_write_b32 a12, v231
  s_waitcnt lgkmcnt(4)
  v_mfma_f32_32x32x16_bf16 v[144:159], a[88:91], v[88:91], v[144:159]
  ds_read_b64_tr_b16 a[80:81], v209 offset:61440
  ds_read_b64_tr_b16 a[82:83], v209 offset:61952
  v_mul_f32 v170, v170, v202
  v_mfma_f32_32x32x16_bf16 v[144:159], a[92:95], v[92:95], v[144:159]
  ds_read_b64_tr_b16 a[84:85], v209 offset:63488
  ds_read_b64_tr_b16 a[86:87], v209 offset:64000
  v_mul_f32 v171, v171, v203
  s_waitcnt lgkmcnt(4)
  v_mfma_f32_32x32x16_bf16 v[144:159], a[72:75], v[96:99], v[144:159]
  v_add_u32 v209, 131072, v211
  ds_read_b64_tr_b16 a[88:89], v209 offset:0
  ds_read_b64_tr_b16 a[90:91], v209 offset:512
  buffer_load_dwordx4 v217, s[24:27], s71 offen offset:2048 lds
  v_cvt_pk_bf16_f32 v232, v170, v171
  v_mfma_f32_32x32x16_bf16 v[144:159], a[76:79], v[100:103], v[144:159]
  ds_read_b64_tr_b16 a[92:93], v209 offset:2048
  ds_read_b64_tr_b16 a[94:95], v209 offset:2560
  v_accvgpr_write_b32 a13, v232
  v_mul_f32 v172, v172, v204
  s_waitcnt lgkmcnt(4)
  v_mfma_f32_32x32x16_bf16 v[144:159], a[80:83], v[104:107], v[144:159]
  ds_read_b64_tr_b16 a[72:73], v209 offset:4096
  ds_read_b64_tr_b16 a[74:75], v209 offset:4608
  s_add_u32 m0, s72, 61440
  s_add_u32 s71, s75, 4423808
  v_mul_f32 v173, v173, v205
  v_mfma_f32_32x32x16_bf16 v[144:159], a[84:87], v[108:111], v[144:159]
  ds_read_b64_tr_b16 a[76:77], v209 offset:6144
  ds_read_b64_tr_b16 a[78:79], v209 offset:6656
  buffer_load_dwordx4 v215, s[24:27], s71 offen offset:0 lds
  v_cvt_pk_bf16_f32 v231, v172, v173
  s_waitcnt lgkmcnt(4)
  v_mfma_f32_32x32x16_bf16 v[144:159], a[88:91], v[112:115], v[144:159]
  ds_read_b64_tr_b16 a[80:81], v209 offset:8192
  ds_read_b64_tr_b16 a[82:83], v209 offset:8704
  v_accvgpr_write_b32 a14, v231
  v_mfma_f32_32x32x16_bf16 v[144:159], a[92:95], v[116:119], v[144:159]
  ds_read_b64_tr_b16 a[84:85], v209 offset:10240
  ds_read_b64_tr_b16 a[86:87], v209 offset:10752
  v_mul_f32 v174, v174, v206
  v_mul_f32 v175, v175, v207
  s_waitcnt lgkmcnt(4)
  v_mfma_f32_32x32x16_bf16 v[144:159], a[72:75], v[120:123], v[144:159]
  ds_read_b64_tr_b16 a[88:89], v209 offset:12288
  ds_read_b64_tr_b16 a[90:91], v209 offset:12800
  buffer_load_dwordx4 v216, s[24:27], s71 offen offset:1024 lds
  v_cvt_pk_bf16_f32 v232, v174, v175
  s_lshl_b32 s70, s46, 6
  v_mfma_f32_32x32x16_bf16 v[144:159], a[76:79], v[124:127], v[144:159]
  ds_read_b64_tr_b16 a[92:93], v209 offset:14336
  ds_read_b64_tr_b16 a[94:95], v209 offset:14848
  v_accvgpr_write_b32 a15, v232
  v_add_u32 v233, s70, v208
  s_waitcnt lgkmcnt(4)
  v_mfma_f32_32x32x16_bf16 v[144:159], a[80:83], v[128:131], v[144:159]
  ds_read_b64_tr_b16 a[72:73], v210 offset:8192
  ds_read_b64_tr_b16 a[74:75], v210 offset:8704
  s_add_u32 s81, s60, 3072
  v_mfma_f32_32x32x16_bf16 v[144:159], a[84:87], v[132:135], v[144:159]
  ds_read_b64_tr_b16 a[76:77], v210 offset:10240
  ds_read_b64_tr_b16 a[78:79], v210 offset:10752
  buffer_load_dwordx4 v217, s[24:27], s71 offen offset:2048 lds
  buffer_store_dwordx4 a[12:15], v224, s[40:43], s81 offen sc1
  s_waitcnt lgkmcnt(4)
  v_mfma_f32_32x32x16_bf16 v[144:159], a[88:91], v[136:139], v[144:159]
  ds_read_b64_tr_b16 a[80:81], v210 offset:12288
  ds_read_b64_tr_b16 a[82:83], v210 offset:12800
  v_mul_u32_u24 v234, 57, v233
  v_lshrrev_b32 v234, 9, v234
  v_mfma_f32_32x32x16_bf16 v[144:159], a[92:95], v[140:143], v[144:159]
  ds_read_b64_tr_b16 a[84:85], v210 offset:14336
  ds_read_b64_tr_b16 a[86:87], v210 offset:14848
  v_lshl_add_u32 v245, v246, 3, v245
  s_waitcnt lgkmcnt(4)
  v_mfma_f32_32x32x16_bf16 v[160:175], a[72:75], v[0:3], 0
  ds_read_b64_tr_b16 a[88:89], v210 offset:16384
  ds_read_b64_tr_b16 a[90:91], v210 offset:16896
  v_mul_u32_u24 v235, 9, v234
  v_mfma_f32_32x32x16_bf16 v[160:175], a[76:79], v[4:7], v[160:175]
  ds_read_b64_tr_b16 a[92:93], v210 offset:18432
  ds_read_b64_tr_b16 a[94:95], v210 offset:18944
  v_sub_u32 v235, v233, v235
  s_waitcnt lgkmcnt(4)
  v_mfma_f32_32x32x16_bf16 v[160:175], a[80:83], v[8:11], v[160:175]
  ds_read_b64_tr_b16 a[72:73], v210 offset:20480
  ds_read_b64_tr_b16 a[74:75], v210 offset:20992
  v_mfma_f32_32x32x16_bf16 v[160:175], a[84:87], v[12:15], v[160:175]
  ds_read_b64_tr_b16 a[76:77], v210 offset:22528
  ds_read_b64_tr_b16 a[78:79], v210 offset:23040
  v_mul_f32 v229, v144, v144
  v_mul_f32 v230, v145, v145
  v_mul_f32 v225, v146, v146
  s_waitcnt lgkmcnt(4)
  v_mfma_f32_32x32x16_bf16 v[160:175], a[88:91], v[16:19], v[160:175]
  ds_read_b64_tr_b16 a[80:81], v210 offset:24576
  ds_read_b64_tr_b16 a[82:83], v210 offset:25088
  v_mul_f32 v226, v147, v147
  v_fmaak_f32 v229, v229, v223, 0xc0135761
  v_fmaak_f32 v230, v230, v223, 0xc0135761
  v_min_u32 v234, 17, v234
  v_mfma_f32_32x32x16_bf16 v[160:175], a[92:95], v[20:23], v[160:175]
  ds_read_b64_tr_b16 a[84:85], v210 offset:26624
  ds_read_b64_tr_b16 a[86:87], v210 offset:27136
  v_fmaak_f32 v225, v225, v223, 0xc0135761
  v_fmaak_f32 v226, v226, v223, 0xc0135761
  v_mul_u32_u24 v234, 1152, v234
  s_waitcnt lgkmcnt(4)
  v_mfma_f32_32x32x16_bf16 v[160:175], a[72:75], v[24:27], v[160:175]
  ds_read_b64_tr_b16 a[88:89], v210 offset:28672
  ds_read_b64_tr_b16 a[90:91], v210 offset:29184
  v_mul_f32 v229, v229, v144
  v_mul_f32 v230, v230, v145
  v_mul_f32 v225, v225, v146
  v_lshl_add_u32 v234, v235, 7, v234
  v_mfma_f32_32x32x16_bf16 v[160:175], a[76:79], v[28:31], v[160:175]
  ds_read_b64_tr_b16 a[92:93], v210 offset:30720
  ds_read_b64_tr_b16 a[94:95], v210 offset:31232
  v_mul_f32 v226, v226, v147
  v_exp_f32 v229, v229
  s_waitcnt lgkmcnt(4)
  v_mfma_f32_32x32x16_bf16 v[160:175], a[80:83], v[32:35], v[160:175]
  ds_read_b64_tr_b16 a[72:73], v210 offset:32768
  ds_read_b64_tr_b16 a[74:75], v210 offset:33280
  v_exp_f32 v230, v230
  s_mul_i32 s70, s44, 288
  v_mfma_f32_32x32x16_bf16 v[160:175], a[84:87], v[36:39], v[160:175]
  ds_read_b64_tr_b16 a[76:77], v210 offset:34816
  ds_read_b64_tr_b16 a[78:79], v210 offset:35328
  v_exp_f32 v225, v225
  s_mul_i32 s69, s100, 18
  s_waitcnt lgkmcnt(4)
  v_mfma_f32_32x32x16_bf16 v[160:175], a[88:91], v[40:43], v[160:175]
  ds_read_b64_tr_b16 a[80:81], v210 offset:36864
  ds_read_b64_tr_b16 a[82:83], v210 offset:37376
  v_exp_f32 v226, v226
  v_add_f32 v229, 1.0, v229
  v_mfma_f32_32x32x16_bf16 v[160:175], a[92:95], v[44:47], v[160:175]
  ds_read_b64_tr_b16 a[84:85], v210 offset:38912
  ds_read_b64_tr_b16 a[86:87], v210 offset:39424
  v_add_f32 v230, 1.0, v230
  v_add_f32 v225, 1.0, v225
  s_add_u32 s70, s70, s69
  s_waitcnt lgkmcnt(4)
  v_mfma_f32_32x32x16_bf16 v[160:175], a[72:75], v[48:51], v[160:175]
  ds_read_b64_tr_b16 a[88:89], v210 offset:40960
  ds_read_b64_tr_b16 a[90:91], v210 offset:41472
  v_add_f32 v226, 1.0, v226
  v_rcp_f32 v229, v229
  s_mul_i32 s70, s70, 1152
  v_mfma_f32_32x32x16_bf16 v[160:175], a[76:79], v[52:55], v[160:175]
  ds_read_b64_tr_b16 a[92:93], v210 offset:43008
  ds_read_b64_tr_b16 a[94:95], v210 offset:43520
  v_rcp_f32 v230, v230
  s_waitcnt lgkmcnt(4)
  v_mfma_f32_32x32x16_bf16 v[160:175], a[80:83], v[56:59], v[160:175]
  ds_read_b64_tr_b16 a[72:73], v210 offset:45056
  ds_read_b64_tr_b16 a[74:75], v210 offset:45568
  v_rcp_f32 v225, v225
  v_rcp_f32 v226, v226
  v_mfma_f32_32x32x16_bf16 v[160:175], a[84:87], v[60:63], v[160:175]
  ds_read_b64_tr_b16 a[76:77], v210 offset:47104
  ds_read_b64_tr_b16 a[78:79], v210 offset:47616
  v_mul_f32 v144, v144, v229
  buffer_load_dword v249, v234, s[28:31], s70 offen
  v_bfe_u32 v246, v208, 3, 1
  s_waitcnt lgkmcnt(4)
  v_mfma_f32_32x32x16_bf16 v[160:175], a[88:91], v[64:67], v[160:175]
  ds_read_b64_tr_b16 a[80:81], v210 offset:49152
  ds_read_b64_tr_b16 a[82:83], v210 offset:49664
  v_mul_f32 v145, v145, v230
  v_mul_f32 v146, v146, v225
  v_mul_f32 v147, v147, v226
  v_mfma_f32_32x32x16_bf16 v[160:175], a[92:95], v[68:71], v[160:175]
  s_waitcnt vmcnt(20)
  s_barrier
  ds_read_b64_tr_b16 a[84:85], v210 offset:51200
  ds_read_b64_tr_b16 a[86:87], v210 offset:51712
  s_add_u32 m0, s72, 73728
  s_add_u32 s71, s75, 256
  s_waitcnt lgkmcnt(4)
  v_mfma_f32_32x32x16_bf16 v[160:175], a[72:75], v[72:75], v[160:175]
  ds_read_b64_tr_b16 a[88:89], v210 offset:53248
  ds_read_b64_tr_b16 a[90:91], v210 offset:53760
  buffer_load_dwordx4 v215, s[20:23], s71 offen offset:0 lds
  v_mul_f32 v229, v148, v148
  v_mul_f32 v230, v149, v149
  v_mfma_f32_32x32x16_bf16 v[160:175], a[76:79], v[76:79], v[160:175]
  ds_read_b64_tr_b16 a[92:93], v210 offset:55296
  ds_read_b64_tr_b16 a[94:95], v210 offset:55808
  v_mul_f32 v225, v150, v150
  v_mul_f32 v226, v151, v151
  v_fmaak_f32 v229, v229, v223, 0xc0135761
  s_waitcnt lgkmcnt(4)
  v_mfma_f32_32x32x16_bf16 v[160:175], a[80:83], v[80:83], v[160:175]
  ds_read_b64_tr_b16 a[72:73], v210 offset:57344
  ds_read_b64_tr_b16 a[74:75], v210 offset:57856
  v_fmaak_f32 v230, v230, v223, 0xc0135761
  v_fmaak_f32 v225, v225, v223, 0xc0135761
  v_fmaak_f32 v226, v226, v223, 0xc0135761
  v_mul_f32 v229, v229, v148
  v_mfma_f32_32x32x16_bf16 v[160:175], a[84:87], v[84:87], v[160:175]
  ds_read_b64_tr_b16 a[76:77], v210 offset:59392
  ds_read_b64_tr_b16 a[78:79], v210 offset:59904
  buffer_load_dwordx4 v216, s[20:23], s71 offen offset:1024 lds
  v_mul_f32 v230, v230, v149
  s_waitcnt lgkmcnt(4)
  v_mfma_f32_32x32x16_bf16 v[160:175], a[88:91], v[88:91], v[160:175]
  ds_read_b64_tr_b16 a[80:81], v210 offset:61440
  ds_read_b64_tr_b16 a[82:83], v210 offset:61952
  v_mul_f32 v225, v225, v150
  v_mul_f32 v226, v226, v151
  v_exp_f32 v229, v229
  v_mfma_f32_32x32x16_bf16 v[160:175], a[92:95], v[92:95], v[160:175]
  ds_read_b64_tr_b16 a[84:85], v210 offset:63488
  ds_read_b64_tr_b16 a[86:87], v210 offset:64000
  v_exp_f32 v230, v230
  s_waitcnt lgkmcnt(4)
  v_mfma_f32_32x32x16_bf16 v[160:175], a[72:75], v[96:99], v[160:175]
  v_add_u32 v210, 131072, v212
  ds_read_b64_tr_b16 a[88:89], v210 offset:0
  ds_read_b64_tr_b16 a[90:91], v210 offset:512
  buffer_load_dwordx4 v217, s[20:23], s71 offen offset:2048 lds
  v_mfma_f32_32x32x16_bf16 v[160:175], a[76:79], v[100:103], v[160:175]
  ds_read_b64_tr_b16 a[92:93], v210 offset:2048
  ds_read_b64_tr_b16 a[94:95], v210 offset:2560
  v_exp_f32 v225, v225
  s_waitcnt lgkmcnt(4)
  v_mfma_f32_32x32x16_bf16 v[160:175], a[80:83], v[104:107], v[160:175]
  ds_read_b64_tr_b16 a[72:73], v210 offset:4096
  ds_read_b64_tr_b16 a[74:75], v210 offset:4608
  s_add_u32 m0, s72, 86016
  s_add_u32 s71, s75, 884992
  buffer_load_dword v251, v254, s[36:39], 0 offen sc1
  v_mfma_f32_32x32x16_bf16 v[160:175], a[84:87], v[108:111], v[160:175]
  ds_read_b64_tr_b16 a[76:77], v210 offset:6144
  ds_read_b64_tr_b16 a[78:79], v210 offset:6656
  buffer_load_dwordx4 v215, s[20:23], s71 offen offset:0 lds
  s_waitcnt lgkmcnt(4)
  v_mfma_f32_32x32x16_bf16 v[160:175], a[88:91], v[112:115], v[160:175]
  ds_read_b64_tr_b16 a[80:81], v210 offset:8192
  ds_read_b64_tr_b16 a[82:83], v210 offset:8704
  v_exp_f32 v226, v226
  v_add_f32 v229, 1.0, v229
  v_add_f32 v230, 1.0, v230
  v_mfma_f32_32x32x16_bf16 v[160:175], a[92:95], v[116:119], v[160:175]
  ds_read_b64_tr_b16 a[84:85], v210 offset:10240
  ds_read_b64_tr_b16 a[86:87], v210 offset:10752
  v_add_f32 v225, 1.0, v225
  v_add_f32 v226, 1.0, v226
  s_waitcnt lgkmcnt(4)
  v_mfma_f32_32x32x16_bf16 v[160:175], a[72:75], v[120:123], v[160:175]
  ds_read_b64_tr_b16 a[88:89], v210 offset:12288
  ds_read_b64_tr_b16 a[90:91], v210 offset:12800
  buffer_load_dwordx4 v216, s[20:23], s71 offen offset:1024 lds
  v_rcp_f32 v229, v229
  v_mfma_f32_32x32x16_bf16 v[160:175], a[76:79], v[124:127], v[160:175]
  ds_read_b64_tr_b16 a[92:93], v210 offset:14336
  ds_read_b64_tr_b16 a[94:95], v210 offset:14848
  v_rcp_f32 v230, v230
  v_lshlrev_b32 v246, 6, v246
  s_waitcnt lgkmcnt(4)
  v_mfma_f32_32x32x16_bf16 v[160:175], a[80:83], v[128:131], v[160:175]
  v_mov_b32 v209, v211
  ds_read_b64_tr_b16 a[72:73], v209 offset:0
  ds_read_b64_tr_b16 a[74:75], v209 offset:512
  v_rcp_f32 v225, v225
  v_mfma_f32_32x32x16_bf16 v[160:175], a[84:87], v[132:135], v[160:175]
  ds_read_b64_tr_b16 a[76:77], v209 offset:2048
  ds_read_b64_tr_b16 a[78:79], v209 offset:2560
  buffer_load_dwordx4 v217, s[20:23], s71 offen offset:2048 lds
  s_waitcnt lgkmcnt(4)
  v_mfma_f32_32x32x16_bf16 v[160:175], a[88:91], v[136:139], v[160:175]
  ds_read_b64_tr_b16 a[80:81], v209 offset:4096
  ds_read_b64_tr_b16 a[82:83], v209 offset:4608
  v_rcp_f32 v226, v226
  v_mul_f32 v148, v148, v229
  v_mul_f32 v149, v149, v230
  v_mfma_f32_32x32x16_bf16 v[160:175], a[92:95], v[140:143], v[160:175]
  s_waitcnt vmcnt(16)
  s_barrier
  ds_read_b64_tr_b16 a[84:85], v209 offset:6144
  ds_read_b64_tr_b16 a[86:87], v209 offset:6656
  s_add_u32 m0, s72, 98304
  s_add_u32 s71, s75, 1769728
  s_waitcnt lgkmcnt(4)
  v_mfma_f32_32x32x16_bf16 v[176:191], a[72:75], v[0:3], 0
  ds_read_b64_tr_b16 a[88:89], v209 offset:8192
  ds_read_b64_tr_b16 a[90:91], v209 offset:8704
  buffer_load_dwordx4 v215, s[20:23], s71 offen offset:0 lds
  v_mul_f32 v150, v150, v225
  v_mul_f32 v151, v151, v226
  v_mfma_f32_32x32x16_bf16 v[176:191], a[76:79], v[4:7], v[176:191]
  ds_read_b64_tr_b16 a[92:93], v209 offset:10240
  ds_read_b64_tr_b16 a[94:95], v209 offset:10752
  v_mul_f32 v229, v152, v152
  v_mul_f32 v230, v153, v153
  v_mul_f32 v225, v154, v154
  s_waitcnt lgkmcnt(4)
  v_mfma_f32_32x32x16_bf16 v[176:191], a[80:83], v[8:11], v[176:191]
  ds_read_b64_tr_b16 a[72:73], v209 offset:12288
  ds_read_b64_tr_b16 a[74:75], v209 offset:12800
  v_mul_f32 v226, v155, v155
  v_fmaak_f32 v229, v229, v223, 0xc0135761
  v_fmaak_f32 v230, v230, v223, 0xc0135761
  v_fmaak_f32 v225, v225, v223, 0xc0135761
  v_mfma_f32_32x32x16_bf16 v[176:191], a[84:87], v[12:15], v[176:191]
  ds_read_b64_tr_b16 a[76:77], v209 offset:14336
  ds_read_b64_tr_b16 a[78:79], v209 offset:14848
  buffer_load_dwordx4 v216, s[20:23], s71 offen offset:1024 lds
  v_fmaak_f32 v226, v226, v223, 0xc0135761
  s_waitcnt lgkmcnt(4)
  v_mfma_f32_32x32x16_bf16 v[176:191], a[88:91], v[16:19], v[176:191]
  ds_read_b64_tr_b16 a[80:81], v209 offset:16384
  ds_read_b64_tr_b16 a[82:83], v209 offset:16896
  v_mul_f32 v229, v229, v152
  v_mul_f32 v230, v230, v153
  v_mul_f32 v225, v225, v154
  v_mul_f32 v226, v226, v155
  v_mfma_f32_32x32x16_bf16 v[176:191], a[92:95], v[20:23], v[176:191]
  ds_read_b64_tr_b16 a[84:85], v209 offset:18432
  ds_read_b64_tr_b16 a[86:87], v209 offset:18944
  v_exp_f32 v229, v229
  s_waitcnt lgkmcnt(4)
  v_mfma_f32_32x32x16_bf16 v[176:191], a[72:75], v[24:27], v[176:191]
  ds_read_b64_tr_b16 a[88:89], v209 offset:20480
  ds_read_b64_tr_b16 a[90:91], v209 offset:20992
  buffer_load_dwordx4 v217, s[20:23], s71 offen offset:2048 lds
  v_exp_f32 v230, v230
  v_mfma_f32_32x32x16_bf16 v[176:191], a[76:79], v[28:31], v[176:191]
  ds_read_b64_tr_b16 a[92:93], v209 offset:22528
  ds_read_b64_tr_b16 a[94:95], v209 offset:23040
  v_exp_f32 v225, v225
  s_waitcnt lgkmcnt(4)
  v_mfma_f32_32x32x16_bf16 v[176:191], a[80:83], v[32:35], v[176:191]
  ds_read_b64_tr_b16 a[72:73], v209 offset:24576
  ds_read_b64_tr_b16 a[74:75], v209 offset:25088
  s_add_u32 m0, s72, 110592
  s_add_u32 s71, s75, 2654464
  v_exp_f32 v226, v226
  v_mfma_f32_32x32x16_bf16 v[176:191], a[84:87], v[36:39], v[176:191]
  ds_read_b64_tr_b16 a[76:77], v209 offset:26624
  ds_read_b64_tr_b16 a[78:79], v209 offset:27136
  buffer_load_dwordx4 v215, s[20:23], s71 offen offset:0 lds
  v_add_f32 v229, 1.0, v229
  s_waitcnt lgkmcnt(4)
  v_mfma_f32_32x32x16_bf16 v[176:191], a[88:91], v[40:43], v[176:191]
  ds_read_b64_tr_b16 a[80:81], v209 offset:28672
  ds_read_b64_tr_b16 a[82:83], v209 offset:29184
  v_add_f32 v230, 1.0, v230
  v_add_f32 v225, 1.0, v225
  v_add_f32 v226, 1.0, v226
  v_xor_b32 v245, v245, v246
  v_mfma_f32_32x32x16_bf16 v[176:191], a[92:95], v[44:47], v[176:191]
  ds_read_b64_tr_b16 a[84:85], v209 offset:30720
  ds_read_b64_tr_b16 a[86:87], v209 offset:31232
  v_rcp_f32 v229, v229
  v_rcp_f32 v230, v230
  s_waitcnt lgkmcnt(4)
  v_mfma_f32_32x32x16_bf16 v[176:191], a[72:75], v[48:51], v[176:191]
  ds_read_b64_tr_b16 a[88:89], v209 offset:32768
  ds_read_b64_tr_b16 a[90:91], v209 offset:33280
  buffer_load_dwordx4 v216, s[20:23], s71 offen offset:1024 lds
  v_rcp_f32 v225, v225
  v_mfma_f32_32x32x16_bf16 v[176:191], a[76:79], v[52:55], v[176:191]
  ds_read_b64_tr_b16 a[92:93], v209 offset:34816
  ds_read_b64_tr_b16 a[94:95], v209 offset:35328
  v_rcp_f32 v226, v226
  v_mul_f32 v152, v152, v229
  v_mul_f32 v153, v153, v230
  s_waitcnt lgkmcnt(4)
  v_mfma_f32_32x32x16_bf16 v[176:191], a[80:83], v[56:59], v[176:191]
  ds_read_b64_tr_b16 a[72:73], v209 offset:36864
  ds_read_b64_tr_b16 a[74:75], v209 offset:37376
  v_mul_f32 v154, v154, v225
  v_mul_f32 v155, v155, v226
  v_mul_f32 v229, v156, v156
  v_mul_f32 v230, v157, v157
  v_mfma_f32_32x32x16_bf16 v[176:191], a[84:87], v[60:63], v[176:191]
  ds_read_b64_tr_b16 a[76:77], v209 offset:38912
  ds_read_b64_tr_b16 a[78:79], v209 offset:39424
  buffer_load_dwordx4 v217, s[20:23], s71 offen offset:2048 lds
  v_mul_f32 v225, v158, v158
  v_mul_f32 v226, v159, v159
  v_fmaak_f32 v229, v229, v223, 0xc0135761
  s_waitcnt lgkmcnt(4)
  v_mfma_f32_32x32x16_bf16 v[176:191], a[88:91], v[64:67], v[176:191]
  ds_read_b64_tr_b16 a[80:81], v209 offset:40960
  ds_read_b64_tr_b16 a[82:83], v209 offset:41472
  v_fmaak_f32 v230, v230, v223, 0xc0135761
  v_fmaak_f32 v225, v225, v223, 0xc0135761
  v_fmaak_f32 v226, v226, v223, 0xc0135761
  v_mul_f32 v229, v229, v156
  v_mfma_f32_32x32x16_bf16 v[176:191], a[92:95], v[68:71], v[176:191]
  s_waitcnt vmcnt(15)
  s_barrier
  ds_read_b64_tr_b16 a[84:85], v209 offset:43008
  ds_read_b64_tr_b16 a[86:87], v209 offset:43520
  s_add_u32 m0, s72, 122880
  s_add_u32 s71, s75, 3539200
  s_waitcnt lgkmcnt(4)
  v_mfma_f32_32x32x16_bf16 v[176:191], a[72:75], v[72:75], v[176:191]
  ds_read_b64_tr_b16 a[88:89], v209 offset:45056
  ds_read_b64_tr_b16 a[90:91], v209 offset:45568
  buffer_load_dwordx4 v215, s[20:23], s71 offen offset:0 lds
  v_mul_f32 v230, v230, v157
  v_mul_f32 v225, v225, v158
  v_mul_f32 v226, v226, v159
  v_mfma_f32_32x32x16_bf16 v[176:191], a[76:79], v[76:79], v[176:191]
  ds_read_b64_tr_b16 a[92:93], v209 offset:47104
  ds_read_b64_tr_b16 a[94:95], v209 offset:47616
  v_exp_f32 v229, v229
  v_exp_f32 v230, v230
  s_waitcnt lgkmcnt(4)
  v_mfma_f32_32x32x16_bf16 v[176:191], a[80:83], v[80:83], v[176:191]
  ds_read_b64_tr_b16 a[72:73], v209 offset:49152
  ds_read_b64_tr_b16 a[74:75], v209 offset:49664
  v_exp_f32 v225, v225
  v_exp_f32 v226, v226
  v_add_f32 v229, 1.0, v229
  v_add_f32 v230, 1.0, v230
  v_mfma_f32_32x32x16_bf16 v[176:191], a[84:87], v[84:87], v[176:191]
  ds_read_b64_tr_b16 a[76:77], v209 offset:51200
  ds_read_b64_tr_b16 a[78:79], v209 offset:51712
  buffer_load_dwordx4 v216, s[20:23], s71 offen offset:1024 lds
  v_add_f32 v225, 1.0, v225
  v_add_f32 v226, 1.0, v226
  s_waitcnt lgkmcnt(4)
  v_mfma_f32_32x32x16_bf16 v[176:191], a[88:91], v[88:91], v[176:191]
  ds_read_b64_tr_b16 a[80:81], v209 offset:53248
  ds_read_b64_tr_b16 a[82:83], v209 offset:53760
  v_rcp_f32 v229, v229
  v_rcp_f32 v230, v230
  v_rcp_f32 v225, v225
  v_mfma_f32_32x32x16_bf16 v[176:191], a[92:95], v[92:95], v[176:191]
  ds_read_b64_tr_b16 a[84:85], v209 offset:55296
  ds_read_b64_tr_b16 a[86:87], v209 offset:55808
  v_rcp_f32 v226, v226
  v_mul_f32 v156, v156, v229
  v_mul_f32 v157, v157, v230
  v_mul_f32 v158, v158, v225
  v_mul_f32 v159, v159, v226
  s_waitcnt lgkmcnt(4)
  v_mfma_f32_32x32x16_bf16 v[176:191], a[72:75], v[96:99], v[176:191]
  ds_read_b64_tr_b16 a[88:89], v209 offset:57344
  ds_read_b64_tr_b16 a[90:91], v209 offset:57856
  buffer_load_dwordx4 v217, s[20:23], s71 offen offset:2048 lds
  v_add_u32 v214, v214, v245
  v_lshrrev_b32 v245, 2, v208
  v_mfma_f32_32x32x16_bf16 v[176:191], a[76:79], v[100:103], v[176:191]
  ds_read_b64_tr_b16 a[92:93], v209 offset:59392
  ds_read_b64_tr_b16 a[94:95], v209 offset:59904
  v_mul_f32 v229, v160, v160
  v_mul_f32 v230, v161, v161
  v_mul_f32 v225, v162, v162
  s_waitcnt lgkmcnt(4)
  v_mfma_f32_32x32x16_bf16 v[176:191], a[80:83], v[104:107], v[176:191]
  ds_read_b64_tr_b16 a[72:73], v209 offset:61440
  ds_read_b64_tr_b16 a[74:75], v209 offset:61952
  s_add_u32 m0, s72, 135168
  s_add_u32 s71, s75, 4423936
  v_mul_f32 v226, v163, v163
  v_fmaak_f32 v229, v229, v223, 0xc0135761
  v_mfma_f32_32x32x16_bf16 v[176:191], a[84:87], v[108:111], v[176:191]
  ds_read_b64_tr_b16 a[76:77], v209 offset:63488
  ds_read_b64_tr_b16 a[78:79], v209 offset:64000
  buffer_load_dwordx4 v215, s[20:23], s71 offen offset:0 lds
  v_fmaak_f32 v230, v230, v223, 0xc0135761
  s_waitcnt lgkmcnt(4)
  v_mfma_f32_32x32x16_bf16 v[176:191], a[88:91], v[112:115], v[176:191]
  v_add_u32 v209, 65536, v211
  ds_read_b64_tr_b16 a[80:81], v209 offset:0
  ds_read_b64_tr_b16 a[82:83], v209 offset:512
  v_fmaak_f32 v225, v225, v223, 0xc0135761
  v_fmaak_f32 v226, v226, v223, 0xc0135761
  v_mul_f32 v229, v229, v160
  v_mfma_f32_32x32x16_bf16 v[176:191], a[92:95], v[116:119], v[176:191]
  ds_read_b64_tr_b16 a[84:85], v209 offset:2048
  ds_read_b64_tr_b16 a[86:87], v209 offset:2560
  v_mul_f32 v230, v230, v161
  v_mul_f32 v225, v225, v162
  v_mul_f32 v226, v226, v163
  s_waitcnt lgkmcnt(4)
  v_mfma_f32_32x32x16_bf16 v[176:191], a[72:75], v[120:123], v[176:191]
  ds_read_b64_tr_b16 a[88:89], v209 offset:4096
  ds_read_b64_tr_b16 a[90:91], v209 offset:4608
  buffer_load_dwordx4 v216, s[20:23], s71 offen offset:1024 lds
  v_exp_f32 v229, v229
  v_mfma_f32_32x32x16_bf16 v[176:191], a[76:79], v[124:127], v[176:191]
  ds_read_b64_tr_b16 a[92:93], v209 offset:6144
  ds_read_b64_tr_b16 a[94:95], v209 offset:6656
  v_exp_f32 v230, v230
  v_and_b32 v246, 3, v208
  s_waitcnt lgkmcnt(4)
  v_mfma_f32_32x32x16_bf16 v[176:191], a[80:83], v[128:131], v[176:191]
  v_mov_b32 v210, v212
  ds_read_b64_tr_b16 a[72:73], v210 offset:0
  ds_read_b64_tr_b16 a[74:75], v210 offset:512
  v_exp_f32 v225, v225
  v_mul_u32_u24 v245, 9216, v245
  v_mfma_f32_32x32x16_bf16 v[176:191], a[84:87], v[132:135], v[176:191]
  ds_read_b64_tr_b16 a[76:77], v210 offset:2048
  ds_read_b64_tr_b16 a[78:79], v210 offset:2560
  buffer_load_dwordx4 v217, s[20:23], s71 offen offset:2048 lds
  s_waitcnt lgkmcnt(4)
  v_mfma_f32_32x32x16_bf16 v[176:191], a[88:91], v[136:139], v[176:191]
  ds_read_b64_tr_b16 a[80:81], v210 offset:4096
  ds_read_b64_tr_b16 a[82:83], v210 offset:4608
  v_exp_f32 v226, v226
  v_add_f32 v229, 1.0, v229
  v_add_f32 v230, 1.0, v230
  v_mfma_f32_32x32x16_bf16 v[176:191], a[92:95], v[140:143], v[176:191]
  ds_read_b64_tr_b16 a[84:85], v210 offset:6144
  ds_read_b64_tr_b16 a[86:87], v210 offset:6656
  v_add_f32 v225, 1.0, v225
  v_add_f32 v226, 1.0, v226
  s_waitcnt lgkmcnt(4)
  v_mfma_f32_32x32x16_bf16 v[192:207], a[72:75], v[0:3], 0
  ds_read_b64_tr_b16 a[88:89], v210 offset:8192
  ds_read_b64_tr_b16 a[90:91], v210 offset:8704
  v_rcp_f32 v229, v229
  v_rcp_f32 v230, v230
  v_mfma_f32_32x32x16_bf16 v[192:207], a[76:79], v[4:7], v[192:207]
  ds_read_b64_tr_b16 a[92:93], v210 offset:10240
  ds_read_b64_tr_b16 a[94:95], v210 offset:10752
  v_rcp_f32 v225, v225
  s_mul_i32 s70, s44, 576
  s_waitcnt lgkmcnt(4)
  v_mfma_f32_32x32x16_bf16 v[192:207], a[80:83], v[8:11], v[192:207]
  ds_read_b64_tr_b16 a[72:73], v210 offset:12288
  ds_read_b64_tr_b16 a[74:75], v210 offset:12800
  v_rcp_f32 v226, v226
  v_mul_f32 v160, v160, v229
  v_mul_f32 v161, v161, v230
  v_mfma_f32_32x32x16_bf16 v[192:207], a[84:87], v[12:15], v[192:207]
  ds_read_b64_tr_b16 a[76:77], v210 offset:14336
  ds_read_b64_tr_b16 a[78:79], v210 offset:14848
  v_mul_f32 v162, v162, v225
  v_mul_f32 v163, v163, v226
  v_mul_f32 v229, v164, v164
  s_waitcnt lgkmcnt(4)
  v_mfma_f32_32x32x16_bf16 v[192:207], a[88:91], v[16:19], v[192:207]
  ds_read_b64_tr_b16 a[80:81], v210 offset:16384
  ds_read_b64_tr_b16 a[82:83], v210 offset:16896
  v_mul_f32 v230, v165, v165
  v_mul_f32 v225, v166, v166
  v_mul_f32 v226, v167, v167
  v_fmaak_f32 v229, v229, v223, 0xc0135761
  v_mfma_f32_32x32x16_bf16 v[192:207], a[92:95], v[20:23], v[192:207]
  ds_read_b64_tr_b16 a[84:85], v210 offset:18432
  ds_read_b64_tr_b16 a[86:87], v210 offset:18944
  v_fmaak_f32 v230, v230, v223, 0xc0135761
  v_fmaak_f32 v225, v225, v223, 0xc0135761
  v_fmaak_f32 v226, v226, v223, 0xc0135761
  s_waitcnt lgkmcnt(4)
  v_mfma_f32_32x32x16_bf16 v[192:207], a[72:75], v[24:27], v[192:207]
  ds_read_b64_tr_b16 a[88:89], v210 offset:20480
  ds_read_b64_tr_b16 a[90:91], v210 offset:20992
  v_mul_f32 v229, v229, v164
  v_mul_f32 v230, v230, v165
  v_mul_f32 v225, v225, v166
  v_mul_f32 v226, v226, v167
  v_mfma_f32_32x32x16_bf16 v[192:207], a[76:79], v[28:31], v[192:207]
  ds_read_b64_tr_b16 a[92:93], v210 offset:22528
  ds_read_b64_tr_b16 a[94:95], v210 offset:23040
  v_exp_f32 v229, v229
  v_mul_f32 v144, v144, v176
  s_waitcnt lgkmcnt(4)
  v_mfma_f32_32x32x16_bf16 v[192:207], a[80:83], v[32:35], v[192:207]
  ds_read_b64_tr_b16 a[72:73], v210 offset:24576
  ds_read_b64_tr_b16 a[74:75], v210 offset:25088
  v_exp_f32 v230, v230
  v_exp_f32 v225, v225
  v_mfma_f32_32x32x16_bf16 v[192:207], a[84:87], v[36:39], v[192:207]
  ds_read_b64_tr_b16 a[76:77], v210 offset:26624
  ds_read_b64_tr_b16 a[78:79], v210 offset:27136
  v_exp_f32 v226, v226
  v_add_f32 v229, 1.0, v229
  s_waitcnt lgkmcnt(4)
  v_mfma_f32_32x32x16_bf16 v[192:207], a[88:91], v[40:43], v[192:207]
  ds_read_b64_tr_b16 a[80:81], v210 offset:28672
  ds_read_b64_tr_b16 a[82:83], v210 offset:29184
  v_add_f32 v230, 1.0, v230
  v_add_f32 v225, 1.0, v225
  v_add_f32 v226, 1.0, v226
  v_mul_f32 v145, v145, v177
  v_mfma_f32_32x32x16_bf16 v[192:207], a[92:95], v[44:47], v[192:207]
  ds_read_b64_tr_b16 a[84:85], v210 offset:30720
  ds_read_b64_tr_b16 a[86:87], v210 offset:31232
  v_rcp_f32 v229, v229
  s_add_u32 s70, s70, s101
  s_waitcnt lgkmcnt(4)
  v_mfma_f32_32x32x16_bf16 v[192:207], a[72:75], v[48:51], v[192:207]
  ds_read_b64_tr_b16 a[88:89], v210 offset:32768
  ds_read_b64_tr_b16 a[90:91], v210 offset:33280
  v_rcp_f32 v230, v230
  v_rcp_f32 v225, v225
  v_mfma_f32_32x32x16_bf16 v[192:207], a[76:79], v[52:55], v[192:207]
  ds_read_b64_tr_b16 a[92:93], v210 offset:34816
  ds_read_b64_tr_b16 a[94:95], v210 offset:35328
  v_rcp_f32 v226, v226
  v_mul_f32 v164, v164, v229
  s_waitcnt lgkmcnt(4)
  v_mfma_f32_32x32x16_bf16 v[192:207], a[80:83], v[56:59], v[192:207]
  ds_read_b64_tr_b16 a[72:73], v210 offset:36864
  ds_read_b64_tr_b16 a[74:75], v210 offset:37376
  s_lshl_b32 s69, s99, 6
  s_add_u32 s70, s70, s69
  s_add_u32 s70, s70, 384
  v_mul_f32 v165, v165, v230
  buffer_load_dword v249, v248, s[20:23], s70 offen
  buffer_load_dword v249, v248, s[24:27], s70 offen
  v_mfma_f32_32x32x16_bf16 v[192:207], a[84:87], v[60:63], v[192:207]
  ds_read_b64_tr_b16 a[76:77], v210 offset:38912
  ds_read_b64_tr_b16 a[78:79], v210 offset:39424
  v_mul_f32 v166, v166, v225
  v_mul_f32 v167, v167, v226
  v_mul_f32 v229, v168, v168
  s_waitcnt lgkmcnt(4)
  v_mfma_f32_32x32x16_bf16 v[192:207], a[88:91], v[64:67], v[192:207]
  ds_read_b64_tr_b16 a[80:81], v210 offset:40960
  ds_read_b64_tr_b16 a[82:83], v210 offset:41472
  v_mul_f32 v230, v169, v169
  v_mul_f32 v225, v170, v170
  v_mul_f32 v226, v171, v171
  v_fmaak_f32 v229, v229, v223, 0xc0135761
  v_mfma_f32_32x32x16_bf16 v[192:207], a[92:95], v[68:71], v[192:207]
  s_waitcnt vmcnt(18)
  s_barrier
  ds_read_b64_tr_b16 a[84:85], v210 offset:43008
  ds_read_b64_tr_b16 a[86:87], v210 offset:43520
  s_add_u32 m0, s72, 0
  s_add_u32 s71, s75, 256
  v_mov_b32 v255, 2
  buffer_store_dword v255, v253, s[40:43], s65 offen sc1
  s_waitcnt lgkmcnt(4)
  v_mfma_f32_32x32x16_bf16 v[192:207], a[72:75], v[72:75], v[192:207]
  ds_read_b64_tr_b16 a[88:89], v210 offset:45056
  ds_read_b64_tr_b16 a[90:91], v210 offset:45568
  buffer_load_dwordx4 v215, s[24:27], s71 offen offset:0 lds
  v_fmaak_f32 v230, v230, v223, 0xc0135761
  v_fmaak_f32 v225, v225, v223, 0xc0135761
  v_mfma_f32_32x32x16_bf16 v[192:207], a[76:79], v[76:79], v[192:207]
  ds_read_b64_tr_b16 a[92:93], v210 offset:47104
  ds_read_b64_tr_b16 a[94:95], v210 offset:47616
  v_fmaak_f32 v226, v226, v223, 0xc0135761
  v_mul_f32 v229, v229, v168
  v_mul_f32 v230, v230, v169
  s_waitcnt lgkmcnt(4)
  v_mfma_f32_32x32x16_bf16 v[192:207], a[80:83], v[80:83], v[192:207]
  ds_read_b64_tr_b16 a[72:73], v210 offset:49152
  ds_read_b64_tr_b16 a[74:75], v210 offset:49664
  v_mul_f32 v225, v225, v170
  v_mul_f32 v226, v226, v171
  v_exp_f32 v229, v229
  v_mfma_f32_32x32x16_bf16 v[192:207], a[84:87], v[84:87], v[192:207]
  ds_read_b64_tr_b16 a[76:77], v210 offset:51200
  ds_read_b64_tr_b16 a[78:79], v210 offset:51712
  buffer_load_dwordx4 v216, s[24:27], s71 offen offset:1024 lds
  v_cvt_pk_bf16_f32 v231, v144, v145
  s_waitcnt lgkmcnt(4)
  v_mfma_f32_32x32x16_bf16 v[192:207], a[88:91], v[88:91], v[192:207]
  ds_read_b64_tr_b16 a[80:81], v210 offset:53248
  ds_read_b64_tr_b16 a[82:83], v210 offset:53760
  v_exp_f32 v230, v230
  v_exp_f32 v225, v225
  v_mfma_f32_32x32x16_bf16 v[192:207], a[92:95], v[92:95], v[192:207]
  ds_read_b64_tr_b16 a[84:85], v210 offset:55296
  ds_read_b64_tr_b16 a[86:87], v210 offset:55808
  v_exp_f32 v226, v226
  v_add_f32 v229, 1.0, v229
  s_waitcnt lgkmcnt(4)
  v_mfma_f32_32x32x16_bf16 v[192:207], a[72:75], v[96:99], v[192:207]
  ds_read_b64_tr_b16 a[88:89], v210 offset:57344
  ds_read_b64_tr_b16 a[90:91], v210 offset:57856
  buffer_load_dwordx4 v217, s[24:27], s71 offen offset:2048 lds
  s_waitcnt vmcnt(21)
  v_cmp_gt_u32 vcc, 16, v251
  s_nop 3
  s_cbranch_vccnz L_slow1
L_ret1:
  v_mfma_f32_32x32x16_bf16 v[192:207], a[76:79], v[100:103], v[192:207]
  ds_read_b64_tr_b16 a[92:93], v210 offset:59392
  ds_read_b64_tr_b16 a[94:95], v210 offset:59904
  v_add_f32 v230, 1.0, v230
  v_add_f32 v225, 1.0, v225
  v_add_f32 v226, 1.0, v226
  s_waitcnt lgkmcnt(4)
  v_mfma_f32_32x32x16_bf16 v[192:207], a[80:83], v[104:107], v[192:207]
  ds_read_b64_tr_b16 a[72:73], v210 offset:61440
  ds_read_b64_tr_b16 a[74:75], v210 offset:61952
  s_add_u32 m0, s72, 12288
  s_add_u32 s71, s75, 884992
  v_rcp_f32 v229, v229
  v_accvgpr_write_b32 a16, v231
  v_mul_f32 v146, v146, v178
  v_mfma_f32_32x32x16_bf16 v[192:207], a[84:87], v[108:111], v[192:207]
  ds_read_b64_tr_b16 a[76:77], v210 offset:63488
  ds_read_b64_tr_b16 a[78:79], v210 offset:64000
  buffer_load_dwordx4 v215, s[24:27], s71 offen offset:0 lds
  v_mul_f32 v147, v147, v179
  v_rcp_f32 v230, v230
  s_waitcnt lgkmcnt(4)
  v_mfma_f32_32x32x16_bf16 v[192:207], a[88:91], v[112:115], v[192:207]
  v_add_u32 v210, 65536, v212
  ds_read_b64_tr_b16 a[80:81], v210 offset:0
  ds_read_b64_tr_b16 a[82:83], v210 offset:512
  v_cvt_pk_bf16_f32 v232, v146, v147
  v_accvgpr_write_b32 a17, v232
  v_rcp_f32 v225, v225
  v_mul_f32 v148, v148, v180
  v_mfma_f32_32x32x16_bf16 v[192:207], a[92:95], v[116:119], v[192:207]
  ds_read_b64_tr_b16 a[84:85], v210 offset:2048
  ds_read_b64_tr_b16 a[86:87], v210 offset:2560
  v_mul_f32 v149, v149, v181
  v_cvt_pk_bf16_f32 v231, v148, v149
  v_rcp_f32 v226, v226
  v_accvgpr_write_b32 a18, v231
  s_waitcnt lgkmcnt(4)
  v_mfma_f32_32x32x16_bf16 v[192:207], a[72:75], v[120:123], v[192:207]
  ds_read_b64_tr_b16 a[88:89], v210 offset:4096
  ds_read_b64_tr_b16 a[90:91], v210 offset:4608
  buffer_load_dwordx4 v216, s[24:27], s71 offen offset:1024 lds
  v_mul_f32 v150, v150, v182
  v_mul_f32 v151, v151, v183
  v_mul_f32 v168, v168, v229
  v_cvt_pk_bf16_f32 v232, v150, v151
  v_mfma_f32_32x32x16_bf16 v[192:207], a[76:79], v[124:127], v[192:207]
  ds_read_b64_tr_b16 a[92:93], v210 offset:6144
  ds_read_b64_tr_b16 a[94:95], v210 offset:6656
  v_accvgpr_write_b32 a19, v232
  s_add_u32 s81, s60, 4096
  v_mul_f32 v169, v169, v230
  v_mul_f32 v170, v170, v225
  buffer_store_dwordx4 a[16:19], v224, s[40:43], s81 offen sc1
  s_waitcnt lgkmcnt(4)
  v_mfma_f32_32x32x16_bf16 v[192:207], a[80:83], v[128:131], v[192:207]
  ds_read_b64_tr_b16 a[72:73], v209 offset:8192
  ds_read_b64_tr_b16 a[74:75], v209 offset:8704
  v_mul_f32 v152, v152, v184
  v_mul_f32 v153, v153, v185
  v_cvt_pk_bf16_f32 v231, v152, v153
  v_mul_f32 v171, v171, v226
  v_mul_f32 v229, v172, v172
  v_mul_f32 v230, v173, v173
  v_mfma_f32_32x32x16_bf16 v[192:207], a[84:87], v[132:135], v[192:207]
  ds_read_b64_tr_b16 a[76:77], v209 offset:10240
  ds_read_b64_tr_b16 a[78:79], v209 offset:10752
  buffer_load_dwordx4 v217, s[24:27], s71 offen offset:2048 lds
  v_accvgpr_write_b32 a20, v231
  v_mul_f32 v154, v154, v186
  v_mul_f32 v155, v155, v187
  s_waitcnt lgkmcnt(4)
  v_mfma_f32_32x32x16_bf16 v[192:207], a[88:91], v[136:139], v[192:207]
  ds_read_b64_tr_b16 a[80:81], v209 offset:12288
  ds_read_b64_tr_b16 a[82:83], v209 offset:12800
  v_cvt_pk_bf16_f32 v232, v154, v155
  v_accvgpr_write_b32 a21, v232
  v_mul_f32 v156, v156, v188
  v_mul_f32 v157, v157, v189
  v_cvt_pk_bf16_f32 v231, v156, v157
  v_accvgpr_write_b32 a22, v231
  v_mul_f32 v158, v158, v190
  v_mul_f32 v159, v159, v191
  v_cvt_pk_bf16_f32 v232, v158, v159
  v_accvgpr_write_b32 a23, v232
  s_add_u32 s81, s60, 5120
  buffer_store_dwordx4 a[20:23], v224, s[40:43], s81 offen sc1
  v_mfma_f32_32x32x16_bf16 v[192:207], a[92:95], v[140:143], v[192:207]
  s_waitcnt vmcnt(17)
  s_barrier
  ds_read_b64_tr_b16 a[84:85], v209 offset:14336
  ds_read_b64_tr_b16 a[86:87], v209 offset:14848
  s_add_u32 m0, s72, 24576
  s_add_u32 s71, s75, 1769728
  s_waitcnt lgkmcnt(4)
  v_mfma_f32_32x32x16_bf16 v[144:159], a[72:75], v[0:3], 0
  ds_read_b64_tr_b16 a[88:89], v209 offset:16384
  ds_read_b64_tr_b16 a[90:91], v209 offset:16896
  buffer_load_dwordx4 v215, s[24:27], s71 offen offset:0 lds
  v_mul_f32 v225, v174, v174
  v_mul_f32 v226, v175, v175
  v_fmaak_f32 v229, v229, v223, 0xc0135761
  v_fmaak_f32 v230, v230, v223, 0xc0135761
  v_mfma_f32_32x32x16_bf16 v[144:159], a[76:79], v[4:7], v[144:159]
  ds_read_b64_tr_b16 a[92:93], v209 offset:18432
  ds_read_b64_tr_b16 a[94:95], v209 offset:18944
  v_fmaak_f32 v225, v225, v223, 0xc0135761
  v_fmaak_f32 v226, v226, v223, 0xc0135761
  v_mul_f32 v229, v229, v172
  v_mul_f32 v230, v230, v173
  v_mul_f32 v225, v225, v174
  s_waitcnt lgkmcnt(4)
  v_mfma_f32_32x32x16_bf16 v[144:159], a[80:83], v[8:11], v[144:159]
  ds_read_b64_tr_b16 a[72:73], v209 offset:20480
  ds_read_b64_tr_b16 a[74:75], v209 offset:20992
  v_mul_f32 v226, v226, v175
  v_exp_f32 v229, v229
  v_exp_f32 v230, v230
  v_exp_f32 v225, v225
  v_exp_f32 v226, v226
  v_add_f32 v229, 1.0, v229
  v_add_f32 v230, 1.0, v230
  v_add_f32 v225, 1.0, v225
  v_add_f32 v226, 1.0, v226
  v_rcp_f32 v229, v229
  v_rcp_f32 v230, v230
  v_rcp_f32 v225, v225
  v_rcp_f32 v226, v226
  v_mul_f32 v172, v172, v229
  v_mul_f32 v173, v173, v230
  v_mul_f32 v174, v174, v225
  v_mul_f32 v175, v175, v226
  v_mfma_f32_32x32x16_bf16 v[144:159], a[84:87], v[12:15], v[144:159]
  ds_read_b64_tr_b16 a[76:77], v209 offset:22528
  ds_read_b64_tr_b16 a[78:79], v209 offset:23040
  buffer_load_dwordx4 v216, s[24:27], s71 offen offset:1024 lds
  v_lshl_add_u32 v219, v246, 4, v245
  s_waitcnt lgkmcnt(4)
  v_mfma_f32_32x32x16_bf16 v[144:159], a[88:91], v[16:19], v[144:159]
  ds_read_b64_tr_b16 a[80:81], v209 offset:24576
  ds_read_b64_tr_b16 a[82:83], v209 offset:25088
  v_mul_f32 v160, v160, v192
  v_mul_f32 v161, v161, v193
  v_mfma_f32_32x32x16_bf16 v[144:159], a[92:95], v[20:23], v[144:159]
  ds_read_b64_tr_b16 a[84:85], v209 offset:26624
  ds_read_b64_tr_b16 a[86:87], v209 offset:27136
  v_cvt_pk_bf16_f32 v231, v160, v161
  s_waitcnt lgkmcnt(4)
  v_mfma_f32_32x32x16_bf16 v[144:159], a[72:75], v[24:27], v[144:159]
  ds_read_b64_tr_b16 a[88:89], v209 offset:28672
  ds_read_b64_tr_b16 a[90:91], v209 offset:29184
  buffer_load_dwordx4 v217, s[24:27], s71 offen offset:2048 lds
  v_accvgpr_write_b32 a24, v231
  v_mfma_f32_32x32x16_bf16 v[144:159], a[76:79], v[28:31], v[144:159]
  ds_read_b64_tr_b16 a[92:93], v209 offset:30720
  ds_read_b64_tr_b16 a[94:95], v209 offset:31232
  v_mul_f32 v162, v162, v194
  s_waitcnt lgkmcnt(4)
  v_mfma_f32_32x32x16_bf16 v[144:159], a[80:83], v[32:35], v[144:159]
  ds_read_b64_tr_b16 a[72:73], v209 offset:32768
  ds_read_b64_tr_b16 a[74:75], v209 offset:33280
  s_add_u32 m0, s72, 36864
  s_add_u32 s71, s75, 2654464
  v_mul_f32 v163, v163, v195
  v_mfma_f32_32x32x16_bf16 v[144:159], a[84:87], v[36:39], v[144:159]
  ds_read_b64_tr_b16 a[76:77], v209 offset:34816
  ds_read_b64_tr_b16 a[78:79], v209 offset:35328
  buffer_load_dwordx4 v215, s[24:27], s71 offen offset:0 lds
  v_cvt_pk_bf16_f32 v232, v162, v163
  s_waitcnt lgkmcnt(4)
  v_mfma_f32_32x32x16_bf16 v[144:159], a[88:91], v[40:43], v[144:159]
  ds_read_b64_tr_b16 a[80:81], v209 offset:36864
  ds_read_b64_tr_b16 a[82:83], v209 offset:37376
  v_accvgpr_write_b32 a25, v232
  v_mul_f32 v164, v164, v196
  v_mfma_f32_32x32x16_bf16 v[144:159], a[92:95], v[44:47], v[144:159]
  ds_read_b64_tr_b16 a[84:85], v209 offset:38912
  ds_read_b64_tr_b16 a[86:87], v209 offset:39424
  v_mul_f32 v165, v165, v197
  s_waitcnt lgkmcnt(4)
  v_mfma_f32_32x32x16_bf16 v[144:159], a[72:75], v[48:51], v[144:159]
  ds_read_b64_tr_b16 a[88:89], v209 offset:40960
  ds_read_b64_tr_b16 a[90:91], v209 offset:41472
  buffer_load_dwordx4 v216, s[24:27], s71 offen offset:1024 lds
  v_cvt_pk_bf16_f32 v231, v164, v165
  v_mfma_f32_32x32x16_bf16 v[144:159], a[76:79], v[52:55], v[144:159]
  ds_read_b64_tr_b16 a[92:93], v209 offset:43008
  ds_read_b64_tr_b16 a[94:95], v209 offset:43520
  v_accvgpr_write_b32 a26, v231
  s_waitcnt lgkmcnt(4)
  v_mfma_f32_32x32x16_bf16 v[144:159], a[80:83], v[56:59], v[144:159]
  ds_read_b64_tr_b16 a[72:73], v209 offset:45056
  ds_read_b64_tr_b16 a[74:75], v209 offset:45568
  v_mul_f32 v166, v166, v198
  v_mul_f32 v167, v167, v199
  v_mfma_f32_32x32x16_bf16 v[144:159], a[84:87], v[60:63], v[144:159]
  ds_read_b64_tr_b16 a[76:77], v209 offset:47104
  ds_read_b64_tr_b16 a[78:79], v209 offset:47616
  buffer_load_dwordx4 v217, s[24:27], s71 offen offset:2048 lds
  v_cvt_pk_bf16_f32 v232, v166, v167
  s_waitcnt lgkmcnt(4)
  v_mfma_f32_32x32x16_bf16 v[144:159], a[88:91], v[64:67], v[144:159]
  ds_read_b64_tr_b16 a[80:81], v209 offset:49152
  ds_read_b64_tr_b16 a[82:83], v209 offset:49664
  v_accvgpr_write_b32 a27, v232
  v_mfma_f32_32x32x16_bf16 v[144:159], a[92:95], v[68:71], v[144:159]
  s_waitcnt vmcnt(17)
  s_barrier
  ds_read_b64_tr_b16 a[84:85], v209 offset:51200
  ds_read_b64_tr_b16 a[86:87], v209 offset:51712
  s_add_u32 m0, s72, 49152
  s_add_u32 s71, s75, 3539200
  s_waitcnt lgkmcnt(4)
  v_mfma_f32_32x32x16_bf16 v[144:159], a[72:75], v[72:75], v[144:159]
  ds_read_b64_tr_b16 a[88:89], v209 offset:53248
  ds_read_b64_tr_b16 a[90:91], v209 offset:53760
  buffer_load_dwordx4 v215, s[24:27], s71 offen offset:0 lds
  s_add_u32 s81, s60, 6144
  buffer_store_dwordx4 a[24:27], v224, s[40:43], s81 offen sc1
  v_mfma_f32_32x32x16_bf16 v[144:159], a[76:79], v[76:79], v[144:159]
  ds_read_b64_tr_b16 a[92:93], v209 offset:55296
  ds_read_b64_tr_b16 a[94:95], v209 offset:55808
  v_mul_f32 v168, v168, v200
  v_mul_f32 v169, v169, v201
  s_waitcnt lgkmcnt(4)
  v_mfma_f32_32x32x16_bf16 v[144:159], a[80:83], v[80:83], v[144:159]
  ds_read_b64_tr_b16 a[72:73], v209 offset:57344
  ds_read_b64_tr_b16 a[74:75], v209 offset:57856
  v_cvt_pk_bf16_f32 v231, v168, v169
  v_mfma_f32_32x32x16_bf16 v[144:159], a[84:87], v[84:87], v[144:159]
  ds_read_b64_tr_b16 a[76:77], v209 offset:59392
  ds_read_b64_tr_b16 a[78:79], v209 offset:59904
  buffer_load_dwordx4 v216, s[24:27], s71 offen offset:1024 lds
  v_accvgpr_write_b32 a28, v231
  s_waitcnt lgkmcnt(4)
  v_mfma_f32_32x32x16_bf16 v[144:159], a[88:91], v[88:91], v[144:159]
  ds_read_b64_tr_b16 a[80:81], v209 offset:61440
  ds_read_b64_tr_b16 a[82:83], v209 offset:61952
  v_mul_f32 v170, v170, v202
  v_mfma_f32_32x32x16_bf16 v[144:159], a[92:95], v[92:95], v[144:159]
  ds_read_b64_tr_b16 a[84:85], v209 offset:63488
  ds_read_b64_tr_b16 a[86:87], v209 offset:64000
  v_mul_f32 v171, v171, v203
  s_waitcnt lgkmcnt(4)
  v_mfma_f32_32x32x16_bf16 v[144:159], a[72:75], v[96:99], v[144:159]
  v_add_u32 v209, 131072, v211
  ds_read_b64_tr_b16 a[88:89], v209 offset:0
  ds_read_b64_tr_b16 a[90:91], v209 offset:512
  buffer_load_dwordx4 v217, s[24:27], s71 offen offset:2048 lds
  v_cvt_pk_bf16_f32 v232, v170, v171
  v_mfma_f32_32x32x16_bf16 v[144:159], a[76:79], v[100:103], v[144:159]
  ds_read_b64_tr_b16 a[92:93], v209 offset:2048
  ds_read_b64_tr_b16 a[94:95], v209 offset:2560
  v_accvgpr_write_b32 a29, v232
  v_mul_f32 v172, v172, v204
  s_waitcnt lgkmcnt(4)
  v_mfma_f32_32x32x16_bf16 v[144:159], a[80:83], v[104:107], v[144:159]
  ds_read_b64_tr_b16 a[72:73], v209 offset:4096
  ds_read_b64_tr_b16 a[74:75], v209 offset:4608
  s_add_u32 m0, s72, 61440
  s_add_u32 s71, s75, 4423936
  v_mul_f32 v173, v173, v205
  v_mfma_f32_32x32x16_bf16 v[144:159], a[84:87], v[108:111], v[144:159]
  ds_read_b64_tr_b16 a[76:77], v209 offset:6144
  ds_read_b64_tr_b16 a[78:79], v209 offset:6656
  buffer_load_dwordx4 v215, s[24:27], s71 offen offset:0 lds
  v_cvt_pk_bf16_f32 v231, v172, v173
  s_waitcnt lgkmcnt(4)
  v_mfma_f32_32x32x16_bf16 v[144:159], a[88:91], v[112:115], v[144:159]
  ds_read_b64_tr_b16 a[80:81], v209 offset:8192
  ds_read_b64_tr_b16 a[82:83], v209 offset:8704
  v_accvgpr_write_b32 a30, v231
  v_mfma_f32_32x32x16_bf16 v[144:159], a[92:95], v[116:119], v[144:159]
  ds_read_b64_tr_b16 a[84:85], v209 offset:10240
  ds_read_b64_tr_b16 a[86:87], v209 offset:10752
  v_mul_f32 v174, v174, v206
  v_mul_f32 v175, v175, v207
  s_waitcnt lgkmcnt(4)
  v_mfma_f32_32x32x16_bf16 v[144:159], a[72:75], v[120:123], v[144:159]
  ds_read_b64_tr_b16 a[88:89], v209 offset:12288
  ds_read_b64_tr_b16 a[90:91], v209 offset:12800
  buffer_load_dwordx4 v216, s[24:27], s71 offen offset:1024 lds
  buffer_load_dword v251, v252, s[40:43], s67 offen sc1
  v_cvt_pk_bf16_f32 v232, v174, v175
  v_mfma_f32_32x32x16_bf16 v[144:159], a[76:79], v[124:127], v[144:159]
  ds_read_b64_tr_b16 a[92:93], v209 offset:14336
  ds_read_b64_tr_b16 a[94:95], v209 offset:14848
  v_accvgpr_write_b32 a31, v232
  s_lshl_b32 s70, s46, 6
  v_add_u32 v233, s70, v208
  s_waitcnt lgkmcnt(4)
  v_mfma_f32_32x32x16_bf16 v[144:159], a[80:83], v[128:131], v[144:159]
  ds_read_b64_tr_b16 a[72:73], v210 offset:8192
  ds_read_b64_tr_b16 a[74:75], v210 offset:8704
  s_add_u32 s81, s60, 7168
  v_mfma_f32_32x32x16_bf16 v[144:159], a[84:87], v[132:135], v[144:159]
  ds_read_b64_tr_b16 a[76:77], v210 offset:10240
  ds_read_b64_tr_b16 a[78:79], v210 offset:10752
  buffer_load_dwordx4 v217, s[24:27], s71 offen offset:2048 lds
  buffer_store_dwordx4 a[28:31], v224, s[40:43], s81 offen sc1
  s_waitcnt lgkmcnt(4)
  v_mfma_f32_32x32x16_bf16 v[144:159], a[88:91], v[136:139], v[144:159]
  ds_read_b64_tr_b16 a[80:81], v210 offset:12288
  ds_read_b64_tr_b16 a[82:83], v210 offset:12800
  v_mul_u32_u24 v234, 57, v233
  v_mfma_f32_32x32x16_bf16 v[144:159], a[92:95], v[140:143], v[144:159]
  ds_read_b64_tr_b16 a[84:85], v210 offset:14336
  ds_read_b64_tr_b16 a[86:87], v210 offset:14848
  v_lshrrev_b32 v234, 9, v234
  s_waitcnt lgkmcnt(4)
  v_mfma_f32_32x32x16_bf16 v[160:175], a[72:75], v[0:3], 0
  ds_read_b64_tr_b16 a[88:89], v210 offset:16384
  ds_read_b64_tr_b16 a[90:91], v210 offset:16896
  v_mfma_f32_32x32x16_bf16 v[160:175], a[76:79], v[4:7], v[160:175]
  ds_read_b64_tr_b16 a[92:93], v210 offset:18432
  ds_read_b64_tr_b16 a[94:95], v210 offset:18944
  v_mul_u32_u24 v235, 9, v234
  s_waitcnt lgkmcnt(4)
  v_mfma_f32_32x32x16_bf16 v[160:175], a[80:83], v[8:11], v[160:175]
  ds_read_b64_tr_b16 a[72:73], v210 offset:20480
  ds_read_b64_tr_b16 a[74:75], v210 offset:20992
  v_mfma_f32_32x32x16_bf16 v[160:175], a[84:87], v[12:15], v[160:175]
  ds_read_b64_tr_b16 a[76:77], v210 offset:22528
  ds_read_b64_tr_b16 a[78:79], v210 offset:23040
  v_mul_f32 v229, v144, v144
  v_mul_f32 v230, v145, v145
  v_mul_f32 v225, v146, v146
  s_waitcnt lgkmcnt(4)
  v_mfma_f32_32x32x16_bf16 v[160:175], a[88:91], v[16:19], v[160:175]
  ds_read_b64_tr_b16 a[80:81], v210 offset:24576
  ds_read_b64_tr_b16 a[82:83], v210 offset:25088
  v_mul_f32 v226, v147, v147
  v_fmaak_f32 v229, v229, v223, 0xc0135761
  v_fmaak_f32 v230, v230, v223, 0xc0135761
  v_sub_u32 v235, v233, v235
  v_mfma_f32_32x32x16_bf16 v[160:175], a[92:95], v[20:23], v[160:175]
  ds_read_b64_tr_b16 a[84:85], v210 offset:26624
  ds_read_b64_tr_b16 a[86:87], v210 offset:27136
  v_fmaak_f32 v225, v225, v223, 0xc0135761
  v_fmaak_f32 v226, v226, v223, 0xc0135761
  v_min_u32 v234, 17, v234
  s_waitcnt lgkmcnt(4)
  v_mfma_f32_32x32x16_bf16 v[160:175], a[72:75], v[24:27], v[160:175]
  ds_read_b64_tr_b16 a[88:89], v210 offset:28672
  ds_read_b64_tr_b16 a[90:91], v210 offset:29184
  v_mul_f32 v229, v229, v144
  v_mul_f32 v230, v230, v145
  v_mul_f32 v225, v225, v146
  v_mul_u32_u24 v234, 1152, v234
  v_mfma_f32_32x32x16_bf16 v[160:175], a[76:79], v[28:31], v[160:175]
  ds_read_b64_tr_b16 a[92:93], v210 offset:30720
  ds_read_b64_tr_b16 a[94:95], v210 offset:31232
  v_mul_f32 v226, v226, v147
  v_exp_f32 v229, v229
  s_waitcnt lgkmcnt(4)
  v_mfma_f32_32x32x16_bf16 v[160:175], a[80:83], v[32:35], v[160:175]
  ds_read_b64_tr_b16 a[72:73], v210 offset:32768
  ds_read_b64_tr_b16 a[74:75], v210 offset:33280
  v_exp_f32 v230, v230
  v_lshl_add_u32 v234, v235, 7, v234
  v_mfma_f32_32x32x16_bf16 v[160:175], a[84:87], v[36:39], v[160:175]
  ds_read_b64_tr_b16 a[76:77], v210 offset:34816
  ds_read_b64_tr_b16 a[78:79], v210 offset:35328
  v_exp_f32 v225, v225
  s_waitcnt lgkmcnt(4)
  v_mfma_f32_32x32x16_bf16 v[160:175], a[88:91], v[40:43], v[160:175]
  ds_read_b64_tr_b16 a[80:81], v210 offset:36864
  ds_read_b64_tr_b16 a[82:83], v210 offset:37376
  v_exp_f32 v226, v226
  v_add_f32 v229, 1.0, v229
  s_lshr_b32 s70, s2, 3
  v_mfma_f32_32x32x16_bf16 v[160:175], a[92:95], v[44:47], v[160:175]
  ds_read_b64_tr_b16 a[84:85], v210 offset:38912
  ds_read_b64_tr_b16 a[86:87], v210 offset:39424
  v_add_f32 v230, 1.0, v230
  v_add_f32 v225, 1.0, v225
  s_waitcnt lgkmcnt(4)
  v_mfma_f32_32x32x16_bf16 v[160:175], a[72:75], v[48:51], v[160:175]
  ds_read_b64_tr_b16 a[88:89], v210 offset:40960
  ds_read_b64_tr_b16 a[90:91], v210 offset:41472
  v_add_f32 v226, 1.0, v226
  v_rcp_f32 v229, v229
  s_mul_i32 s70, s70, 20736
  v_mfma_f32_32x32x16_bf16 v[160:175], a[76:79], v[52:55], v[160:175]
  ds_read_b64_tr_b16 a[92:93], v210 offset:43008
  ds_read_b64_tr_b16 a[94:95], v210 offset:43520
  v_rcp_f32 v230, v230
  s_waitcnt lgkmcnt(4)
  v_mfma_f32_32x32x16_bf16 v[160:175], a[80:83], v[56:59], v[160:175]
  ds_read_b64_tr_b16 a[72:73], v210 offset:45056
  ds_read_b64_tr_b16 a[74:75], v210 offset:45568
  v_rcp_f32 v225, v225
  v_rcp_f32 v226, v226
  v_mfma_f32_32x32x16_bf16 v[160:175], a[84:87], v[60:63], v[160:175]
  ds_read_b64_tr_b16 a[76:77], v210 offset:47104
  ds_read_b64_tr_b16 a[78:79], v210 offset:47616
  v_mul_f32 v144, v144, v229
  buffer_load_dword v249, v234, s[16:19], s70 offen
  s_waitcnt lgkmcnt(4)
  v_mfma_f32_32x32x16_bf16 v[160:175], a[88:91], v[64:67], v[160:175]
  ds_read_b64_tr_b16 a[80:81], v210 offset:49152
  ds_read_b64_tr_b16 a[82:83], v210 offset:49664
  v_mul_f32 v145, v145, v230
  v_mul_f32 v146, v146, v225
  v_mul_f32 v147, v147, v226
  v_mfma_f32_32x32x16_bf16 v[160:175], a[92:95], v[68:71], v[160:175]
  s_waitcnt vmcnt(21)
  s_barrier
  ds_read_b64_tr_b16 a[84:85], v210 offset:51200
  ds_read_b64_tr_b16 a[86:87], v210 offset:51712
  s_add_u32 m0, s72, 73728
  s_add_u32 s71, s75, 384
  s_waitcnt lgkmcnt(4)
  v_mfma_f32_32x32x16_bf16 v[160:175], a[72:75], v[72:75], v[160:175]
  ds_read_b64_tr_b16 a[88:89], v210 offset:53248
  ds_read_b64_tr_b16 a[90:91], v210 offset:53760
  buffer_load_dwordx4 v215, s[20:23], s71 offen offset:0 lds
  v_mul_f32 v229, v148, v148
  v_mul_f32 v230, v149, v149
  v_mfma_f32_32x32x16_bf16 v[160:175], a[76:79], v[76:79], v[160:175]
  ds_read_b64_tr_b16 a[92:93], v210 offset:55296
  ds_read_b64_tr_b16 a[94:95], v210 offset:55808
  v_mul_f32 v225, v150, v150
  v_mul_f32 v226, v151, v151
  v_fmaak_f32 v229, v229, v223, 0xc0135761
  s_waitcnt lgkmcnt(4)
  v_mfma_f32_32x32x16_bf16 v[160:175], a[80:83], v[80:83], v[160:175]
  ds_read_b64_tr_b16 a[72:73], v210 offset:57344
  ds_read_b64_tr_b16 a[74:75], v210 offset:57856
  v_fmaak_f32 v230, v230, v223, 0xc0135761
  v_fmaak_f32 v225, v225, v223, 0xc0135761
  v_fmaak_f32 v226, v226, v223, 0xc0135761
  v_mul_f32 v229, v229, v148
  v_mfma_f32_32x32x16_bf16 v[160:175], a[84:87], v[84:87], v[160:175]
  ds_read_b64_tr_b16 a[76:77], v210 offset:59392
  ds_read_b64_tr_b16 a[78:79], v210 offset:59904
  buffer_load_dwordx4 v216, s[20:23], s71 offen offset:1024 lds
  v_mul_f32 v230, v230, v149
  s_waitcnt lgkmcnt(4)
  v_mfma_f32_32x32x16_bf16 v[160:175], a[88:91], v[88:91], v[160:175]
  ds_read_b64_tr_b16 a[80:81], v210 offset:61440
  ds_read_b64_tr_b16 a[82:83], v210 offset:61952
  v_mul_f32 v225, v225, v150
  v_mul_f32 v226, v226, v151
  v_exp_f32 v229, v229
  v_mfma_f32_32x32x16_bf16 v[160:175], a[92:95], v[92:95], v[160:175]
  ds_read_b64_tr_b16 a[84:85], v210 offset:63488
  ds_read_b64_tr_b16 a[86:87], v210 offset:64000
  v_exp_f32 v230, v230
  v_add_u32 v220, 146432, v219
  s_waitcnt lgkmcnt(4)
  v_mfma_f32_32x32x16_bf16 v[160:175], a[72:75], v[96:99], v[160:175]
  v_add_u32 v210, 131072, v212
  ds_read_b64_tr_b16 a[88:89], v210 offset:0
  ds_read_b64_tr_b16 a[90:91], v210 offset:512
  buffer_load_dwordx4 v217, s[20:23], s71 offen offset:2048 lds
  v_mfma_f32_32x32x16_bf16 v[160:175], a[76:79], v[100:103], v[160:175]
  ds_read_b64_tr_b16 a[92:93], v210 offset:2048
  ds_read_b64_tr_b16 a[94:95], v210 offset:2560
  v_exp_f32 v225, v225
  s_waitcnt lgkmcnt(4)
  v_mfma_f32_32x32x16_bf16 v[160:175], a[80:83], v[104:107], v[160:175]
  ds_read_b64_tr_b16 a[72:73], v210 offset:4096
  ds_read_b64_tr_b16 a[74:75], v210 offset:4608
  s_add_u32 m0, s72, 86016
  s_add_u32 s71, s75, 885120
  v_exp_f32 v226, v226
  v_mfma_f32_32x32x16_bf16 v[160:175], a[84:87], v[108:111], v[160:175]
  ds_read_b64_tr_b16 a[76:77], v210 offset:6144
  ds_read_b64_tr_b16 a[78:79], v210 offset:6656
  buffer_load_dwordx4 v215, s[20:23], s71 offen offset:0 lds
  v_add_f32 v229, 1.0, v229
  s_waitcnt lgkmcnt(4)
  v_mfma_f32_32x32x16_bf16 v[160:175], a[88:91], v[112:115], v[160:175]
  ds_read_b64_tr_b16 a[80:81], v210 offset:8192
  ds_read_b64_tr_b16 a[82:83], v210 offset:8704
  v_add_f32 v230, 1.0, v230
  v_add_f32 v225, 1.0, v225
  v_add_f32 v226, 1.0, v226
  v_mfma_f32_32x32x16_bf16 v[160:175], a[92:95], v[116:119], v[160:175]
  ds_read_b64_tr_b16 a[84:85], v210 offset:10240
  ds_read_b64_tr_b16 a[86:87], v210 offset:10752
  v_rcp_f32 v229, v229
  s_waitcnt lgkmcnt(4)
  v_mfma_f32_32x32x16_bf16 v[160:175], a[72:75], v[120:123], v[160:175]
  ds_read_b64_tr_b16 a[88:89], v210 offset:12288
  ds_read_b64_tr_b16 a[90:91], v210 offset:12800
  buffer_load_dwordx4 v216, s[20:23], s71 offen offset:1024 lds
  v_rcp_f32 v230, v230
  v_mfma_f32_32x32x16_bf16 v[160:175], a[76:79], v[124:127], v[160:175]
  ds_read_b64_tr_b16 a[92:93], v210 offset:14336
  ds_read_b64_tr_b16 a[94:95], v210 offset:14848
  v_rcp_f32 v225, v225
  s_waitcnt lgkmcnt(4)
  v_mfma_f32_32x32x16_bf16 v[160:175], a[80:83], v[128:131], v[160:175]
  v_mov_b32 v209, v211
  ds_read_b64_tr_b16 a[72:73], v209 offset:0
  ds_read_b64_tr_b16 a[74:75], v209 offset:512
  v_rcp_f32 v226, v226
  v_mul_f32 v148, v148, v229
  v_mfma_f32_32x32x16_bf16 v[160:175], a[84:87], v[132:135], v[160:175]
  ds_read_b64_tr_b16 a[76:77], v209 offset:2048
  ds_read_b64_tr_b16 a[78:79], v209 offset:2560
  buffer_load_dwordx4 v217, s[20:23], s71 offen offset:2048 lds
  v_mul_f32 v149, v149, v230
  s_waitcnt lgkmcnt(4)
  v_mfma_f32_32x32x16_bf16 v[160:175], a[88:91], v[136:139], v[160:175]
  ds_read_b64_tr_b16 a[80:81], v209 offset:4096
  ds_read_b64_tr_b16 a[82:83], v209 offset:4608
  v_mul_f32 v150, v150, v225
  v_mul_f32 v151, v151, v226
  v_mul_f32 v229, v152, v152
  v_mul_f32 v230, v153, v153
  v_mfma_f32_32x32x16_bf16 v[160:175], a[92:95], v[140:143], v[160:175]
  s_waitcnt vmcnt(16)
  s_barrier
  ds_read_b64_tr_b16 a[84:85], v209 offset:6144
  ds_read_b64_tr_b16 a[86:87], v209 offset:6656
  s_add_u32 m0, s72, 98304
  s_add_u32 s71, s75, 1769856
  s_waitcnt lgkmcnt(4)
  v_mfma_f32_32x32x16_bf16 v[176:191], a[72:75], v[0:3], 0
  ds_read_b64_tr_b16 a[88:89], v209 offset:8192
  ds_read_b64_tr_b16 a[90:91], v209 offset:8704
  buffer_load_dwordx4 v215, s[20:23], s71 offen offset:0 lds
  v_mul_f32 v225, v154, v154
  v_mul_f32 v226, v155, v155
  v_mfma_f32_32x32x16_bf16 v[176:191], a[76:79], v[4:7], v[176:191]
  ds_read_b64_tr_b16 a[92:93], v209 offset:10240
  ds_read_b64_tr_b16 a[94:95], v209 offset:10752
  v_fmaak_f32 v229, v229, v223, 0xc0135761
  v_fmaak_f32 v230, v230, v223, 0xc0135761
  v_fmaak_f32 v225, v225, v223, 0xc0135761
  s_waitcnt lgkmcnt(4)
  v_mfma_f32_32x32x16_bf16 v[176:191], a[80:83], v[8:11], v[176:191]
  ds_read_b64_tr_b16 a[72:73], v209 offset:12288
  ds_read_b64_tr_b16 a[74:75], v209 offset:12800
  v_fmaak_f32 v226, v226, v223, 0xc0135761
  v_mul_f32 v229, v229, v152
  v_mul_f32 v230, v230, v153
  v_mul_f32 v225, v225, v154
  v_mfma_f32_32x32x16_bf16 v[176:191], a[84:87], v[12:15], v[176:191]
  ds_read_b64_tr_b16 a[76:77], v209 offset:14336
  ds_read_b64_tr_b16 a[78:79], v209 offset:14848
  buffer_load_dwordx4 v216, s[20:23], s71 offen offset:1024 lds
  v_mul_f32 v226, v226, v155
  s_waitcnt lgkmcnt(4)
  v_mfma_f32_32x32x16_bf16 v[176:191], a[88:91], v[16:19], v[176:191]
  ds_read_b64_tr_b16 a[80:81], v209 offset:16384
  ds_read_b64_tr_b16 a[82:83], v209 offset:16896
  v_exp_f32 v229, v229
  v_exp_f32 v230, v230
  v_mfma_f32_32x32x16_bf16 v[176:191], a[92:95], v[20:23], v[176:191]
  ds_read_b64_tr_b16 a[84:85], v209 offset:18432
  ds_read_b64_tr_b16 a[86:87], v209 offset:18944
  v_exp_f32 v225, v225
  s_waitcnt lgkmcnt(4)
  v_mfma_f32_32x32x16_bf16 v[176:191], a[72:75], v[24:27], v[176:191]
  ds_read_b64_tr_b16 a[88:89], v209 offset:20480
  ds_read_b64_tr_b16 a[90:91], v209 offset:20992
  buffer_load_dwordx4 v217, s[20:23], s71 offen offset:2048 lds
  v_exp_f32 v226, v226
  v_mfma_f32_32x32x16_bf16 v[176:191], a[76:79], v[28:31], v[176:191]
  ds_read_b64_tr_b16 a[92:93], v209 offset:22528
  ds_read_b64_tr_b16 a[94:95], v209 offset:23040
  v_add_f32 v229, 1.0, v229
  v_add_f32 v230, 1.0, v230
  v_add_f32 v225, 1.0, v225
  s_waitcnt lgkmcnt(4)
  v_mfma_f32_32x32x16_bf16 v[176:191], a[80:83], v[32:35], v[176:191]
  ds_read_b64_tr_b16 a[72:73], v209 offset:24576
  ds_read_b64_tr_b16 a[74:75], v209 offset:25088
  s_add_u32 m0, s72, 110592
  s_add_u32 s71, s75, 2654592
  v_add_f32 v226, 1.0, v226
  v_mfma_f32_32x32x16_bf16 v[176:191], a[84:87], v[36:39], v[176:191]
  ds_read_b64_tr_b16 a[76:77], v209 offset:26624
  ds_read_b64_tr_b16 a[78:79], v209 offset:27136
  buffer_load_dwordx4 v215, s[20:23], s71 offen offset:0 lds
  s_waitcnt lgkmcnt(4)
  v_mfma_f32_32x32x16_bf16 v[176:191], a[88:91], v[40:43], v[176:191]
  ds_read_b64_tr_b16 a[80:81], v209 offset:28672
  ds_read_b64_tr_b16 a[82:83], v209 offset:29184
  v_rcp_f32 v229, v229
  v_rcp_f32 v230, v230
  v_mfma_f32_32x32x16_bf16 v[176:191], a[92:95], v[44:47], v[176:191]
  ds_read_b64_tr_b16 a[84:85], v209 offset:30720
  ds_read_b64_tr_b16 a[86:87], v209 offset:31232
  v_rcp_f32 v225, v225
  s_waitcnt lgkmcnt(4)
  v_mfma_f32_32x32x16_bf16 v[176:191], a[72:75], v[48:51], v[176:191]
  ds_read_b64_tr_b16 a[88:89], v209 offset:32768
  ds_read_b64_tr_b16 a[90:91], v209 offset:33280
  buffer_load_dwordx4 v216, s[20:23], s71 offen offset:1024 lds
  v_rcp_f32 v226, v226
  v_mfma_f32_32x32x16_bf16 v[176:191], a[76:79], v[52:55], v[176:191]
  ds_read_b64_tr_b16 a[92:93], v209 offset:34816
  ds_read_b64_tr_b16 a[94:95], v209 offset:35328
  v_mul_f32 v152, v152, v229
  v_mul_f32 v153, v153, v230
  v_mul_f32 v154, v154, v225
  s_waitcnt lgkmcnt(4)
  v_mfma_f32_32x32x16_bf16 v[176:191], a[80:83], v[56:59], v[176:191]
  ds_read_b64_tr_b16 a[72:73], v209 offset:36864
  ds_read_b64_tr_b16 a[74:75], v209 offset:37376
  v_mul_f32 v155, v155, v226
  v_mul_f32 v229, v156, v156
  v_mul_f32 v230, v157, v157
  v_mul_f32 v225, v158, v158
  v_mfma_f32_32x32x16_bf16 v[176:191], a[84:87], v[60:63], v[176:191]
  ds_read_b64_tr_b16 a[76:77], v209 offset:38912
  ds_read_b64_tr_b16 a[78:79], v209 offset:39424
  buffer_load_dwordx4 v217, s[20:23], s71 offen offset:2048 lds
  v_mul_f32 v226, v159, v159
  v_fmaak_f32 v229, v229, v223, 0xc0135761
  s_waitcnt lgkmcnt(4)
  v_mfma_f32_32x32x16_bf16 v[176:191], a[88:91], v[64:67], v[176:191]
  ds_read_b64_tr_b16 a[80:81], v209 offset:40960
  ds_read_b64_tr_b16 a[82:83], v209 offset:41472
  v_fmaak_f32 v230, v230, v223, 0xc0135761
  v_fmaak_f32 v225, v225, v223, 0xc0135761
  v_fmaak_f32 v226, v226, v223, 0xc0135761
  v_mul_f32 v229, v229, v156
  v_mfma_f32_32x32x16_bf16 v[176:191], a[92:95], v[68:71], v[176:191]
  s_waitcnt vmcnt(14)
  s_barrier
  ds_read_b64_tr_b16 a[84:85], v209 offset:43008
  ds_read_b64_tr_b16 a[86:87], v209 offset:43520
  s_add_u32 m0, s72, 122880
  s_add_u32 s71, s75, 3539328
  s_waitcnt lgkmcnt(4)
  v_mfma_f32_32x32x16_bf16 v[176:191], a[72:75], v[72:75], v[176:191]
  ds_read_b64_tr_b16 a[88:89], v209 offset:45056
  ds_read_b64_tr_b16 a[90:91], v209 offset:45568
  buffer_load_dwordx4 v215, s[20:23], s71 offen offset:0 lds
  v_mul_f32 v230, v230, v157
  v_mul_f32 v225, v225, v158
  v_mul_f32 v226, v226, v159
  v_mfma_f32_32x32x16_bf16 v[176:191], a[76:79], v[76:79], v[176:191]
  ds_read_b64_tr_b16 a[92:93], v209 offset:47104
  ds_read_b64_tr_b16 a[94:95], v209 offset:47616
  v_exp_f32 v229, v229
  v_exp_f32 v230, v230
  s_waitcnt lgkmcnt(4)
  v_mfma_f32_32x32x16_bf16 v[176:191], a[80:83], v[80:83], v[176:191]
  ds_read_b64_tr_b16 a[72:73], v209 offset:49152
  ds_read_b64_tr_b16 a[74:75], v209 offset:49664
  v_exp_f32 v225, v225
  v_exp_f32 v226, v226
  v_add_f32 v229, 1.0, v229
  v_add_f32 v230, 1.0, v230
  v_mfma_f32_32x32x16_bf16 v[176:191], a[84:87], v[84:87], v[176:191]
  ds_read_b64_tr_b16 a[76:77], v209 offset:51200
  ds_read_b64_tr_b16 a[78:79], v209 offset:51712
  buffer_load_dwordx4 v216, s[20:23], s71 offen offset:1024 lds
  v_add_f32 v225, 1.0, v225
  v_add_f32 v226, 1.0, v226
  s_waitcnt lgkmcnt(4)
  v_mfma_f32_32x32x16_bf16 v[176:191], a[88:91], v[88:91], v[176:191]
  ds_read_b64_tr_b16 a[80:81], v209 offset:53248
  ds_read_b64_tr_b16 a[82:83], v209 offset:53760
  v_rcp_f32 v229, v229
  v_rcp_f32 v230, v230
  v_rcp_f32 v225, v225
  v_mfma_f32_32x32x16_bf16 v[176:191], a[92:95], v[92:95], v[176:191]
  ds_read_b64_tr_b16 a[84:85], v209 offset:55296
  ds_read_b64_tr_b16 a[86:87], v209 offset:55808
  v_rcp_f32 v226, v226
  v_mul_f32 v156, v156, v229
  v_mul_f32 v157, v157, v230
  v_mul_f32 v158, v158, v225
  v_mul_f32 v159, v159, v226
  s_waitcnt lgkmcnt(4)
  v_mfma_f32_32x32x16_bf16 v[176:191], a[72:75], v[96:99], v[176:191]
  ds_read_b64_tr_b16 a[88:89], v209 offset:57344
  ds_read_b64_tr_b16 a[90:91], v209 offset:57856
  buffer_load_dwordx4 v217, s[20:23], s71 offen offset:2048 lds
  v_mfma_f32_32x32x16_bf16 v[176:191], a[76:79], v[100:103], v[176:191]
  ds_read_b64_tr_b16 a[92:93], v209 offset:59392
  ds_read_b64_tr_b16 a[94:95], v209 offset:59904
  v_mul_f32 v229, v160, v160
  v_mul_f32 v230, v161, v161
  v_mul_f32 v225, v162, v162
  s_waitcnt lgkmcnt(4)
  v_mfma_f32_32x32x16_bf16 v[176:191], a[80:83], v[104:107], v[176:191]
  ds_read_b64_tr_b16 a[72:73], v209 offset:61440
  ds_read_b64_tr_b16 a[74:75], v209 offset:61952
  s_add_u32 m0, s72, 135168
  s_add_u32 s71, s75, 4424064
  v_mul_f32 v226, v163, v163
  v_fmaak_f32 v229, v229, v223, 0xc0135761
  v_mfma_f32_32x32x16_bf16 v[176:191], a[84:87], v[108:111], v[176:191]
  ds_read_b64_tr_b16 a[76:77], v209 offset:63488
  ds_read_b64_tr_b16 a[78:79], v209 offset:64000
  buffer_load_dwordx4 v215, s[20:23], s71 offen offset:0 lds
  v_fmaak_f32 v230, v230, v223, 0xc0135761
  s_waitcnt lgkmcnt(4)
  v_mfma_f32_32x32x16_bf16 v[176:191], a[88:91], v[112:115], v[176:191]
  v_add_u32 v209, 65536, v211
  ds_read_b64_tr_b16 a[80:81], v209 offset:0
  ds_read_b64_tr_b16 a[82:83], v209 offset:512
  v_cmp_gt_u32 vcc, 2, v251
  s_nop 3
  s_cbranch_vccnz L_slow2
L_ret2:
  v_fmaak_f32 v225, v225, v223, 0xc0135761
  v_mfma_f32_32x32x16_bf16 v[176:191], a[92:95], v[116:119], v[176:191]
  ds_read_b64_tr_b16 a[84:85], v209 offset:2048
  ds_read_b64_tr_b16 a[86:87], v209 offset:2560
  v_fmaak_f32 v226, v226, v223, 0xc0135761
  v_mul_f32 v229, v229, v160
  v_mul_f32 v230, v230, v161
  s_waitcnt lgkmcnt(4)
  v_mfma_f32_32x32x16_bf16 v[176:191], a[72:75], v[120:123], v[176:191]
  ds_read_b64_tr_b16 a[88:89], v209 offset:4096
  ds_read_b64_tr_b16 a[90:91], v209 offset:4608
  buffer_load_dwordx4 v216, s[20:23], s71 offen offset:1024 lds
  v_mul_f32 v225, v225, v162
  v_mul_f32 v226, v226, v163
  v_mfma_f32_32x32x16_bf16 v[176:191], a[76:79], v[124:127], v[176:191]
  ds_read_b64_tr_b16 a[92:93], v209 offset:6144
  ds_read_b64_tr_b16 a[94:95], v209 offset:6656
  s_add_u32 s84, s61, 0
  buffer_load_dwordx4 a[96:99], v224, s[40:43], s84 offen sc1
  s_add_u32 s84, s61, 1024
  s_waitcnt lgkmcnt(4)
  v_mfma_f32_32x32x16_bf16 v[176:191], a[80:83], v[128:131], v[176:191]
  v_mov_b32 v210, v212
  ds_read_b64_tr_b16 a[72:73], v210 offset:0
  ds_read_b64_tr_b16 a[74:75], v210 offset:512
  buffer_load_dwordx4 a[100:103], v224, s[40:43], s84 offen sc1
  s_add_u32 s84, s61, 2048
  buffer_load_dwordx4 a[104:107], v224, s[40:43], s84 offen sc1
  s_add_u32 s84, s61, 3072
  buffer_load_dwordx4 a[108:111], v224, s[40:43], s84 offen sc1
  v_mfma_f32_32x32x16_bf16 v[176:191], a[84:87], v[132:135], v[176:191]
  ds_read_b64_tr_b16 a[76:77], v210 offset:2048
  ds_read_b64_tr_b16 a[78:79], v210 offset:2560
  buffer_load_dwordx4 v217, s[20:23], s71 offen offset:2048 lds
  s_waitcnt lgkmcnt(4)
  v_mfma_f32_32x32x16_bf16 v[176:191], a[88:91], v[136:139], v[176:191]
  ds_read_b64_tr_b16 a[80:81], v210 offset:4096
  ds_read_b64_tr_b16 a[82:83], v210 offset:4608
  v_exp_f32 v229, v229
  v_exp_f32 v230, v230
  v_mfma_f32_32x32x16_bf16 v[176:191], a[92:95], v[140:143], v[176:191]
  ds_read_b64_tr_b16 a[84:85], v210 offset:6144
  ds_read_b64_tr_b16 a[86:87], v210 offset:6656
  v_exp_f32 v225, v225
  s_waitcnt lgkmcnt(4)
  v_mfma_f32_32x32x16_bf16 v[192:207], a[72:75], v[0:3], 0
  ds_read_b64_tr_b16 a[88:89], v210 offset:8192
  ds_read_b64_tr_b16 a[90:91], v210 offset:8704
  v_exp_f32 v226, v226
  v_add_f32 v229, 1.0, v229
  v_add_f32 v230, 1.0, v230
  v_mfma_f32_32x32x16_bf16 v[192:207], a[76:79], v[4:7], v[192:207]
  ds_read_b64_tr_b16 a[92:93], v210 offset:10240
  ds_read_b64_tr_b16 a[94:95], v210 offset:10752
  v_add_f32 v225, 1.0, v225
  v_add_f32 v226, 1.0, v226
  s_mul_i32 s70, s44, 576
  s_waitcnt lgkmcnt(4)
  v_mfma_f32_32x32x16_bf16 v[192:207], a[80:83], v[8:11], v[192:207]
  ds_read_b64_tr_b16 a[72:73], v210 offset:12288
  ds_read_b64_tr_b16 a[74:75], v210 offset:12800
  v_rcp_f32 v229, v229
  v_rcp_f32 v230, v230
  v_mfma_f32_32x32x16_bf16 v[192:207], a[84:87], v[12:15], v[192:207]
  ds_read_b64_tr_b16 a[76:77], v210 offset:14336
  ds_read_b64_tr_b16 a[78:79], v210 offset:14848
  v_rcp_f32 v225, v225
  v_mul_f32 v144, v144, v176
  s_waitcnt lgkmcnt(4)
  v_mfma_f32_32x32x16_bf16 v[192:207], a[88:91], v[16:19], v[192:207]
  ds_read_b64_tr_b16 a[80:81], v210 offset:16384
  ds_read_b64_tr_b16 a[82:83], v210 offset:16896
  v_rcp_f32 v226, v226
  v_mul_f32 v160, v160, v229
  v_mul_f32 v161, v161, v230
  v_mfma_f32_32x32x16_bf16 v[192:207], a[92:95], v[20:23], v[192:207]
  ds_read_b64_tr_b16 a[84:85], v210 offset:18432
  ds_read_b64_tr_b16 a[86:87], v210 offset:18944
  v_mul_f32 v162, v162, v225
  v_mul_f32 v163, v163, v226
  v_mul_f32 v229, v164, v164
  s_waitcnt lgkmcnt(4)
  v_mfma_f32_32x32x16_bf16 v[192:207], a[72:75], v[24:27], v[192:207]
  ds_read_b64_tr_b16 a[88:89], v210 offset:20480
  ds_read_b64_tr_b16 a[90:91], v210 offset:20992
  v_mul_f32 v230, v165, v165
  v_mul_f32 v225, v166, v166
  v_mul_f32 v226, v167, v167
  v_fmaak_f32 v229, v229, v223, 0xc0135761
  v_mfma_f32_32x32x16_bf16 v[192:207], a[76:79], v[28:31], v[192:207]
  ds_read_b64_tr_b16 a[92:93], v210 offset:22528
  ds_read_b64_tr_b16 a[94:95], v210 offset:23040
  v_fmaak_f32 v230, v230, v223, 0xc0135761
  v_fmaak_f32 v225, v225, v223, 0xc0135761
  v_fmaak_f32 v226, v226, v223, 0xc0135761
  s_waitcnt lgkmcnt(4)
  v_mfma_f32_32x32x16_bf16 v[192:207], a[80:83], v[32:35], v[192:207]
  ds_read_b64_tr_b16 a[72:73], v210 offset:24576
  ds_read_b64_tr_b16 a[74:75], v210 offset:25088
  v_mul_f32 v229, v229, v164
  v_mul_f32 v230, v230, v165
  v_mul_f32 v225, v225, v166
  v_mul_f32 v226, v226, v167
  v_mfma_f32_32x32x16_bf16 v[192:207], a[84:87], v[36:39], v[192:207]
  ds_read_b64_tr_b16 a[76:77], v210 offset:26624
  ds_read_b64_tr_b16 a[78:79], v210 offset:27136
  v_exp_f32 v229, v229
  v_mul_f32 v145, v145, v177
  s_waitcnt lgkmcnt(4)
  v_mfma_f32_32x32x16_bf16 v[192:207], a[88:91], v[40:43], v[192:207]
  ds_read_b64_tr_b16 a[80:81], v210 offset:28672
  ds_read_b64_tr_b16 a[82:83], v210 offset:29184
  v_exp_f32 v230, v230
  v_exp_f32 v225, v225
  v_mfma_f32_32x32x16_bf16 v[192:207], a[92:95], v[44:47], v[192:207]
  ds_read_b64_tr_b16 a[84:85], v210 offset:30720
  ds_read_b64_tr_b16 a[86:87], v210 offset:31232
  v_exp_f32 v226, v226
  v_add_f32 v229, 1.0, v229
  s_waitcnt lgkmcnt(4)
  v_mfma_f32_32x32x16_bf16 v[192:207], a[72:75], v[48:51], v[192:207]
  ds_read_b64_tr_b16 a[88:89], v210 offset:32768
  ds_read_b64_tr_b16 a[90:91], v210 offset:33280
  v_add_f32 v230, 1.0, v230
  v_add_f32 v225, 1.0, v225
  v_add_f32 v226, 1.0, v226
  s_add_u32 s70, s70, s101
  v_mfma_f32_32x32x16_bf16 v[192:207], a[76:79], v[52:55], v[192:207]
  ds_read_b64_tr_b16 a[92:93], v210 offset:34816
  ds_read_b64_tr_b16 a[94:95], v210 offset:35328
  v_rcp_f32 v229, v229
  s_xor_b32 s69, s99, 1
  s_waitcnt lgkmcnt(4)
  v_mfma_f32_32x32x16_bf16 v[192:207], a[80:83], v[56:59], v[192:207]
  ds_read_b64_tr_b16 a[72:73], v210 offset:36864
  ds_read_b64_tr_b16 a[74:75], v210 offset:37376
  s_lshl_b32 s69, s69, 9
  v_rcp_f32 v230, v230
  s_add_u32 s70, s70, s69
  buffer_load_dword v249, v248, s[20:23], s70 offen
  buffer_load_dword v249, v248, s[24:27], s70 offen
  v_mfma_f32_32x32x16_bf16 v[192:207], a[84:87], v[60:63], v[192:207]
  ds_read_b64_tr_b16 a[76:77], v210 offset:38912
  ds_read_b64_tr_b16 a[78:79], v210 offset:39424
  v_rcp_f32 v225, v225
  v_cvt_pk_bf16_f32 v231, v144, v145
  s_waitcnt lgkmcnt(4)
  v_mfma_f32_32x32x16_bf16 v[192:207], a[88:91], v[64:67], v[192:207]
  ds_read_b64_tr_b16 a[80:81], v210 offset:40960
  ds_read_b64_tr_b16 a[82:83], v210 offset:41472
  v_rcp_f32 v226, v226
  v_mul_f32 v164, v164, v229
  v_mul_f32 v165, v165, v230
  v_mfma_f32_32x32x16_bf16 v[192:207], a[92:95], v[68:71], v[192:207]
  s_waitcnt vmcnt(21)
  s_barrier
  ds_read_b64_tr_b16 a[84:85], v210 offset:43008
  ds_read_b64_tr_b16 a[86:87], v210 offset:43520
  s_add_u32 m0, s72, 0
  s_add_u32 s71, s75, 384
  v_mov_b32 v255, 4
  buffer_store_dword v255, v253, s[40:43], s65 offen sc1
  s_waitcnt lgkmcnt(4)
  v_mfma_f32_32x32x16_bf16 v[192:207], a[72:75], v[72:75], v[192:207]
  ds_read_b64_tr_b16 a[88:89], v210 offset:45056
  ds_read_b64_tr_b16 a[90:91], v210 offset:45568
  buffer_load_dwordx4 v215, s[24:27], s71 offen offset:0 lds
  v_mul_f32 v166, v166, v225
  v_mul_f32 v167, v167, v226
  v_mfma_f32_32x32x16_bf16 v[192:207], a[76:79], v[76:79], v[192:207]
  ds_read_b64_tr_b16 a[92:93], v210 offset:47104
  ds_read_b64_tr_b16 a[94:95], v210 offset:47616
  v_mul_f32 v229, v168, v168
  v_mul_f32 v230, v169, v169
  v_mul_f32 v225, v170, v170
  s_waitcnt lgkmcnt(4)
  v_mfma_f32_32x32x16_bf16 v[192:207], a[80:83], v[80:83], v[192:207]
  ds_read_b64_tr_b16 a[72:73], v210 offset:49152
  ds_read_b64_tr_b16 a[74:75], v210 offset:49664
  v_mul_f32 v226, v171, v171
  v_fmaak_f32 v229, v229, v223, 0xc0135761
  v_fmaak_f32 v230, v230, v223, 0xc0135761
  v_fmaak_f32 v225, v225, v223, 0xc0135761
  v_mfma_f32_32x32x16_bf16 v[192:207], a[84:87], v[84:87], v[192:207]
  ds_read_b64_tr_b16 a[76:77], v210 offset:51200
  ds_read_b64_tr_b16 a[78:79], v210 offset:51712
  buffer_load_dwordx4 v216, s[24:27], s71 offen offset:1024 lds
  v_fmaak_f32 v226, v226, v223, 0xc0135761
  v_mul_f32 v229, v229, v168
  s_waitcnt lgkmcnt(4)
  v_mfma_f32_32x32x16_bf16 v[192:207], a[88:91], v[88:91], v[192:207]
  ds_read_b64_tr_b16 a[80:81], v210 offset:53248
  ds_read_b64_tr_b16 a[82:83], v210 offset:53760
  v_mul_f32 v230, v230, v169
  v_mul_f32 v225, v225, v170
  v_mul_f32 v226, v226, v171
  v_exp_f32 v229, v229
  v_mfma_f32_32x32x16_bf16 v[192:207], a[92:95], v[92:95], v[192:207]
  ds_read_b64_tr_b16 a[84:85], v210 offset:55296
  ds_read_b64_tr_b16 a[86:87], v210 offset:55808
  v_exp_f32 v230, v230
  v_accvgpr_write_b32 a32, v231
  s_waitcnt lgkmcnt(4)
  v_mfma_f32_32x32x16_bf16 v[192:207], a[72:75], v[96:99], v[192:207]
  ds_read_b64_tr_b16 a[88:89], v210 offset:57344
  ds_read_b64_tr_b16 a[90:91], v210 offset:57856
  buffer_load_dwordx4 v217, s[24:27], s71 offen offset:2048 lds
  v_exp_f32 v225, v225
  v_exp_f32 v226, v226
  v_mfma_f32_32x32x16_bf16 v[192:207], a[76:79], v[100:103], v[192:207]
  ds_read_b64_tr_b16 a[92:93], v210 offset:59392
  ds_read_b64_tr_b16 a[94:95], v210 offset:59904
  v_add_f32 v229, 1.0, v229
  v_add_f32 v230, 1.0, v230
  v_add_f32 v225, 1.0, v225
  s_waitcnt lgkmcnt(4)
  v_mfma_f32_32x32x16_bf16 v[192:207], a[80:83], v[104:107], v[192:207]
  ds_read_b64_tr_b16 a[72:73], v210 offset:61440
  ds_read_b64_tr_b16 a[74:75], v210 offset:61952
  s_add_u32 m0, s72, 12288
  s_add_u32 s71, s75, 885120
  v_add_f32 v226, 1.0, v226
  v_rcp_f32 v229, v229
  v_mul_f32 v146, v146, v178
  v_mfma_f32_32x32x16_bf16 v[192:207], a[84:87], v[108:111], v[192:207]
  ds_read_b64_tr_b16 a[76:77], v210 offset:63488
  ds_read_b64_tr_b16 a[78:79], v210 offset:64000
  buffer_load_dwordx4 v215, s[24:27], s71 offen offset:0 lds
  v_mul_f32 v147, v147, v179
  v_rcp_f32 v230, v230
  s_waitcnt lgkmcnt(4)
  v_mfma_f32_32x32x16_bf16 v[192:207], a[88:91], v[112:115], v[192:207]
  v_add_u32 v210, 65536, v212
  ds_read_b64_tr_b16 a[80:81], v210 offset:0
  ds_read_b64_tr_b16 a[82:83], v210 offset:512
  v_cvt_pk_bf16_f32 v232, v146, v147
  v_accvgpr_write_b32 a33, v232
  v_rcp_f32 v225, v225
  v_mul_f32 v148, v148, v180
  v_mfma_f32_32x32x16_bf16 v[192:207], a[92:95], v[116:119], v[192:207]
  ds_read_b64_tr_b16 a[84:85], v210 offset:2048
  ds_read_b64_tr_b16 a[86:87], v210 offset:2560
  v_mul_f32 v149, v149, v181
  v_cvt_pk_bf16_f32 v231, v148, v149
  v_rcp_f32 v226, v226
  v_accvgpr_write_b32 a34, v231
  s_waitcnt lgkmcnt(4)
  v_mfma_f32_32x32x16_bf16 v[192:207], a[72:75], v[120:123], v[192:207]
  ds_read_b64_tr_b16 a[88:89], v210 offset:4096
  ds_read_b64_tr_b16 a[90:91], v210 offset:4608
  buffer_load_dwordx4 v216, s[24:27], s71 offen offset:1024 lds
  v_mul_f32 v150, v150, v182
  v_mul_f32 v151, v151, v183
  v_mul_f32 v168, v168, v229
  v_cvt_pk_bf16_f32 v232, v150, v151
  v_mfma_f32_32x32x16_bf16 v[192:207], a[76:79], v[124:127], v[192:207]
  ds_read_b64_tr_b16 a[92:93], v210 offset:6144
  ds_read_b64_tr_b16 a[94:95], v210 offset:6656
  v_accvgpr_write_b32 a35, v232
  s_add_u32 s81, s60, 8192
  v_mul_f32 v169, v169, v230
  v_mul_f32 v170, v170, v225
  buffer_store_dwordx4 a[32:35], v224, s[40:43], s81 offen sc1
  s_waitcnt lgkmcnt(4)
  v_mfma_f32_32x32x16_bf16 v[192:207], a[80:83], v[128:131], v[192:207]
  ds_read_b64_tr_b16 a[72:73], v209 offset:8192
  ds_read_b64_tr_b16 a[74:75], v209 offset:8704
  v_mul_f32 v152, v152, v184
  v_mul_f32 v153, v153, v185
  v_cvt_pk_bf16_f32 v231, v152, v153
  v_mul_f32 v171, v171, v226
  v_mul_f32 v229, v172, v172
  v_mul_f32 v230, v173, v173
  v_mfma_f32_32x32x16_bf16 v[192:207], a[84:87], v[132:135], v[192:207]
  ds_read_b64_tr_b16 a[76:77], v209 offset:10240
  ds_read_b64_tr_b16 a[78:79], v209 offset:10752
  buffer_load_dwordx4 v217, s[24:27], s71 offen offset:2048 lds
  v_accvgpr_write_b32 a36, v231
  v_mul_f32 v154, v154, v186
  v_mul_f32 v155, v155, v187
  s_waitcnt lgkmcnt(4)
  v_mfma_f32_32x32x16_bf16 v[192:207], a[88:91], v[136:139], v[192:207]
  ds_read_b64_tr_b16 a[80:81], v209 offset:12288
  ds_read_b64_tr_b16 a[82:83], v209 offset:12800
  v_cvt_pk_bf16_f32 v232, v154, v155
  v_accvgpr_write_b32 a37, v232
  v_mul_f32 v156, v156, v188
  v_mul_f32 v157, v157, v189
  v_cvt_pk_bf16_f32 v231, v156, v157
  v_accvgpr_write_b32 a38, v231
  v_mul_f32 v158, v158, v190
  v_mul_f32 v159, v159, v191
  v_cvt_pk_bf16_f32 v232, v158, v159
  v_accvgpr_write_b32 a39, v232
  s_add_u32 s81, s60, 9216
  buffer_store_dwordx4 a[36:39], v224, s[40:43], s81 offen sc1
  v_mfma_f32_32x32x16_bf16 v[192:207], a[92:95], v[140:143], v[192:207]
  s_waitcnt vmcnt(21)
  s_barrier
  ds_read_b64_tr_b16 a[84:85], v209 offset:14336
  ds_read_b64_tr_b16 a[86:87], v209 offset:14848
  s_add_u32 m0, s72, 24576
  s_add_u32 s71, s75, 1769856
  s_waitcnt lgkmcnt(4)
  v_mfma_f32_32x32x16_bf16 v[144:159], a[72:75], v[0:3], 0
  ds_read_b64_tr_b16 a[88:89], v209 offset:16384
  ds_read_b64_tr_b16 a[90:91], v209 offset:16896
  buffer_load_dwordx4 v215, s[24:27], s71 offen offset:0 lds
  v_mul_f32 v225, v174, v174
  v_mul_f32 v226, v175, v175
  v_fmaak_f32 v229, v229, v223, 0xc0135761
  v_fmaak_f32 v230, v230, v223, 0xc0135761
  v_mfma_f32_32x32x16_bf16 v[144:159], a[76:79], v[4:7], v[144:159]
  ds_read_b64_tr_b16 a[92:93], v209 offset:18432
  ds_read_b64_tr_b16 a[94:95], v209 offset:18944
  v_fmaak_f32 v225, v225, v223, 0xc0135761
  v_fmaak_f32 v226, v226, v223, 0xc0135761
  v_mul_f32 v229, v229, v172
  v_mul_f32 v230, v230, v173
  v_mul_f32 v225, v225, v174
  s_waitcnt lgkmcnt(4)
  v_mfma_f32_32x32x16_bf16 v[144:159], a[80:83], v[8:11], v[144:159]
  ds_read_b64_tr_b16 a[72:73], v209 offset:20480
  ds_read_b64_tr_b16 a[74:75], v209 offset:20992
  v_mul_f32 v226, v226, v175
  v_exp_f32 v229, v229
  v_exp_f32 v230, v230
  v_exp_f32 v225, v225
  v_exp_f32 v226, v226
  v_add_f32 v229, 1.0, v229
  v_add_f32 v230, 1.0, v230
  v_add_f32 v225, 1.0, v225
  v_add_f32 v226, 1.0, v226
  v_rcp_f32 v229, v229
  v_rcp_f32 v230, v230
  v_rcp_f32 v225, v225
  v_rcp_f32 v226, v226
  v_mul_f32 v172, v172, v229
  v_mul_f32 v173, v173, v230
  v_mul_f32 v174, v174, v225
  v_mul_f32 v175, v175, v226
  v_mfma_f32_32x32x16_bf16 v[144:159], a[84:87], v[12:15], v[144:159]
  ds_read_b64_tr_b16 a[76:77], v209 offset:22528
  ds_read_b64_tr_b16 a[78:79], v209 offset:23040
  buffer_load_dwordx4 v216, s[24:27], s71 offen offset:1024 lds
  v_add_u32 v221, 292864, v219
  s_waitcnt lgkmcnt(4)
  v_mfma_f32_32x32x16_bf16 v[144:159], a[88:91], v[16:19], v[144:159]
  ds_read_b64_tr_b16 a[80:81], v209 offset:24576
  ds_read_b64_tr_b16 a[82:83], v209 offset:25088
  v_mul_f32 v160, v160, v192
  v_mul_f32 v161, v161, v193
  v_lshrrev_b32 v245, 2, v208
  v_and_b32 v246, 3, v208
  v_mfma_f32_32x32x16_bf16 v[144:159], a[92:95], v[20:23], v[144:159]
  ds_read_b64_tr_b16 a[84:85], v209 offset:26624
  ds_read_b64_tr_b16 a[86:87], v209 offset:27136
  v_cvt_pk_bf16_f32 v231, v160, v161
  v_mul_u32_u24 v245, 1152, v245
  v_lshl_add_u32 v218, v246, 4, v245
  s_waitcnt lgkmcnt(4)
  v_mfma_f32_32x32x16_bf16 v[144:159], a[72:75], v[24:27], v[144:159]
  ds_read_b64_tr_b16 a[88:89], v209 offset:28672
  ds_read_b64_tr_b16 a[90:91], v209 offset:29184
  buffer_load_dwordx4 v217, s[24:27], s71 offen offset:2048 lds
  v_accvgpr_write_b32 a40, v231
  v_mfma_f32_32x32x16_bf16 v[144:159], a[76:79], v[28:31], v[144:159]
  ds_read_b64_tr_b16 a[92:93], v209 offset:30720
  ds_read_b64_tr_b16 a[94:95], v209 offset:31232
  v_mul_f32 v162, v162, v194
  s_waitcnt lgkmcnt(4)
  v_mfma_f32_32x32x16_bf16 v[144:159], a[80:83], v[32:35], v[144:159]
  ds_read_b64_tr_b16 a[72:73], v209 offset:32768
  ds_read_b64_tr_b16 a[74:75], v209 offset:33280
  s_add_u32 m0, s72, 36864
  s_add_u32 s71, s75, 2654592
  v_mul_f32 v163, v163, v195
  v_mfma_f32_32x32x16_bf16 v[144:159], a[84:87], v[36:39], v[144:159]
  ds_read_b64_tr_b16 a[76:77], v209 offset:34816
  ds_read_b64_tr_b16 a[78:79], v209 offset:35328
  buffer_load_dwordx4 v215, s[24:27], s71 offen offset:0 lds
  v_cvt_pk_bf16_f32 v232, v162, v163
  s_waitcnt lgkmcnt(4)
  v_mfma_f32_32x32x16_bf16 v[144:159], a[88:91], v[40:43], v[144:159]
  ds_read_b64_tr_b16 a[80:81], v209 offset:36864
  ds_read_b64_tr_b16 a[82:83], v209 offset:37376
  v_accvgpr_write_b32 a41, v232
  v_mul_f32 v164, v164, v196
  v_mfma_f32_32x32x16_bf16 v[144:159], a[92:95], v[44:47], v[144:159]
  ds_read_b64_tr_b16 a[84:85], v209 offset:38912
  ds_read_b64_tr_b16 a[86:87], v209 offset:39424
  v_mul_f32 v165, v165, v197
  s_waitcnt lgkmcnt(4)
  v_mfma_f32_32x32x16_bf16 v[144:159], a[72:75], v[48:51], v[144:159]
  ds_read_b64_tr_b16 a[88:89], v209 offset:40960
  ds_read_b64_tr_b16 a[90:91], v209 offset:41472
  buffer_load_dwordx4 v216, s[24:27], s71 offen offset:1024 lds
  v_cvt_pk_bf16_f32 v231, v164, v165
  v_mfma_f32_32x32x16_bf16 v[144:159], a[76:79], v[52:55], v[144:159]
  ds_read_b64_tr_b16 a[92:93], v209 offset:43008
  ds_read_b64_tr_b16 a[94:95], v209 offset:43520
  v_accvgpr_write_b32 a42, v231
  s_waitcnt lgkmcnt(4)
  v_mfma_f32_32x32x16_bf16 v[144:159], a[80:83], v[56:59], v[144:159]
  ds_read_b64_tr_b16 a[72:73], v209 offset:45056
  ds_read_b64_tr_b16 a[74:75], v209 offset:45568
  v_mul_f32 v166, v166, v198
  v_mul_f32 v167, v167, v199
  v_mfma_f32_32x32x16_bf16 v[144:159], a[84:87], v[60:63], v[144:159]
  ds_read_b64_tr_b16 a[76:77], v209 offset:47104
  ds_read_b64_tr_b16 a[78:79], v209 offset:47616
  buffer_load_dwordx4 v217, s[24:27], s71 offen offset:2048 lds
  v_cvt_pk_bf16_f32 v232, v166, v167
  s_waitcnt lgkmcnt(4)
  v_mfma_f32_32x32x16_bf16 v[144:159], a[88:91], v[64:67], v[144:159]
  ds_read_b64_tr_b16 a[80:81], v209 offset:49152
  ds_read_b64_tr_b16 a[82:83], v209 offset:49664
  v_accvgpr_write_b32 a43, v232
  v_mfma_f32_32x32x16_bf16 v[144:159], a[92:95], v[68:71], v[144:159]
  s_waitcnt vmcnt(17)
  s_barrier
  ds_read_b64_tr_b16 a[84:85], v209 offset:51200
  ds_read_b64_tr_b16 a[86:87], v209 offset:51712
  s_add_u32 m0, s72, 49152
  s_add_u32 s71, s75, 3539328
  s_waitcnt lgkmcnt(4)
  v_mfma_f32_32x32x16_bf16 v[144:159], a[72:75], v[72:75], v[144:159]
  ds_read_b64_tr_b16 a[88:89], v209 offset:53248
  ds_read_b64_tr_b16 a[90:91], v209 offset:53760
  buffer_load_dwordx4 v215, s[24:27], s71 offen offset:0 lds
  s_add_u32 s81, s60, 10240
  buffer_store_dwordx4 a[40:43], v224, s[40:43], s81 offen sc1
  v_mfma_f32_32x32x16_bf16 v[144:159], a[76:79], v[76:79], v[144:159]
  ds_read_b64_tr_b16 a[92:93], v209 offset:55296
  ds_read_b64_tr_b16 a[94:95], v209 offset:55808
  v_mul_f32 v168, v168, v200
  v_mul_f32 v169, v169, v201
  s_waitcnt lgkmcnt(4)
  v_mfma_f32_32x32x16_bf16 v[144:159], a[80:83], v[80:83], v[144:159]
  ds_read_b64_tr_b16 a[72:73], v209 offset:57344
  ds_read_b64_tr_b16 a[74:75], v209 offset:57856
  v_cvt_pk_bf16_f32 v231, v168, v169
  v_mfma_f32_32x32x16_bf16 v[144:159], a[84:87], v[84:87], v[144:159]
  ds_read_b64_tr_b16 a[76:77], v209 offset:59392
  ds_read_b64_tr_b16 a[78:79], v209 offset:59904
  buffer_load_dwordx4 v216, s[24:27], s71 offen offset:1024 lds
  v_accvgpr_write_b32 a44, v231
  s_waitcnt lgkmcnt(4)
  v_mfma_f32_32x32x16_bf16 v[144:159], a[88:91], v[88:91], v[144:159]
  ds_read_b64_tr_b16 a[80:81], v209 offset:61440
  ds_read_b64_tr_b16 a[82:83], v209 offset:61952
  v_mul_f32 v170, v170, v202
  v_mfma_f32_32x32x16_bf16 v[144:159], a[92:95], v[92:95], v[144:159]
  ds_read_b64_tr_b16 a[84:85], v209 offset:63488
  ds_read_b64_tr_b16 a[86:87], v209 offset:64000
  v_mul_f32 v171, v171, v203
  s_waitcnt lgkmcnt(4)
  v_mfma_f32_32x32x16_bf16 v[144:159], a[72:75], v[96:99], v[144:159]
  v_add_u32 v209, 131072, v211
  ds_read_b64_tr_b16 a[88:89], v209 offset:0
  ds_read_b64_tr_b16 a[90:91], v209 offset:512
  buffer_load_dwordx4 v217, s[24:27], s71 offen offset:2048 lds
  v_cvt_pk_bf16_f32 v232, v170, v171
  v_mfma_f32_32x32x16_bf16 v[144:159], a[76:79], v[100:103], v[144:159]
  ds_read_b64_tr_b16 a[92:93], v209 offset:2048
  ds_read_b64_tr_b16 a[94:95], v209 offset:2560
  v_accvgpr_write_b32 a45, v232
  v_mul_f32 v172, v172, v204
  s_waitcnt lgkmcnt(4)
  v_mfma_f32_32x32x16_bf16 v[144:159], a[80:83], v[104:107], v[144:159]
  ds_read_b64_tr_b16 a[72:73], v209 offset:4096
  ds_read_b64_tr_b16 a[74:75], v209 offset:4608
  s_add_u32 m0, s72, 61440
  s_add_u32 s71, s75, 4424064
  v_mul_f32 v173, v173, v205
  v_mfma_f32_32x32x16_bf16 v[144:159], a[84:87], v[108:111], v[144:159]
  ds_read_b64_tr_b16 a[76:77], v209 offset:6144
  ds_read_b64_tr_b16 a[78:79], v209 offset:6656
  buffer_load_dwordx4 v215, s[24:27], s71 offen offset:0 lds
  v_cvt_pk_bf16_f32 v231, v172, v173
  s_waitcnt lgkmcnt(4)
  v_mfma_f32_32x32x16_bf16 v[144:159], a[88:91], v[112:115], v[144:159]
  ds_read_b64_tr_b16 a[80:81], v209 offset:8192
  ds_read_b64_tr_b16 a[82:83], v209 offset:8704
  v_accvgpr_write_b32 a46, v231
  v_mfma_f32_32x32x16_bf16 v[144:159], a[92:95], v[116:119], v[144:159]
  ds_read_b64_tr_b16 a[84:85], v209 offset:10240
  ds_read_b64_tr_b16 a[86:87], v209 offset:10752
  v_mul_f32 v174, v174, v206
  v_mul_f32 v175, v175, v207
  s_waitcnt lgkmcnt(4)
  v_mfma_f32_32x32x16_bf16 v[144:159], a[72:75], v[120:123], v[144:159]
  ds_read_b64_tr_b16 a[88:89], v209 offset:12288
  ds_read_b64_tr_b16 a[90:91], v209 offset:12800
  buffer_load_dwordx4 v216, s[24:27], s71 offen offset:1024 lds
  buffer_load_dword v251, v252, s[40:43], s67 offen sc1
  v_cvt_pk_bf16_f32 v232, v174, v175
  v_mfma_f32_32x32x16_bf16 v[144:159], a[76:79], v[124:127], v[144:159]
  ds_read_b64_tr_b16 a[92:93], v209 offset:14336
  ds_read_b64_tr_b16 a[94:95], v209 offset:14848
  v_accvgpr_write_b32 a47, v232
  s_waitcnt lgkmcnt(4)
  v_mfma_f32_32x32x16_bf16 v[144:159], a[80:83], v[128:131], v[144:159]
  ds_read_b64_tr_b16 a[72:73], v210 offset:8192
  ds_read_b64_tr_b16 a[74:75], v210 offset:8704
  s_add_u32 s81, s60, 11264
  v_mfma_f32_32x32x16_bf16 v[144:159], a[84:87], v[132:135], v[144:159]
  ds_read_b64_tr_b16 a[76:77], v210 offset:10240
  ds_read_b64_tr_b16 a[78:79], v210 offset:10752
  buffer_load_dwordx4 v217, s[24:27], s71 offen offset:2048 lds
  buffer_store_dwordx4 a[44:47], v224, s[40:43], s81 offen sc1
  s_waitcnt lgkmcnt(4)
  v_mfma_f32_32x32x16_bf16 v[144:159], a[88:91], v[136:139], v[144:159]
  ds_read_b64_tr_b16 a[80:81], v210 offset:12288
  ds_read_b64_tr_b16 a[82:83], v210 offset:12800
  v_lshrrev_b32 v245, 3, v208
  v_mfma_f32_32x32x16_bf16 v[144:159], a[92:95], v[140:143], v[144:159]
  ds_read_b64_tr_b16 a[84:85], v210 offset:14336
  ds_read_b64_tr_b16 a[86:87], v210 offset:14848
  s_waitcnt lgkmcnt(4)
  v_mfma_f32_32x32x16_bf16 v[160:175], a[72:75], v[0:3], 0
  ds_read_b64_tr_b16 a[88:89], v210 offset:16384
  ds_read_b64_tr_b16 a[90:91], v210 offset:16896
  v_mfma_f32_32x32x16_bf16 v[160:175], a[76:79], v[4:7], v[160:175]
  ds_read_b64_tr_b16 a[92:93], v210 offset:18432
  ds_read_b64_tr_b16 a[94:95], v210 offset:18944
  s_waitcnt lgkmcnt(4)
  v_mfma_f32_32x32x16_bf16 v[160:175], a[80:83], v[8:11], v[160:175]
  ds_read_b64_tr_b16 a[72:73], v210 offset:20480
  ds_read_b64_tr_b16 a[74:75], v210 offset:20992
  v_mfma_f32_32x32x16_bf16 v[160:175], a[84:87], v[12:15], v[160:175]
  ds_read_b64_tr_b16 a[76:77], v210 offset:22528
  ds_read_b64_tr_b16 a[78:79], v210 offset:23040
  v_mul_f32 v229, v144, v144
  v_mul_f32 v230, v145, v145
  v_mul_f32 v225, v146, v146
  s_waitcnt lgkmcnt(4)
  v_mfma_f32_32x32x16_bf16 v[160:175], a[88:91], v[16:19], v[160:175]
  ds_read_b64_tr_b16 a[80:81], v210 offset:24576
  ds_read_b64_tr_b16 a[82:83], v210 offset:25088
  v_mul_f32 v226, v147, v147
  v_fmaak_f32 v229, v229, v223, 0xc0135761
  v_fmaak_f32 v230, v230, v223, 0xc0135761
  v_mfma_f32_32x32x16_bf16 v[160:175], a[92:95], v[20:23], v[160:175]
  ds_read_b64_tr_b16 a[84:85], v210 offset:26624
  ds_read_b64_tr_b16 a[86:87], v210 offset:27136
  v_fmaak_f32 v225, v225, v223, 0xc0135761
  v_fmaak_f32 v226, v226, v223, 0xc0135761
  s_waitcnt lgkmcnt(4)
  v_mfma_f32_32x32x16_bf16 v[160:175], a[72:75], v[24:27], v[160:175]
  ds_read_b64_tr_b16 a[88:89], v210 offset:28672
  ds_read_b64_tr_b16 a[90:91], v210 offset:29184
  v_mul_f32 v229, v229, v144
  v_mul_f32 v230, v230, v145
  v_mul_f32 v225, v225, v146
  v_mfma_f32_32x32x16_bf16 v[160:175], a[76:79], v[28:31], v[160:175]
  ds_read_b64_tr_b16 a[92:93], v210 offset:30720
  ds_read_b64_tr_b16 a[94:95], v210 offset:31232
  v_mul_f32 v226, v226, v147
  v_exp_f32 v229, v229
  s_waitcnt lgkmcnt(4)
  v_mfma_f32_32x32x16_bf16 v[160:175], a[80:83], v[32:35], v[160:175]
  ds_read_b64_tr_b16 a[72:73], v210 offset:32768
  ds_read_b64_tr_b16 a[74:75], v210 offset:33280
  v_exp_f32 v230, v230
  v_and_b32 v246, 7, v208
  v_mfma_f32_32x32x16_bf16 v[160:175], a[84:87], v[36:39], v[160:175]
  ds_read_b64_tr_b16 a[76:77], v210 offset:34816
  ds_read_b64_tr_b16 a[78:79], v210 offset:35328
  v_exp_f32 v225, v225
  s_waitcnt lgkmcnt(4)
  v_mfma_f32_32x32x16_bf16 v[160:175], a[88:91], v[40:43], v[160:175]
  ds_read_b64_tr_b16 a[80:81], v210 offset:36864
  ds_read_b64_tr_b16 a[82:83], v210 offset:37376
  v_exp_f32 v226, v226
  v_add_f32 v229, 1.0, v229
  v_mfma_f32_32x32x16_bf16 v[160:175], a[92:95], v[44:47], v[160:175]
  ds_read_b64_tr_b16 a[84:85], v210 offset:38912
  ds_read_b64_tr_b16 a[86:87], v210 offset:39424
  v_add_f32 v230, 1.0, v230
  v_add_f32 v225, 1.0, v225
  s_waitcnt lgkmcnt(4)
  v_mfma_f32_32x32x16_bf16 v[160:175], a[72:75], v[48:51], v[160:175]
  ds_read_b64_tr_b16 a[88:89], v210 offset:40960
  ds_read_b64_tr_b16 a[90:91], v210 offset:41472
  v_add_f32 v226, 1.0, v226
  v_rcp_f32 v229, v229
  v_mfma_f32_32x32x16_bf16 v[160:175], a[76:79], v[52:55], v[160:175]
  ds_read_b64_tr_b16 a[92:93], v210 offset:43008
  ds_read_b64_tr_b16 a[94:95], v210 offset:43520
  v_rcp_f32 v230, v230
  s_waitcnt lgkmcnt(4)
  v_mfma_f32_32x32x16_bf16 v[160:175], a[80:83], v[56:59], v[160:175]
  ds_read_b64_tr_b16 a[72:73], v210 offset:45056
  ds_read_b64_tr_b16 a[74:75], v210 offset:45568
  v_rcp_f32 v225, v225
  v_rcp_f32 v226, v226
  v_mfma_f32_32x32x16_bf16 v[160:175], a[84:87], v[60:63], v[160:175]
  ds_read_b64_tr_b16 a[76:77], v210 offset:47104
  ds_read_b64_tr_b16 a[78:79], v210 offset:47616
  v_mul_f32 v144, v144, v229
  s_waitcnt lgkmcnt(4)
  v_mfma_f32_32x32x16_bf16 v[160:175], a[88:91], v[64:67], v[160:175]
  ds_read_b64_tr_b16 a[80:81], v210 offset:49152
  ds_read_b64_tr_b16 a[82:83], v210 offset:49664
  v_mul_f32 v145, v145, v230
  v_mul_f32 v146, v146, v225
  v_mul_f32 v147, v147, v226
  v_mfma_f32_32x32x16_bf16 v[160:175], a[92:95], v[68:71], v[160:175]
  s_waitcnt vmcnt(20)
  s_barrier
  ds_read_b64_tr_b16 a[84:85], v210 offset:51200
  ds_read_b64_tr_b16 a[86:87], v210 offset:51712
  s_add_u32 m0, s72, 73728
  s_add_u32 s71, s76, 0
  s_waitcnt lgkmcnt(4)
  v_mfma_f32_32x32x16_bf16 v[160:175], a[72:75], v[72:75], v[160:175]
  ds_read_b64_tr_b16 a[88:89], v210 offset:53248
  ds_read_b64_tr_b16 a[90:91], v210 offset:53760
  buffer_load_dwordx4 v219, s[20:23], s71 offen offset:0 lds
  v_mul_f32 v229, v148, v148
  v_mul_f32 v230, v149, v149
  v_mfma_f32_32x32x16_bf16 v[160:175], a[76:79], v[76:79], v[160:175]
  ds_read_b64_tr_b16 a[92:93], v210 offset:55296
  ds_read_b64_tr_b16 a[94:95], v210 offset:55808
  v_mul_f32 v225, v150, v150
  v_mul_f32 v226, v151, v151
  v_fmaak_f32 v229, v229, v223, 0xc0135761
  s_waitcnt lgkmcnt(4)
  v_mfma_f32_32x32x16_bf16 v[160:175], a[80:83], v[80:83], v[160:175]
  ds_read_b64_tr_b16 a[72:73], v210 offset:57344
  ds_read_b64_tr_b16 a[74:75], v210 offset:57856
  v_fmaak_f32 v230, v230, v223, 0xc0135761
  v_fmaak_f32 v225, v225, v223, 0xc0135761
  v_fmaak_f32 v226, v226, v223, 0xc0135761
  v_mul_f32 v229, v229, v148
  v_mfma_f32_32x32x16_bf16 v[160:175], a[84:87], v[84:87], v[160:175]
  ds_read_b64_tr_b16 a[76:77], v210 offset:59392
  ds_read_b64_tr_b16 a[78:79], v210 offset:59904
  buffer_load_dwordx4 v220, s[20:23], s71 offen offset:1024 lds
  v_mul_f32 v230, v230, v149
  s_waitcnt lgkmcnt(4)
  v_mfma_f32_32x32x16_bf16 v[160:175], a[88:91], v[88:91], v[160:175]
  ds_read_b64_tr_b16 a[80:81], v210 offset:61440
  ds_read_b64_tr_b16 a[82:83], v210 offset:61952
  v_mul_f32 v225, v225, v150
  v_mul_f32 v226, v226, v151
  v_exp_f32 v229, v229
  v_mfma_f32_32x32x16_bf16 v[160:175], a[92:95], v[92:95], v[160:175]
  ds_read_b64_tr_b16 a[84:85], v210 offset:63488
  ds_read_b64_tr_b16 a[86:87], v210 offset:64000
  v_exp_f32 v230, v230
  v_bfe_u32 v215, v245, 1, 1
  s_waitcnt lgkmcnt(4)
  v_mfma_f32_32x32x16_bf16 v[160:175], a[72:75], v[96:99], v[160:175]
  v_add_u32 v210, 131072, v212
  ds_read_b64_tr_b16 a[88:89], v210 offset:0
  ds_read_b64_tr_b16 a[90:91], v210 offset:512
  buffer_load_dwordx4 v221, s[20:23], s71 offen offset:2048 lds
  v_mfma_f32_32x32x16_bf16 v[160:175], a[76:79], v[100:103], v[160:175]
  ds_read_b64_tr_b16 a[92:93], v210 offset:2048
  ds_read_b64_tr_b16 a[94:95], v210 offset:2560
  v_exp_f32 v225, v225
  s_waitcnt lgkmcnt(4)
  v_mfma_f32_32x32x16_bf16 v[160:175], a[80:83], v[104:107], v[160:175]
  ds_read_b64_tr_b16 a[72:73], v210 offset:4096
  ds_read_b64_tr_b16 a[74:75], v210 offset:4608
  s_add_u32 m0, s72, 86016
  s_add_u32 s71, s76, 1769472
  v_exp_f32 v226, v226
  v_mfma_f32_32x32x16_bf16 v[160:175], a[84:87], v[108:111], v[160:175]
  ds_read_b64_tr_b16 a[76:77], v210 offset:6144
  ds_read_b64_tr_b16 a[78:79], v210 offset:6656
  buffer_load_dwordx4 v219, s[20:23], s71 offen offset:0 lds
  v_add_f32 v229, 1.0, v229
  s_waitcnt lgkmcnt(4)
  v_mfma_f32_32x32x16_bf16 v[160:175], a[88:91], v[112:115], v[160:175]
  ds_read_b64_tr_b16 a[80:81], v210 offset:8192
  ds_read_b64_tr_b16 a[82:83], v210 offset:8704
  v_add_f32 v230, 1.0, v230
  v_add_f32 v225, 1.0, v225
  v_add_f32 v226, 1.0, v226
  v_lshlrev_b32 v215, 2, v215
  v_mfma_f32_32x32x16_bf16 v[160:175], a[92:95], v[116:119], v[160:175]
  ds_read_b64_tr_b16 a[84:85], v210 offset:10240
  ds_read_b64_tr_b16 a[86:87], v210 offset:10752
  v_rcp_f32 v229, v229
  s_waitcnt lgkmcnt(4)
  v_mfma_f32_32x32x16_bf16 v[160:175], a[72:75], v[120:123], v[160:175]
  ds_read_b64_tr_b16 a[88:89], v210 offset:12288
  ds_read_b64_tr_b16 a[90:91], v210 offset:12800
  buffer_load_dwordx4 v220, s[20:23], s71 offen offset:1024 lds
  v_rcp_f32 v230, v230
  v_mfma_f32_32x32x16_bf16 v[160:175], a[76:79], v[124:127], v[160:175]
  ds_read_b64_tr_b16 a[92:93], v210 offset:14336
  ds_read_b64_tr_b16 a[94:95], v210 offset:14848
  v_rcp_f32 v225, v225
  s_waitcnt lgkmcnt(4)
  v_mfma_f32_32x32x16_bf16 v[160:175], a[80:83], v[128:131], v[160:175]
  v_mov_b32 v209, v211
  ds_read_b64_tr_b16 a[72:73], v209 offset:0
  ds_read_b64_tr_b16 a[74:75], v209 offset:512
  v_rcp_f32 v226, v226
  v_mul_f32 v148, v148, v229
  v_mfma_f32_32x32x16_bf16 v[160:175], a[84:87], v[132:135], v[160:175]
  ds_read_b64_tr_b16 a[76:77], v209 offset:2048
  ds_read_b64_tr_b16 a[78:79], v209 offset:2560
  buffer_load_dwordx4 v221, s[20:23], s71 offen offset:2048 lds
  v_mul_f32 v149, v149, v230
  s_waitcnt lgkmcnt(4)
  v_mfma_f32_32x32x16_bf16 v[160:175], a[88:91], v[136:139], v[160:175]
  ds_read_b64_tr_b16 a[80:81], v209 offset:4096
  ds_read_b64_tr_b16 a[82:83], v209 offset:4608
  v_mul_f32 v150, v150, v225
  v_mul_f32 v151, v151, v226
  v_mul_f32 v229, v152, v152
  v_mul_f32 v230, v153, v153
  v_mfma_f32_32x32x16_bf16 v[160:175], a[92:95], v[140:143], v[160:175]
  s_waitcnt vmcnt(15)
  s_barrier
  ds_read_b64_tr_b16 a[84:85], v209 offset:6144
  ds_read_b64_tr_b16 a[86:87], v209 offset:6656
  s_add_u32 m0, s72, 98304
  s_add_u32 s71, s76, 3538944
  s_waitcnt lgkmcnt(4)
  v_mfma_f32_32x32x16_bf16 v[176:191], a[72:75], v[0:3], 0
  ds_read_b64_tr_b16 a[88:89], v209 offset:8192
  ds_read_b64_tr_b16 a[90:91], v209 offset:8704
  buffer_load_dwordx4 v219, s[20:23], s71 offen offset:0 lds
  v_mul_f32 v225, v154, v154
  v_mul_f32 v226, v155, v155
  v_mfma_f32_32x32x16_bf16 v[176:191], a[76:79], v[4:7], v[176:191]
  ds_read_b64_tr_b16 a[92:93], v209 offset:10240
  ds_read_b64_tr_b16 a[94:95], v209 offset:10752
  v_fmaak_f32 v229, v229, v223, 0xc0135761
  v_fmaak_f32 v230, v230, v223, 0xc0135761
  v_fmaak_f32 v225, v225, v223, 0xc0135761
  s_waitcnt lgkmcnt(4)
  v_mfma_f32_32x32x16_bf16 v[176:191], a[80:83], v[8:11], v[176:191]
  ds_read_b64_tr_b16 a[72:73], v209 offset:12288
  ds_read_b64_tr_b16 a[74:75], v209 offset:12800
  v_fmaak_f32 v226, v226, v223, 0xc0135761
  v_mul_f32 v229, v229, v152
  v_mul_f32 v230, v230, v153
  v_mul_f32 v225, v225, v154
  v_mfma_f32_32x32x16_bf16 v[176:191], a[84:87], v[12:15], v[176:191]
  ds_read_b64_tr_b16 a[76:77], v209 offset:14336
  ds_read_b64_tr_b16 a[78:79], v209 offset:14848
  buffer_load_dwordx4 v220, s[20:23], s71 offen offset:1024 lds
  v_mul_f32 v226, v226, v155
  s_waitcnt lgkmcnt(4)
  v_mfma_f32_32x32x16_bf16 v[176:191], a[88:91], v[16:19], v[176:191]
  ds_read_b64_tr_b16 a[80:81], v209 offset:16384
  ds_read_b64_tr_b16 a[82:83], v209 offset:16896
  v_exp_f32 v229, v229
  v_exp_f32 v230, v230
  v_mfma_f32_32x32x16_bf16 v[176:191], a[92:95], v[20:23], v[176:191]
  ds_read_b64_tr_b16 a[84:85], v209 offset:18432
  ds_read_b64_tr_b16 a[86:87], v209 offset:18944
  v_exp_f32 v225, v225
  v_xor_b32 v246, v246, v215
  s_waitcnt lgkmcnt(4)
  v_mfma_f32_32x32x16_bf16 v[176:191], a[72:75], v[24:27], v[176:191]
  ds_read_b64_tr_b16 a[88:89], v209 offset:20480
  ds_read_b64_tr_b16 a[90:91], v209 offset:20992
  buffer_load_dwordx4 v221, s[20:23], s71 offen offset:2048 lds
  v_exp_f32 v226, v226
  v_mfma_f32_32x32x16_bf16 v[176:191], a[76:79], v[28:31], v[176:191]
  ds_read_b64_tr_b16 a[92:93], v209 offset:22528
  ds_read_b64_tr_b16 a[94:95], v209 offset:23040
  v_add_f32 v229, 1.0, v229
  v_add_f32 v230, 1.0, v230
  v_add_f32 v225, 1.0, v225
  s_waitcnt lgkmcnt(4)
  v_mfma_f32_32x32x16_bf16 v[176:191], a[80:83], v[32:35], v[176:191]
  ds_read_b64_tr_b16 a[72:73], v209 offset:24576
  ds_read_b64_tr_b16 a[74:75], v209 offset:25088
  s_add_u32 m0, s72, 110592
  s_add_u32 s71, s76, 0
  v_add_f32 v226, 1.0, v226
  v_mfma_f32_32x32x16_bf16 v[176:191], a[84:87], v[36:39], v[176:191]
  ds_read_b64_tr_b16 a[76:77], v209 offset:26624
  ds_read_b64_tr_b16 a[78:79], v209 offset:27136
  buffer_load_dwordx4 v219, s[24:27], s71 offen offset:0 lds
  s_waitcnt lgkmcnt(4)
  v_mfma_f32_32x32x16_bf16 v[176:191], a[88:91], v[40:43], v[176:191]
  ds_read_b64_tr_b16 a[80:81], v209 offset:28672
  ds_read_b64_tr_b16 a[82:83], v209 offset:29184
  v_rcp_f32 v229, v229
  v_rcp_f32 v230, v230
  v_mfma_f32_32x32x16_bf16 v[176:191], a[92:95], v[44:47], v[176:191]
  ds_read_b64_tr_b16 a[84:85], v209 offset:30720
  ds_read_b64_tr_b16 a[86:87], v209 offset:31232
  v_rcp_f32 v225, v225
  s_waitcnt lgkmcnt(4)
  v_mfma_f32_32x32x16_bf16 v[176:191], a[72:75], v[48:51], v[176:191]
  ds_read_b64_tr_b16 a[88:89], v209 offset:32768
  ds_read_b64_tr_b16 a[90:91], v209 offset:33280
  buffer_load_dwordx4 v220, s[24:27], s71 offen offset:1024 lds
  v_rcp_f32 v226, v226
  v_mfma_f32_32x32x16_bf16 v[176:191], a[76:79], v[52:55], v[176:191]
  ds_read_b64_tr_b16 a[92:93], v209 offset:34816
  ds_read_b64_tr_b16 a[94:95], v209 offset:35328
  v_mul_f32 v152, v152, v229
  v_mul_f32 v153, v153, v230
  v_mul_f32 v154, v154, v225
  s_waitcnt lgkmcnt(4)
  v_mfma_f32_32x32x16_bf16 v[176:191], a[80:83], v[56:59], v[176:191]
  ds_read_b64_tr_b16 a[72:73], v209 offset:36864
  ds_read_b64_tr_b16 a[74:75], v209 offset:37376
  v_mul_f32 v155, v155, v226
  v_mul_f32 v229, v156, v156
  v_mul_f32 v230, v157, v157
  v_mul_f32 v225, v158, v158
  v_mfma_f32_32x32x16_bf16 v[176:191], a[84:87], v[60:63], v[176:191]
  ds_read_b64_tr_b16 a[76:77], v209 offset:38912
  ds_read_b64_tr_b16 a[78:79], v209 offset:39424
  buffer_load_dwordx4 v221, s[24:27], s71 offen offset:2048 lds
  v_mul_f32 v226, v159, v159
  v_fmaak_f32 v229, v229, v223, 0xc0135761
  s_waitcnt lgkmcnt(4)
  v_mfma_f32_32x32x16_bf16 v[176:191], a[88:91], v[64:67], v[176:191]
  ds_read_b64_tr_b16 a[80:81], v209 offset:40960
  ds_read_b64_tr_b16 a[82:83], v209 offset:41472
  v_fmaak_f32 v230, v230, v223, 0xc0135761
  v_fmaak_f32 v225, v225, v223, 0xc0135761
  v_fmaak_f32 v226, v226, v223, 0xc0135761
  v_mul_f32 v229, v229, v156
  v_mfma_f32_32x32x16_bf16 v[176:191], a[92:95], v[68:71], v[176:191]
  s_waitcnt vmcnt(13)
  s_barrier
  ds_read_b64_tr_b16 a[84:85], v209 offset:43008
  ds_read_b64_tr_b16 a[86:87], v209 offset:43520
  s_add_u32 m0, s72, 122880
  s_add_u32 s71, s76, 1769472
  s_waitcnt lgkmcnt(4)
  v_mfma_f32_32x32x16_bf16 v[176:191], a[72:75], v[72:75], v[176:191]
  ds_read_b64_tr_b16 a[88:89], v209 offset:45056
  ds_read_b64_tr_b16 a[90:91], v209 offset:45568
  buffer_load_dwordx4 v219, s[24:27], s71 offen offset:0 lds
  v_mul_f32 v230, v230, v157
  v_mul_f32 v225, v225, v158
  v_mul_f32 v226, v226, v159
  v_mfma_f32_32x32x16_bf16 v[176:191], a[76:79], v[76:79], v[176:191]
  ds_read_b64_tr_b16 a[92:93], v209 offset:47104
  ds_read_b64_tr_b16 a[94:95], v209 offset:47616
  v_exp_f32 v229, v229
  v_exp_f32 v230, v230
  s_waitcnt lgkmcnt(4)
  v_mfma_f32_32x32x16_bf16 v[176:191], a[80:83], v[80:83], v[176:191]
  ds_read_b64_tr_b16 a[72:73], v209 offset:49152
  ds_read_b64_tr_b16 a[74:75], v209 offset:49664
  v_exp_f32 v225, v225
  v_exp_f32 v226, v226
  v_add_f32 v229, 1.0, v229
  v_add_f32 v230, 1.0, v230
  v_mfma_f32_32x32x16_bf16 v[176:191], a[84:87], v[84:87], v[176:191]
  ds_read_b64_tr_b16 a[76:77], v209 offset:51200
  ds_read_b64_tr_b16 a[78:79], v209 offset:51712
  buffer_load_dwordx4 v220, s[24:27], s71 offen offset:1024 lds
  v_add_f32 v225, 1.0, v225
  v_add_f32 v226, 1.0, v226
  s_waitcnt lgkmcnt(4)
  v_mfma_f32_32x32x16_bf16 v[176:191], a[88:91], v[88:91], v[176:191]
  ds_read_b64_tr_b16 a[80:81], v209 offset:53248
  ds_read_b64_tr_b16 a[82:83], v209 offset:53760
  v_rcp_f32 v229, v229
  v_rcp_f32 v230, v230
  v_rcp_f32 v225, v225
  v_mfma_f32_32x32x16_bf16 v[176:191], a[92:95], v[92:95], v[176:191]
  ds_read_b64_tr_b16 a[84:85], v209 offset:55296
  ds_read_b64_tr_b16 a[86:87], v209 offset:55808
  v_rcp_f32 v226, v226
  v_mul_f32 v156, v156, v229
  v_mul_f32 v157, v157, v230
  v_mul_f32 v158, v158, v225
  v_mul_f32 v159, v159, v226
  s_waitcnt lgkmcnt(4)
  v_mfma_f32_32x32x16_bf16 v[176:191], a[72:75], v[96:99], v[176:191]
  ds_read_b64_tr_b16 a[88:89], v209 offset:57344
  ds_read_b64_tr_b16 a[90:91], v209 offset:57856
  buffer_load_dwordx4 v221, s[24:27], s71 offen offset:2048 lds
  v_mul_u32_u24 v245, 1152, v245
  v_lshl_add_u32 v215, v246, 4, v245
  v_mfma_f32_32x32x16_bf16 v[176:191], a[76:79], v[100:103], v[176:191]
  ds_read_b64_tr_b16 a[92:93], v209 offset:59392
  ds_read_b64_tr_b16 a[94:95], v209 offset:59904
  v_mul_f32 v229, v160, v160
  v_mul_f32 v230, v161, v161
  v_mul_f32 v225, v162, v162
  s_waitcnt lgkmcnt(4)
  v_mfma_f32_32x32x16_bf16 v[176:191], a[80:83], v[104:107], v[176:191]
  ds_read_b64_tr_b16 a[72:73], v209 offset:61440
  ds_read_b64_tr_b16 a[74:75], v209 offset:61952
  s_add_u32 m0, s72, 135168
  s_add_u32 s71, s76, 3538944
  v_mul_f32 v226, v163, v163
  v_fmaak_f32 v229, v229, v223, 0xc0135761
  v_mfma_f32_32x32x16_bf16 v[176:191], a[84:87], v[108:111], v[176:191]
  ds_read_b64_tr_b16 a[76:77], v209 offset:63488
  ds_read_b64_tr_b16 a[78:79], v209 offset:64000
  buffer_load_dwordx4 v219, s[24:27], s71 offen offset:0 lds
  v_fmaak_f32 v230, v230, v223, 0xc0135761
  s_waitcnt lgkmcnt(4)
  v_mfma_f32_32x32x16_bf16 v[176:191], a[88:91], v[112:115], v[176:191]
  v_add_u32 v209, 65536, v211
  ds_read_b64_tr_b16 a[80:81], v209 offset:0
  ds_read_b64_tr_b16 a[82:83], v209 offset:512
  v_cmp_gt_u32 vcc, 4, v251
  s_nop 3
  s_cbranch_vccnz L_slow3
L_ret3:
  v_fmaak_f32 v225, v225, v223, 0xc0135761
  v_mfma_f32_32x32x16_bf16 v[176:191], a[92:95], v[116:119], v[176:191]
  ds_read_b64_tr_b16 a[84:85], v209 offset:2048
  ds_read_b64_tr_b16 a[86:87], v209 offset:2560
  v_fmaak_f32 v226, v226, v223, 0xc0135761
  v_mul_f32 v229, v229, v160
  v_mul_f32 v230, v230, v161
  s_waitcnt lgkmcnt(4)
  v_mfma_f32_32x32x16_bf16 v[176:191], a[72:75], v[120:123], v[176:191]
  ds_read_b64_tr_b16 a[88:89], v209 offset:4096
  ds_read_b64_tr_b16 a[90:91], v209 offset:4608
  buffer_load_dwordx4 v220, s[24:27], s71 offen offset:1024 lds
  v_mul_f32 v225, v225, v162
  v_mul_f32 v226, v226, v163
  v_mfma_f32_32x32x16_bf16 v[176:191], a[76:79], v[124:127], v[176:191]
  ds_read_b64_tr_b16 a[92:93], v209 offset:6144
  ds_read_b64_tr_b16 a[94:95], v209 offset:6656
  s_add_u32 s84, s61, 4096
  buffer_load_dwordx4 a[112:115], v224, s[40:43], s84 offen sc1
  s_add_u32 s84, s61, 5120
  s_waitcnt lgkmcnt(4)
  v_mfma_f32_32x32x16_bf16 v[176:191], a[80:83], v[128:131], v[176:191]
  v_mov_b32 v210, v212
  ds_read_b64_tr_b16 a[72:73], v210 offset:0
  ds_read_b64_tr_b16 a[74:75], v210 offset:512
  buffer_load_dwordx4 a[116:119], v224, s[40:43], s84 offen sc1
  s_add_u32 s84, s61, 6144
  buffer_load_dwordx4 a[120:123], v224, s[40:43], s84 offen sc1
  s_add_u32 s84, s61, 7168
  buffer_load_dwordx4 a[124:127], v224, s[40:43], s84 offen sc1
  v_mfma_f32_32x32x16_bf16 v[176:191], a[84:87], v[132:135], v[176:191]
  ds_read_b64_tr_b16 a[76:77], v210 offset:2048
  ds_read_b64_tr_b16 a[78:79], v210 offset:2560
  buffer_load_dwordx4 v221, s[24:27], s71 offen offset:2048 lds
  v_add_u32 v216, 8192, v215
  s_waitcnt lgkmcnt(4)
  v_mfma_f32_32x32x16_bf16 v[176:191], a[88:91], v[136:139], v[176:191]
  ds_read_b64_tr_b16 a[80:81], v210 offset:4096
  ds_read_b64_tr_b16 a[82:83], v210 offset:4608
  v_exp_f32 v229, v229
  v_exp_f32 v230, v230
  v_mfma_f32_32x32x16_bf16 v[176:191], a[92:95], v[140:143], v[176:191]
  ds_read_b64_tr_b16 a[84:85], v210 offset:6144
  ds_read_b64_tr_b16 a[86:87], v210 offset:6656
  v_exp_f32 v225, v225
  s_waitcnt lgkmcnt(4)
  v_mfma_f32_32x32x16_bf16 v[192:207], a[72:75], v[0:3], 0
  ds_read_b64_tr_b16 a[88:89], v210 offset:8192
  ds_read_b64_tr_b16 a[90:91], v210 offset:8704
  v_exp_f32 v226, v226
  v_add_f32 v229, 1.0, v229
  v_add_f32 v230, 1.0, v230
  v_mfma_f32_32x32x16_bf16 v[192:207], a[76:79], v[4:7], v[192:207]
  ds_read_b64_tr_b16 a[92:93], v210 offset:10240
  ds_read_b64_tr_b16 a[94:95], v210 offset:10752
  v_add_f32 v225, 1.0, v225
  v_add_f32 v226, 1.0, v226
  s_waitcnt lgkmcnt(4)
  v_mfma_f32_32x32x16_bf16 v[192:207], a[80:83], v[8:11], v[192:207]
  ds_read_b64_tr_b16 a[72:73], v210 offset:12288
  ds_read_b64_tr_b16 a[74:75], v210 offset:12800
  v_rcp_f32 v229, v229
  v_rcp_f32 v230, v230
  v_mfma_f32_32x32x16_bf16 v[192:207], a[84:87], v[12:15], v[192:207]
  ds_read_b64_tr_b16 a[76:77], v210 offset:14336
  ds_read_b64_tr_b16 a[78:79], v210 offset:14848
  v_rcp_f32 v225, v225
  v_mul_f32 v144, v144, v176
  s_waitcnt lgkmcnt(4)
  v_mfma_f32_32x32x16_bf16 v[192:207], a[88:91], v[16:19], v[192:207]
  ds_read_b64_tr_b16 a[80:81], v210 offset:16384
  ds_read_b64_tr_b16 a[82:83], v210 offset:16896
  v_rcp_f32 v226, v226
  v_mul_f32 v160, v160, v229
  v_mul_f32 v161, v161, v230
  v_mfma_f32_32x32x16_bf16 v[192:207], a[92:95], v[20:23], v[192:207]
  ds_read_b64_tr_b16 a[84:85], v210 offset:18432
  ds_read_b64_tr_b16 a[86:87], v210 offset:18944
  v_mul_f32 v162, v162, v225
  v_mul_f32 v163, v163, v226
  v_mul_f32 v229, v164, v164
  s_waitcnt lgkmcnt(4)
  v_mfma_f32_32x32x16_bf16 v[192:207], a[72:75], v[24:27], v[192:207]
  ds_read_b64_tr_b16 a[88:89], v210 offset:20480
  ds_read_b64_tr_b16 a[90:91], v210 offset:20992
  v_mul_f32 v230, v165, v165
  v_mul_f32 v225, v166, v166
  v_mul_f32 v226, v167, v167
  v_fmaak_f32 v229, v229, v223, 0xc0135761
  v_mfma_f32_32x32x16_bf16 v[192:207], a[76:79], v[28:31], v[192:207]
  ds_read_b64_tr_b16 a[92:93], v210 offset:22528
  ds_read_b64_tr_b16 a[94:95], v210 offset:23040
  v_fmaak_f32 v230, v230, v223, 0xc0135761
  v_fmaak_f32 v225, v225, v223, 0xc0135761
  v_fmaak_f32 v226, v226, v223, 0xc0135761
  s_waitcnt lgkmcnt(4)
  v_mfma_f32_32x32x16_bf16 v[192:207], a[80:83], v[32:35], v[192:207]
  ds_read_b64_tr_b16 a[72:73], v210 offset:24576
  ds_read_b64_tr_b16 a[74:75], v210 offset:25088
  v_mul_f32 v229, v229, v164
  v_mul_f32 v230, v230, v165
  v_mul_f32 v225, v225, v166
  v_mul_f32 v226, v226, v167
  v_mfma_f32_32x32x16_bf16 v[192:207], a[84:87], v[36:39], v[192:207]
  ds_read_b64_tr_b16 a[76:77], v210 offset:26624
  ds_read_b64_tr_b16 a[78:79], v210 offset:27136
  v_exp_f32 v229, v229
  v_mul_f32 v145, v145, v177
  s_waitcnt lgkmcnt(4)
  v_mfma_f32_32x32x16_bf16 v[192:207], a[88:91], v[40:43], v[192:207]
  ds_read_b64_tr_b16 a[80:81], v210 offset:28672
  ds_read_b64_tr_b16 a[82:83], v210 offset:29184
  v_exp_f32 v230, v230
  v_exp_f32 v225, v225
  v_mfma_f32_32x32x16_bf16 v[192:207], a[92:95], v[44:47], v[192:207]
  ds_read_b64_tr_b16 a[84:85], v210 offset:30720
  ds_read_b64_tr_b16 a[86:87], v210 offset:31232
  v_exp_f32 v226, v226
  v_add_f32 v229, 1.0, v229
  s_waitcnt lgkmcnt(4)
  v_mfma_f32_32x32x16_bf16 v[192:207], a[72:75], v[48:51], v[192:207]
  ds_read_b64_tr_b16 a[88:89], v210 offset:32768
  ds_read_b64_tr_b16 a[90:91], v210 offset:33280
  v_add_f32 v230, 1.0, v230
  v_add_f32 v225, 1.0, v225
  v_add_f32 v226, 1.0, v226
  v_cvt_pk_bf16_f32 v231, v144, v145
  v_mfma_f32_32x32x16_bf16 v[192:207], a[76:79], v[52:55], v[192:207]
  ds_read_b64_tr_b16 a[92:93], v210 offset:34816
  ds_read_b64_tr_b16 a[94:95], v210 offset:35328
  v_rcp_f32 v229, v229
  v_accvgpr_write_b32 a48, v231
  s_waitcnt lgkmcnt(4)
  v_mfma_f32_32x32x16_bf16 v[192:207], a[80:83], v[56:59], v[192:207]
  ds_read_b64_tr_b16 a[72:73], v210 offset:36864
  ds_read_b64_tr_b16 a[74:75], v210 offset:37376
  v_rcp_f32 v230, v230
  v_rcp_f32 v225, v225
  v_mfma_f32_32x32x16_bf16 v[192:207], a[84:87], v[60:63], v[192:207]
  ds_read_b64_tr_b16 a[76:77], v210 offset:38912
  ds_read_b64_tr_b16 a[78:79], v210 offset:39424
  v_rcp_f32 v226, v226
  v_mul_f32 v164, v164, v229
  v_add_u32 v217, 16384, v215
  s_waitcnt lgkmcnt(4)
  v_mfma_f32_32x32x16_bf16 v[192:207], a[88:91], v[64:67], v[192:207]
  ds_read_b64_tr_b16 a[80:81], v210 offset:40960
  ds_read_b64_tr_b16 a[82:83], v210 offset:41472
  v_mul_f32 v165, v165, v230
  v_mul_f32 v166, v166, v225
  v_mul_f32 v167, v167, v226
  v_mul_f32 v229, v168, v168
  v_mfma_f32_32x32x16_bf16 v[192:207], a[92:95], v[68:71], v[192:207]
  s_waitcnt vmcnt(19)
  s_barrier
  ds_read_b64_tr_b16 a[84:85], v210 offset:43008
  ds_read_b64_tr_b16 a[86:87], v210 offset:43520
  s_add_u32 m0, s72, 0
  s_add_u32 s71, s48, 0
  v_mov_b32 v255, 6
  buffer_store_dword v255, v253, s[40:43], s65 offen sc1
  s_waitcnt lgkmcnt(4)
  v_mfma_f32_32x32x16_bf16 v[192:207], a[72:75], v[72:75], v[192:207]
  ds_read_b64_tr_b16 a[88:89], v210 offset:45056
  ds_read_b64_tr_b16 a[90:91], v210 offset:45568
  buffer_load_dwordx4 v215, s[28:31], s71 offen offset:0 lds
  v_mul_f32 v230, v169, v169
  v_mul_f32 v225, v170, v170
  v_mfma_f32_32x32x16_bf16 v[192:207], a[76:79], v[76:79], v[192:207]
  ds_read_b64_tr_b16 a[92:93], v210 offset:47104
  ds_read_b64_tr_b16 a[94:95], v210 offset:47616
  v_mul_f32 v226, v171, v171
  v_fmaak_f32 v229, v229, v223, 0xc0135761
  v_fmaak_f32 v230, v230, v223, 0xc0135761
  s_waitcnt lgkmcnt(4)
  v_mfma_f32_32x32x16_bf16 v[192:207], a[80:83], v[80:83], v[192:207]
  ds_read_b64_tr_b16 a[72:73], v210 offset:49152
  ds_read_b64_tr_b16 a[74:75], v210 offset:49664
  v_fmaak_f32 v225, v225, v223, 0xc0135761
  v_fmaak_f32 v226, v226, v223, 0xc0135761
  v_mul_f32 v229, v229, v168
  v_mul_f32 v230, v230, v169
  v_mfma_f32_32x32x16_bf16 v[192:207], a[84:87], v[84:87], v[192:207]
  ds_read_b64_tr_b16 a[76:77], v210 offset:51200
  ds_read_b64_tr_b16 a[78:79], v210 offset:51712
  buffer_load_dwordx4 v216, s[28:31], s71 offen offset:1024 lds
  v_mul_f32 v225, v225, v170
  s_waitcnt lgkmcnt(4)
  v_mfma_f32_32x32x16_bf16 v[192:207], a[88:91], v[88:91], v[192:207]
  ds_read_b64_tr_b16 a[80:81], v210 offset:53248
  ds_read_b64_tr_b16 a[82:83], v210 offset:53760
  v_mul_f32 v226, v226, v171
  v_exp_f32 v229, v229
  v_mul_f32 v146, v146, v178
  v_mfma_f32_32x32x16_bf16 v[192:207], a[92:95], v[92:95], v[192:207]
  ds_read_b64_tr_b16 a[84:85], v210 offset:55296
  ds_read_b64_tr_b16 a[86:87], v210 offset:55808
  v_exp_f32 v230, v230
  v_mul_f32 v147, v147, v179
  s_waitcnt lgkmcnt(4)
  v_mfma_f32_32x32x16_bf16 v[192:207], a[72:75], v[96:99], v[192:207]
  ds_read_b64_tr_b16 a[88:89], v210 offset:57344
  ds_read_b64_tr_b16 a[90:91], v210 offset:57856
  buffer_load_dwordx4 v217, s[28:31], s71 offen offset:2048 lds
  v_exp_f32 v225, v225
  v_exp_f32 v226, v226
  v_mfma_f32_32x32x16_bf16 v[192:207], a[76:79], v[100:103], v[192:207]
  ds_read_b64_tr_b16 a[92:93], v210 offset:59392
  ds_read_b64_tr_b16 a[94:95], v210 offset:59904
  v_add_f32 v229, 1.0, v229
  v_add_f32 v230, 1.0, v230
  v_add_f32 v225, 1.0, v225
  s_waitcnt lgkmcnt(4)
  v_mfma_f32_32x32x16_bf16 v[192:207], a[80:83], v[104:107], v[192:207]
  ds_read_b64_tr_b16 a[72:73], v210 offset:61440
  ds_read_b64_tr_b16 a[74:75], v210 offset:61952
  s_add_u32 m0, s72, 12288
  s_add_u32 s71, s48, 110592
  v_add_f32 v226, 1.0, v226
  v_rcp_f32 v229, v229
  v_mfma_f32_32x32x16_bf16 v[192:207], a[84:87], v[108:111], v[192:207]
  ds_read_b64_tr_b16 a[76:77], v210 offset:63488
  ds_read_b64_tr_b16 a[78:79], v210 offset:64000
  buffer_load_dwordx4 v215, s[28:31], s71 offen offset:0 lds
  v_rcp_f32 v230, v230
  v_cvt_pk_bf16_f32 v232, v146, v147
  s_waitcnt lgkmcnt(4)
  v_mfma_f32_32x32x16_bf16 v[192:207], a[88:91], v[112:115], v[192:207]
  v_add_u32 v210, 65536, v212
  ds_read_b64_tr_b16 a[80:81], v210 offset:0
  ds_read_b64_tr_b16 a[82:83], v210 offset:512
  v_accvgpr_write_b32 a49, v232
  v_rcp_f32 v225, v225
  v_mul_f32 v148, v148, v180
  v_mul_f32 v149, v149, v181
  v_mfma_f32_32x32x16_bf16 v[192:207], a[92:95], v[116:119], v[192:207]
  ds_read_b64_tr_b16 a[84:85], v210 offset:2048
  ds_read_b64_tr_b16 a[86:87], v210 offset:2560
  v_cvt_pk_bf16_f32 v231, v148, v149
  v_rcp_f32 v226, v226
  v_accvgpr_write_b32 a50, v231
  v_mul_f32 v168, v168, v229
  s_waitcnt lgkmcnt(4)
  v_mfma_f32_32x32x16_bf16 v[192:207], a[72:75], v[120:123], v[192:207]
  ds_read_b64_tr_b16 a[88:89], v210 offset:4096
  ds_read_b64_tr_b16 a[90:91], v210 offset:4608
  buffer_load_dwordx4 v216, s[28:31], s71 offen offset:1024 lds
  v_mul_f32 v150, v150, v182
  v_mul_f32 v151, v151, v183
  v_cvt_pk_bf16_f32 v232, v150, v151
  v_mul_f32 v169, v169, v230
  v_mfma_f32_32x32x16_bf16 v[192:207], a[76:79], v[124:127], v[192:207]
  ds_read_b64_tr_b16 a[92:93], v210 offset:6144
  ds_read_b64_tr_b16 a[94:95], v210 offset:6656
  v_accvgpr_write_b32 a51, v232
  s_add_u32 s81, s60, 12288
  v_mul_f32 v170, v170, v225
  buffer_store_dwordx4 a[48:51], v224, s[40:43], s81 offen sc1
  v_mul_f32 v171, v171, v226
  s_waitcnt lgkmcnt(4)
  v_mfma_f32_32x32x16_bf16 v[192:207], a[80:83], v[128:131], v[192:207]
  v_add_u32 v209, 73728, v213
  ds_read_b64_tr_b16 a[72:73], v209 offset:0
  ds_read_b64_tr_b16 a[74:75], v209 offset:256
  v_mul_f32 v152, v152, v184
  v_mul_f32 v153, v153, v185
  v_cvt_pk_bf16_f32 v231, v152, v153
  v_mul_f32 v229, v172, v172
  v_mul_f32 v230, v173, v173
  v_mfma_f32_32x32x16_bf16 v[192:207], a[84:87], v[132:135], v[192:207]
  ds_read_b64_tr_b16 a[76:77], v209 offset:1024
  ds_read_b64_tr_b16 a[78:79], v209 offset:1280
  buffer_load_dwordx4 v217, s[28:31], s71 offen offset:2048 lds
  v_accvgpr_write_b32 a52, v231
  v_mul_f32 v154, v154, v186
  v_mul_f32 v155, v155, v187
  s_waitcnt lgkmcnt(4)
  v_mfma_f32_32x32x16_bf16 v[192:207], a[88:91], v[136:139], v[192:207]
  ds_read_b64_tr_b16 a[80:81], v209 offset:2048
  ds_read_b64_tr_b16 a[82:83], v209 offset:2304
  v_cvt_pk_bf16_f32 v232, v154, v155
  v_accvgpr_write_b32 a53, v232
  v_mul_f32 v156, v156, v188
  v_mul_f32 v157, v157, v189
  v_cvt_pk_bf16_f32 v231, v156, v157
  v_accvgpr_write_b32 a54, v231
  v_mul_f32 v158, v158, v190
  v_mul_f32 v159, v159, v191
  v_cvt_pk_bf16_f32 v232, v158, v159
  v_accvgpr_write_b32 a55, v232
  s_add_u32 s81, s60, 13312
  buffer_store_dwordx4 a[52:55], v224, s[40:43], s81 offen sc1
  v_mfma_f32_32x32x16_bf16 v[192:207], a[92:95], v[140:143], v[192:207]
  s_waitcnt vmcnt(25)
  s_barrier
  ds_read_b64_tr_b16 a[84:85], v209 offset:3072
  ds_read_b64_tr_b16 a[86:87], v209 offset:3328
  s_add_u32 m0, s73, 24576
  s_add_u32 s71, s49, 221184
  s_waitcnt lgkmcnt(4)
  v_mfma_f32_32x32x16_bf16 v[144:159], a[72:75], v[0:3], 0
  ds_read_b64_tr_b16 a[88:89], v209 offset:4096
  ds_read_b64_tr_b16 a[90:91], v209 offset:4352
  buffer_load_dwordx4 v215, s[28:31], s71 offen lds
  v_mul_f32 v225, v174, v174
  v_mul_f32 v226, v175, v175
  v_fmaak_f32 v229, v229, v223, 0xc0135761
  v_fmaak_f32 v230, v230, v223, 0xc0135761
  v_mfma_f32_32x32x16_bf16 v[144:159], a[76:79], v[4:7], v[144:159]
  ds_read_b64_tr_b16 a[92:93], v209 offset:5120
  ds_read_b64_tr_b16 a[94:95], v209 offset:5376
  v_fmaak_f32 v225, v225, v223, 0xc0135761
  v_fmaak_f32 v226, v226, v223, 0xc0135761
  v_mul_f32 v229, v229, v172
  v_mul_f32 v230, v230, v173
  v_mul_f32 v225, v225, v174
  s_waitcnt lgkmcnt(4)
  v_mfma_f32_32x32x16_bf16 v[144:159], a[80:83], v[8:11], v[144:159]
  ds_read_b64_tr_b16 a[72:73], v209 offset:6144
  ds_read_b64_tr_b16 a[74:75], v209 offset:6400
  s_add_u32 m0, s73, 28672
  s_add_u32 s71, s49, 258048
  v_mul_f32 v226, v226, v175
  v_exp_f32 v229, v229
  v_exp_f32 v230, v230
  v_exp_f32 v225, v225
  v_exp_f32 v226, v226
  v_add_f32 v229, 1.0, v229
  v_add_f32 v230, 1.0, v230
  v_add_f32 v225, 1.0, v225
  v_add_f32 v226, 1.0, v226
  v_rcp_f32 v229, v229
  v_rcp_f32 v230, v230
  v_rcp_f32 v225, v225
  v_rcp_f32 v226, v226
  v_mul_f32 v172, v172, v229
  v_mul_f32 v173, v173, v230
  v_mul_f32 v174, v174, v225
  v_mul_f32 v175, v175, v226
  v_mfma_f32_32x32x16_bf16 v[144:159], a[84:87], v[12:15], v[144:159]
  ds_read_b64_tr_b16 a[76:77], v209 offset:7168
  ds_read_b64_tr_b16 a[78:79], v209 offset:7424
  buffer_load_dwordx4 v215, s[28:31], s71 offen lds
  v_xor_b32 v211, 64, v214
  s_waitcnt lgkmcnt(4)
  v_mfma_f32_32x32x16_bf16 v[144:159], a[88:91], v[16:19], v[144:159]
  ds_read_b64_tr_b16 a[80:81], v209 offset:8192
  ds_read_b64_tr_b16 a[82:83], v209 offset:8448
  v_mul_f32 v160, v160, v192
  v_mul_f32 v161, v161, v193
  v_lshrrev_b32 v245, 5, v208
  v_mfma_f32_32x32x16_bf16 v[144:159], a[92:95], v[20:23], v[144:159]
  ds_read_b64_tr_b16 a[84:85], v209 offset:9216
  ds_read_b64_tr_b16 a[86:87], v209 offset:9472
  s_add_u32 m0, s73, 32768
  s_add_u32 s71, s50, 294912
  v_cvt_pk_bf16_f32 v231, v160, v161
  s_waitcnt lgkmcnt(4)
  v_mfma_f32_32x32x16_bf16 v[144:159], a[72:75], v[24:27], v[144:159]
  ds_read_b64_tr_b16 a[88:89], v209 offset:10240
  ds_read_b64_tr_b16 a[90:91], v209 offset:10496
  buffer_load_dwordx4 v215, s[28:31], s71 offen lds
  v_accvgpr_write_b32 a56, v231
  v_mfma_f32_32x32x16_bf16 v[144:159], a[76:79], v[28:31], v[144:159]
  ds_read_b64_tr_b16 a[92:93], v209 offset:11264
  ds_read_b64_tr_b16 a[94:95], v209 offset:11520
  v_mul_f32 v162, v162, v194
  s_waitcnt lgkmcnt(4)
  v_mfma_f32_32x32x16_bf16 v[144:159], a[80:83], v[32:35], v[144:159]
  ds_read_b64_tr_b16 a[72:73], v209 offset:12288
  ds_read_b64_tr_b16 a[74:75], v209 offset:12544
  s_add_u32 m0, s72, 36864
  s_add_u32 s71, s48, 128
  v_mul_f32 v163, v163, v195
  v_mfma_f32_32x32x16_bf16 v[144:159], a[84:87], v[36:39], v[144:159]
  ds_read_b64_tr_b16 a[76:77], v209 offset:13312
  ds_read_b64_tr_b16 a[78:79], v209 offset:13568
  buffer_load_dwordx4 v215, s[28:31], s71 offen offset:0 lds
  v_cvt_pk_bf16_f32 v232, v162, v163
  s_waitcnt lgkmcnt(4)
  v_mfma_f32_32x32x16_bf16 v[144:159], a[88:91], v[40:43], v[144:159]
  ds_read_b64_tr_b16 a[80:81], v209 offset:14336
  ds_read_b64_tr_b16 a[82:83], v209 offset:14592
  v_accvgpr_write_b32 a57, v232
  v_mul_f32 v164, v164, v196
  v_mfma_f32_32x32x16_bf16 v[144:159], a[92:95], v[44:47], v[144:159]
  ds_read_b64_tr_b16 a[84:85], v209 offset:15360
  ds_read_b64_tr_b16 a[86:87], v209 offset:15616
  v_mul_f32 v165, v165, v197
  s_waitcnt lgkmcnt(4)
  v_mfma_f32_32x32x16_bf16 v[144:159], a[72:75], v[48:51], v[144:159]
  ds_read_b64_tr_b16 a[88:89], v209 offset:16384
  ds_read_b64_tr_b16 a[90:91], v209 offset:16640
  buffer_load_dwordx4 v216, s[28:31], s71 offen offset:1024 lds
  v_cvt_pk_bf16_f32 v231, v164, v165
  v_mfma_f32_32x32x16_bf16 v[144:159], a[76:79], v[52:55], v[144:159]
  ds_read_b64_tr_b16 a[92:93], v209 offset:17408
  ds_read_b64_tr_b16 a[94:95], v209 offset:17664
  v_accvgpr_write_b32 a58, v231
  s_waitcnt lgkmcnt(4)
  v_mfma_f32_32x32x16_bf16 v[144:159], a[80:83], v[56:59], v[144:159]
  ds_read_b64_tr_b16 a[72:73], v209 offset:18432
  ds_read_b64_tr_b16 a[74:75], v209 offset:18688
  v_mul_f32 v166, v166, v198
  v_mul_f32 v167, v167, v199
  s_lshl_b32 s47, s46, 6
  v_mfma_f32_32x32x16_bf16 v[144:159], a[84:87], v[60:63], v[144:159]
  ds_read_b64_tr_b16 a[76:77], v209 offset:19456
  ds_read_b64_tr_b16 a[78:79], v209 offset:19712
  buffer_load_dwordx4 v217, s[28:31], s71 offen offset:2048 lds
  v_cvt_pk_bf16_f32 v232, v166, v167
  s_waitcnt lgkmcnt(4)
  v_mfma_f32_32x32x16_bf16 v[144:159], a[88:91], v[64:67], v[144:159]
  ds_read_b64_tr_b16 a[80:81], v209 offset:20480
  ds_read_b64_tr_b16 a[82:83], v209 offset:20736
  v_accvgpr_write_b32 a59, v232
  v_add_u32 v238, s47, v208
  v_min_u32 v238, 239, v238
  v_mfma_f32_32x32x16_bf16 v[144:159], a[92:95], v[68:71], v[144:159]
  s_waitcnt vmcnt(25)
  s_barrier
  ds_read_b64_tr_b16 a[84:85], v209 offset:21504
  ds_read_b64_tr_b16 a[86:87], v209 offset:21760
  s_add_u32 m0, s72, 49152
  s_add_u32 s71, s48, 110720
  s_waitcnt lgkmcnt(4)
  v_mfma_f32_32x32x16_bf16 v[144:159], a[72:75], v[72:75], v[144:159]
  ds_read_b64_tr_b16 a[88:89], v209 offset:22528
  ds_read_b64_tr_b16 a[90:91], v209 offset:22784
  buffer_load_dwordx4 v215, s[28:31], s71 offen offset:0 lds
  s_add_u32 s81, s60, 14336
  buffer_store_dwordx4 a[56:59], v224, s[40:43], s81 offen sc1
  v_mfma_f32_32x32x16_bf16 v[144:159], a[76:79], v[76:79], v[144:159]
  ds_read_b64_tr_b16 a[92:93], v209 offset:23552
  ds_read_b64_tr_b16 a[94:95], v209 offset:23808
  v_mul_f32 v168, v168, v200
  v_mul_f32 v169, v169, v201
  s_movk_i32 s68, 120
  s_waitcnt lgkmcnt(4)
  v_mfma_f32_32x32x16_bf16 v[144:159], a[80:83], v[80:83], v[144:159]
  ds_read_b64_tr_b16 a[72:73], v209 offset:24576
  ds_read_b64_tr_b16 a[74:75], v209 offset:24832
  v_cvt_pk_bf16_f32 v231, v168, v169
  v_cmp_le_u32 s[100:101], s68, v238
  s_nop 1
  v_cndmask_b32 v234, 0, 1, s[100:101]
  v_mul_u32_u24 v245, 4, v245
  v_mfma_f32_32x32x16_bf16 v[144:159], a[84:87], v[84:87], v[144:159]
  ds_read_b64_tr_b16 a[76:77], v209 offset:25600
  ds_read_b64_tr_b16 a[78:79], v209 offset:25856
  buffer_load_dwordx4 v216, s[28:31], s71 offen offset:1024 lds
  v_accvgpr_write_b32 a60, v231
  s_waitcnt lgkmcnt(4)
  v_mfma_f32_32x32x16_bf16 v[144:159], a[88:91], v[88:91], v[144:159]
  ds_read_b64_tr_b16 a[80:81], v209 offset:26624
  ds_read_b64_tr_b16 a[82:83], v209 offset:26880
  v_mul_f32 v170, v170, v202
  v_mul_u32_u24 v235, 120, v234
  v_sub_u32 v238, v238, v235
  v_mfma_f32_32x32x16_bf16 v[144:159], a[92:95], v[92:95], v[144:159]
  ds_read_b64_tr_b16 a[84:85], v209 offset:27648
  ds_read_b64_tr_b16 a[86:87], v209 offset:27904
  v_mul_f32 v171, v171, v203
  v_mul_u32_u24 v235, 205, v238
  s_waitcnt lgkmcnt(4)
  v_mfma_f32_32x32x16_bf16 v[144:159], a[72:75], v[96:99], v[144:159]
  ds_read_b64_tr_b16 a[88:89], v209 offset:28672
  ds_read_b64_tr_b16 a[90:91], v209 offset:28928
  buffer_load_dwordx4 v217, s[28:31], s71 offen offset:2048 lds
  v_cvt_pk_bf16_f32 v232, v170, v171
  v_accvgpr_write_b32 a61, v232
  v_mfma_f32_32x32x16_bf16 v[144:159], a[76:79], v[100:103], v[144:159]
  ds_read_b64_tr_b16 a[92:93], v209 offset:29696
  ds_read_b64_tr_b16 a[94:95], v209 offset:29952
  v_mul_f32 v172, v172, v204
  v_lshrrev_b32 v235, 13, v235
  s_waitcnt lgkmcnt(4)
  v_mfma_f32_32x32x16_bf16 v[144:159], a[80:83], v[104:107], v[144:159]
  ds_read_b64_tr_b16 a[72:73], v209 offset:30720
  ds_read_b64_tr_b16 a[74:75], v209 offset:30976
  s_add_u32 m0, s73, 61440
  s_add_u32 s71, s49, 221312
  buffer_load_dword v251, v252, s[40:43], s67 offen sc1
  v_mul_f32 v173, v173, v205
  v_mfma_f32_32x32x16_bf16 v[144:159], a[84:87], v[108:111], v[144:159]
  ds_read_b64_tr_b16 a[76:77], v209 offset:31744
  ds_read_b64_tr_b16 a[78:79], v209 offset:32000
  buffer_load_dwordx4 v215, s[28:31], s71 offen lds
  v_cvt_pk_bf16_f32 v231, v172, v173
  s_waitcnt lgkmcnt(4)
  v_mfma_f32_32x32x16_bf16 v[144:159], a[88:91], v[112:115], v[144:159]
  ds_read_b64_tr_b16 a[80:81], v209 offset:32768
  ds_read_b64_tr_b16 a[82:83], v209 offset:33024
  v_accvgpr_write_b32 a62, v231
  v_mul_u32_u24 v236, 40, v235
  v_sub_u32 v238, v238, v236
  v_cmp_le_u32 s[100:101], 20, v238
  v_mfma_f32_32x32x16_bf16 v[144:159], a[92:95], v[116:119], v[144:159]
  ds_read_b64_tr_b16 a[84:85], v209 offset:33792
  ds_read_b64_tr_b16 a[86:87], v209 offset:34048
  s_add_u32 m0, s73, 65536
  s_add_u32 s71, s49, 258176
  v_mul_f32 v174, v174, v206
  s_waitcnt lgkmcnt(4)
  v_mfma_f32_32x32x16_bf16 v[144:159], a[72:75], v[120:123], v[144:159]
  ds_read_b64_tr_b16 a[88:89], v209 offset:34816
  ds_read_b64_tr_b16 a[90:91], v209 offset:35072
  buffer_load_dwordx4 v215, s[28:31], s71 offen lds
  v_mul_f32 v175, v175, v207
  v_cvt_pk_bf16_f32 v232, v174, v175
  v_mfma_f32_32x32x16_bf16 v[144:159], a[76:79], v[124:127], v[144:159]
  ds_read_b64_tr_b16 a[92:93], v209 offset:35840
  ds_read_b64_tr_b16 a[94:95], v209 offset:36096
  v_accvgpr_write_b32 a63, v232
  v_cndmask_b32 v236, 0, 1, s[100:101]
  v_mul_u32_u24 v239, 20, v236
  s_waitcnt lgkmcnt(4)
  v_mfma_f32_32x32x16_bf16 v[144:159], a[80:83], v[128:131], v[144:159]
  ds_read_b64_tr_b16 a[72:73], v209 offset:36864
  ds_read_b64_tr_b16 a[74:75], v209 offset:37120
  s_add_u32 m0, s73, 69632
  s_add_u32 s71, s50, 295040
  s_add_u32 s81, s60, 15360
  v_sub_u32 v239, v238, v239
  v_mfma_f32_32x32x16_bf16 v[144:159], a[84:87], v[132:135], v[144:159]
  ds_read_b64_tr_b16 a[76:77], v209 offset:37888
  ds_read_b64_tr_b16 a[78:79], v209 offset:38144
  buffer_load_dwordx4 v215, s[28:31], s71 offen lds
  buffer_store_dwordx4 a[60:63], v224, s[40:43], s81 offen sc1
  s_waitcnt lgkmcnt(4)
  v_mfma_f32_32x32x16_bf16 v[144:159], a[88:91], v[136:139], v[144:159]
  ds_read_b64_tr_b16 a[80:81], v209 offset:38912
  ds_read_b64_tr_b16 a[82:83], v209 offset:39168
  s_add_u32 m0, s72, 73728
  s_add_u32 s71, s48, 256
  v_lshlrev_b32 v240, 3, v235
  v_bfe_u32 v246, v208, 2, 2
  v_mfma_f32_32x32x16_bf16 v[144:159], a[92:95], v[140:143], v[144:159]
  s_waitcnt vmcnt(31)
  s_barrier
  ds_read_b64_tr_b16 a[84:85], v209 offset:39936
  ds_read_b64_tr_b16 a[86:87], v209 offset:40192
  buffer_load_dwordx4 v215, s[28:31], s71 offen offset:0 lds
  s_waitcnt lgkmcnt(4)
  v_mfma_f32_32x32x16_bf16 v[176:191], a[72:75], v[0:3], 0
  ds_read_b64_tr_b16 a[88:89], v209 offset:40960
  ds_read_b64_tr_b16 a[90:91], v209 offset:41216
  v_lshl_add_u32 v240, v236, 2, v240
  v_lshlrev_b32 v241, 1, v234
  v_mfma_f32_32x32x16_bf16 v[176:191], a[76:79], v[4:7], v[176:191]
  ds_read_b64_tr_b16 a[92:93], v209 offset:41984
  ds_read_b64_tr_b16 a[94:95], v209 offset:42240
  buffer_load_dwordx4 v216, s[28:31], s71 offen offset:1024 lds
  v_sub_u32 v238, v240, v241
  s_waitcnt lgkmcnt(4)
  v_mfma_f32_32x32x16_bf16 v[176:191], a[80:83], v[8:11], v[176:191]
  ds_read_b64_tr_b16 a[72:73], v209 offset:43008
  ds_read_b64_tr_b16 a[74:75], v209 offset:43264
  v_cmp_gt_u32 s[96:97], 17, v238
  v_mfma_f32_32x32x16_bf16 v[176:191], a[84:87], v[12:15], v[176:191]
  ds_read_b64_tr_b16 a[76:77], v209 offset:44032
  ds_read_b64_tr_b16 a[78:79], v209 offset:44288
  buffer_load_dwordx4 v217, s[28:31], s71 offen offset:2048 lds
  v_mul_f32 v229, v144, v144
  v_mul_f32 v230, v145, v145
  v_mul_f32 v225, v146, v146
  s_waitcnt lgkmcnt(4)
  v_mfma_f32_32x32x16_bf16 v[176:191], a[88:91], v[16:19], v[176:191]
  ds_read_b64_tr_b16 a[80:81], v209 offset:45056
  ds_read_b64_tr_b16 a[82:83], v209 offset:45312
  s_add_u32 m0, s72, 86016
  s_add_u32 s71, s48, 110848
  v_mul_f32 v226, v147, v147
  v_fmaak_f32 v229, v229, v223, 0xc0135761
  v_fmaak_f32 v230, v230, v223, 0xc0135761
  v_fmaak_f32 v225, v225, v223, 0xc0135761
  v_mfma_f32_32x32x16_bf16 v[176:191], a[92:95], v[20:23], v[176:191]
  ds_read_b64_tr_b16 a[84:85], v209 offset:46080
  ds_read_b64_tr_b16 a[86:87], v209 offset:46336
  buffer_load_dwordx4 v215, s[28:31], s71 offen offset:0 lds
  v_fmaak_f32 v226, v226, v223, 0xc0135761
  v_mul_f32 v229, v229, v144
  v_mul_f32 v230, v230, v145
  s_waitcnt lgkmcnt(4)
  v_mfma_f32_32x32x16_bf16 v[176:191], a[72:75], v[24:27], v[176:191]
  ds_read_b64_tr_b16 a[88:89], v209 offset:47104
  ds_read_b64_tr_b16 a[90:91], v209 offset:47360
  v_mul_f32 v225, v225, v146
  v_mul_f32 v226, v226, v147
  v_exp_f32 v229, v229
  v_exp_f32 v230, v230
  v_mfma_f32_32x32x16_bf16 v[176:191], a[76:79], v[28:31], v[176:191]
  ds_read_b64_tr_b16 a[92:93], v209 offset:48128
  ds_read_b64_tr_b16 a[94:95], v209 offset:48384
  buffer_load_dwordx4 v216, s[28:31], s71 offen offset:1024 lds
  v_exp_f32 v225, v225
  s_waitcnt lgkmcnt(4)
  v_mfma_f32_32x32x16_bf16 v[176:191], a[80:83], v[32:35], v[176:191]
  ds_read_b64_tr_b16 a[72:73], v209 offset:49152
  ds_read_b64_tr_b16 a[74:75], v209 offset:49408
  v_exp_f32 v226, v226
  v_add_f32 v229, 1.0, v229
  v_add_f32 v230, 1.0, v230
  v_add_f32 v225, 1.0, v225
  v_add_f32 v226, 1.0, v226
  v_mfma_f32_32x32x16_bf16 v[176:191], a[84:87], v[36:39], v[176:191]
  ds_read_b64_tr_b16 a[76:77], v209 offset:50176
  ds_read_b64_tr_b16 a[78:79], v209 offset:50432
  buffer_load_dwordx4 v217, s[28:31], s71 offen offset:2048 lds
  v_rcp_f32 v229, v229
  s_waitcnt lgkmcnt(4)
  v_mfma_f32_32x32x16_bf16 v[176:191], a[88:91], v[40:43], v[176:191]
  ds_read_b64_tr_b16 a[80:81], v209 offset:51200
  ds_read_b64_tr_b16 a[82:83], v209 offset:51456
  s_add_u32 m0, s73, 98304
  s_add_u32 s71, s49, 221440
  v_rcp_f32 v230, v230
  v_rcp_f32 v225, v225
  v_mfma_f32_32x32x16_bf16 v[176:191], a[92:95], v[44:47], v[176:191]
  ds_read_b64_tr_b16 a[84:85], v209 offset:52224
  ds_read_b64_tr_b16 a[86:87], v209 offset:52480
  buffer_load_dwordx4 v215, s[28:31], s71 offen lds
  v_rcp_f32 v226, v226
  v_mul_f32 v144, v144, v229
  s_waitcnt lgkmcnt(4)
  v_mfma_f32_32x32x16_bf16 v[176:191], a[72:75], v[48:51], v[176:191]
  ds_read_b64_tr_b16 a[88:89], v209 offset:53248
  ds_read_b64_tr_b16 a[90:91], v209 offset:53504
  s_add_u32 m0, s73, 102400
  s_add_u32 s71, s49, 258304
  v_mul_f32 v145, v145, v230
  v_mul_f32 v146, v146, v225
  v_mul_f32 v147, v147, v226
  v_mul_f32 v229, v148, v148
  v_mfma_f32_32x32x16_bf16 v[176:191], a[76:79], v[52:55], v[176:191]
  ds_read_b64_tr_b16 a[92:93], v209 offset:54272
  ds_read_b64_tr_b16 a[94:95], v209 offset:54528
  buffer_load_dwordx4 v215, s[28:31], s71 offen lds
  v_mul_f32 v230, v149, v149
  v_mul_f32 v225, v150, v150
  v_mul_f32 v226, v151, v151
  s_waitcnt lgkmcnt(4)
  v_mfma_f32_32x32x16_bf16 v[176:191], a[80:83], v[56:59], v[176:191]
  ds_read_b64_tr_b16 a[72:73], v209 offset:55296
  ds_read_b64_tr_b16 a[74:75], v209 offset:55552
  s_add_u32 m0, s73, 106496
  s_add_u32 s71, s50, 295168
  v_fmaak_f32 v229, v229, v223, 0xc0135761
  v_fmaak_f32 v230, v230, v223, 0xc0135761
  v_fmaak_f32 v225, v225, v223, 0xc0135761
  v_fmaak_f32 v226, v226, v223, 0xc0135761
  v_mfma_f32_32x32x16_bf16 v[176:191], a[84:87], v[60:63], v[176:191]
  ds_read_b64_tr_b16 a[76:77], v209 offset:56320
  ds_read_b64_tr_b16 a[78:79], v209 offset:56576
  buffer_load_dwordx4 v215, s[28:31], s71 offen lds
  v_mul_f32 v229, v229, v148
  v_mul_f32 v230, v230, v149
  v_mul_f32 v225, v225, v150
  s_waitcnt lgkmcnt(4)
  v_mfma_f32_32x32x16_bf16 v[176:191], a[88:91], v[64:67], v[176:191]
  ds_read_b64_tr_b16 a[80:81], v209 offset:57344
  ds_read_b64_tr_b16 a[82:83], v209 offset:57600
  v_mul_f32 v226, v226, v151
  v_exp_f32 v229, v229
  v_exp_f32 v230, v230
  v_mfma_f32_32x32x16_bf16 v[176:191], a[92:95], v[68:71], v[176:191]
  s_waitcnt vmcnt(29)
  s_barrier
  ds_read_b64_tr_b16 a[84:85], v209 offset:58368
  ds_read_b64_tr_b16 a[86:87], v209 offset:58624
  s_add_u32 m0, s72, 110592
  s_add_u32 s71, s48, 384
  s_waitcnt lgkmcnt(4)
  v_mfma_f32_32x32x16_bf16 v[176:191], a[72:75], v[72:75], v[176:191]
  ds_read_b64_tr_b16 a[88:89], v209 offset:59392
  ds_read_b64_tr_b16 a[90:91], v209 offset:59648
  buffer_load_dwordx4 v215, s[28:31], s71 offen offset:0 lds
  v_exp_f32 v225, v225
  v_exp_f32 v226, v226
  v_mfma_f32_32x32x16_bf16 v[176:191], a[76:79], v[76:79], v[176:191]
  ds_read_b64_tr_b16 a[92:93], v209 offset:60416
  ds_read_b64_tr_b16 a[94:95], v209 offset:60672
  v_add_f32 v229, 1.0, v229
  v_add_f32 v230, 1.0, v230
  v_add_f32 v225, 1.0, v225
  v_add_f32 v226, 1.0, v226
  s_waitcnt lgkmcnt(4)
  v_mfma_f32_32x32x16_bf16 v[176:191], a[80:83], v[80:83], v[176:191]
  ds_read_b64_tr_b16 a[72:73], v209 offset:61440
  ds_read_b64_tr_b16 a[74:75], v209 offset:61696
  buffer_load_dwordx4 v216, s[28:31], s71 offen offset:1024 lds
  v_rcp_f32 v229, v229
  v_rcp_f32 v230, v230
  v_mfma_f32_32x32x16_bf16 v[176:191], a[84:87], v[84:87], v[176:191]
  ds_read_b64_tr_b16 a[76:77], v209 offset:62464
  ds_read_b64_tr_b16 a[78:79], v209 offset:62720
  v_rcp_f32 v225, v225
  v_rcp_f32 v226, v226
  v_mul_f32 v148, v148, v229
  s_waitcnt lgkmcnt(4)
  v_mfma_f32_32x32x16_bf16 v[176:191], a[88:91], v[88:91], v[176:191]
  ds_read_b64_tr_b16 a[80:81], v209 offset:63488
  ds_read_b64_tr_b16 a[82:83], v209 offset:63744
  buffer_load_dwordx4 v217, s[28:31], s71 offen offset:2048 lds
  v_mul_f32 v149, v149, v230
  v_mul_f32 v150, v150, v225
  v_mul_f32 v151, v151, v226
  v_mul_f32 v229, v152, v152
  v_mfma_f32_32x32x16_bf16 v[176:191], a[92:95], v[92:95], v[176:191]
  ds_read_b64_tr_b16 a[84:85], v209 offset:64512
  ds_read_b64_tr_b16 a[86:87], v209 offset:64768
  v_mul_f32 v230, v153, v153
  v_mul_f32 v225, v154, v154
  v_mul_f32 v226, v155, v155
  v_fmaak_f32 v229, v229, v223, 0xc0135761
  v_fmaak_f32 v230, v230, v223, 0xc0135761
  s_waitcnt lgkmcnt(4)
  v_mfma_f32_32x32x16_bf16 v[176:191], a[72:75], v[96:99], v[176:191]
  v_add_u32 v209, 139264, v213
  ds_read_b64_tr_b16 a[88:89], v209 offset:0
  ds_read_b64_tr_b16 a[90:91], v209 offset:256
  v_fmaak_f32 v225, v225, v223, 0xc0135761
  v_fmaak_f32 v226, v226, v223, 0xc0135761
  v_mul_f32 v229, v229, v152
  v_mul_f32 v230, v230, v153
  v_mul_f32 v225, v225, v154
  v_mfma_f32_32x32x16_bf16 v[176:191], a[76:79], v[100:103], v[176:191]
  ds_read_b64_tr_b16 a[92:93], v209 offset:1024
  ds_read_b64_tr_b16 a[94:95], v209 offset:1280
  v_mul_f32 v226, v226, v155
  v_exp_f32 v229, v229
  v_exp_f32 v230, v230
  s_waitcnt lgkmcnt(4)
  v_mfma_f32_32x32x16_bf16 v[176:191], a[80:83], v[104:107], v[176:191]
  ds_read_b64_tr_b16 a[72:73], v209 offset:2048
  ds_read_b64_tr_b16 a[74:75], v209 offset:2304
  v_exp_f32 v225, v225
  v_exp_f32 v226, v226
  v_add_u32 v238, 2, v238
  v_add_f32 v229, 1.0, v229
  v_mfma_f32_32x32x16_bf16 v[176:191], a[84:87], v[108:111], v[176:191]
  ds_read_b64_tr_b16 a[76:77], v209 offset:3072
  ds_read_b64_tr_b16 a[78:79], v209 offset:3328
  v_cmp_gt_u32 s[88:89], 17, v238
  v_sub_u32 v242, v239, v241
  v_cmp_gt_i32 s[100:101], 0, v242
  v_add_f32 v230, 1.0, v230
  v_add_u32 v238, 20, v242
  s_waitcnt lgkmcnt(4)
  v_mfma_f32_32x32x16_bf16 v[176:191], a[88:91], v[112:115], v[176:191]
  ds_read_b64_tr_b16 a[80:81], v209 offset:4096
  ds_read_b64_tr_b16 a[82:83], v209 offset:4352
  v_cndmask_b32 v242, v242, v238, s[100:101]
  v_lshlrev_b32 v243, 11, v234
  v_lshl_add_u32 v243, v240, 1, v243
  v_add_u32 v243, 156672, v243
  v_add_f32 v225, 1.0, v225
  v_add_f32 v226, 1.0, v226
  v_mfma_f32_32x32x16_bf16 v[176:191], a[92:95], v[116:119], v[176:191]
  ds_read_b64_tr_b16 a[84:85], v209 offset:5120
  ds_read_b64_tr_b16 a[86:87], v209 offset:5376
  v_cmp_eq_u32 s[100:101], 18, v242
  v_mov_b32 v238, 31
  v_mov_b32 v235, 22
  v_cndmask_b32 v238, v238, v235, s[100:101]
  v_lshl_add_u32 v244, v238, 6, v243
  v_lshl_add_u32 v243, v242, 6, v243
  v_lshlrev_b32 v238, 6, v208
  v_add_u32 v238, 156720, v238
  v_mov_b32 v234, 0
  v_mov_b32 v235, 0
  ds_write_b64 v238, v[234:235]
  ds_write_b64 v238, v[234:235] offset:8
  s_waitcnt lgkmcnt(6)
  v_mfma_f32_32x32x16_bf16 v[176:191], a[72:75], v[120:123], v[176:191]
  ds_read_b64_tr_b16 a[88:89], v209 offset:6144
  ds_read_b64_tr_b16 a[90:91], v209 offset:6400
  v_rcp_f32 v229, v229
  v_rcp_f32 v230, v230
  v_rcp_f32 v225, v225
  v_mfma_f32_32x32x16_bf16 v[176:191], a[76:79], v[124:127], v[176:191]
  ds_read_b64_tr_b16 a[92:93], v209 offset:7168
  ds_read_b64_tr_b16 a[94:95], v209 offset:7424
  v_rcp_f32 v226, v226
  v_mul_f32 v152, v152, v229
  v_mul_f32 v153, v153, v230
  v_mul_f32 v154, v154, v225
  s_waitcnt lgkmcnt(6)
  v_mfma_f32_32x32x16_bf16 v[176:191], a[80:83], v[128:131], v[176:191]
  v_mov_b32 v210, v214
  ds_read_b64_tr_b16 a[72:73], v210 offset:0
  ds_read_b64_tr_b16 a[74:75], v210 offset:1024
  v_mul_f32 v155, v155, v226
  v_mul_f32 v229, v156, v156
  v_mul_f32 v230, v157, v157
  v_mul_f32 v225, v158, v158
  v_mul_f32 v226, v159, v159
  v_mfma_f32_32x32x16_bf16 v[176:191], a[84:87], v[132:135], v[176:191]
  ds_read_b64_tr_b16 a[76:77], v210 offset:2048
  ds_read_b64_tr_b16 a[78:79], v210 offset:3072
  v_fmaak_f32 v229, v229, v223, 0xc0135761
  v_fmaak_f32 v230, v230, v223, 0xc0135761
  v_fmaak_f32 v225, v225, v223, 0xc0135761
  v_fmaak_f32 v226, v226, v223, 0xc0135761
  v_mul_f32 v229, v229, v156
  s_waitcnt lgkmcnt(4)
  v_mfma_f32_32x32x16_bf16 v[176:191], a[88:91], v[136:139], v[176:191]
  ds_read_b64_tr_b16 a[80:81], v210 offset:4096
  ds_read_b64_tr_b16 a[82:83], v210 offset:5120
  v_mul_f32 v230, v230, v157
  v_mul_f32 v225, v225, v158
  v_mul_f32 v226, v226, v159
  v_exp_f32 v229, v229
  v_mfma_f32_32x32x16_bf16 v[176:191], a[92:95], v[140:143], v[176:191]
  s_waitcnt vmcnt(24)
  s_barrier
  ds_read_b64_tr_b16 a[84:85], v210 offset:6144
  ds_read_b64_tr_b16 a[86:87], v210 offset:7168
  s_add_u32 m0, s72, 122880
  s_add_u32 s71, s48, 110976
  s_waitcnt vmcnt(16)
  v_cmp_gt_u32 vcc, 6, v251
  s_nop 3
  s_cbranch_vccnz L_slow4
L_ret4:
  v_exp_f32 v230, v230
  v_exp_f32 v225, v225
  v_exp_f32 v226, v226
  v_add_f32 v229, 1.0, v229
  v_add_f32 v230, 1.0, v230
  v_add_f32 v225, 1.0, v225
  v_add_f32 v226, 1.0, v226
  v_rcp_f32 v229, v229
  v_rcp_f32 v230, v230
  v_rcp_f32 v225, v225
  v_rcp_f32 v226, v226
  v_mul_f32 v156, v156, v229
  v_mul_f32 v157, v157, v230
  v_mul_f32 v158, v158, v225
  v_mul_f32 v159, v159, v226
  s_waitcnt lgkmcnt(4)
  v_mfma_f32_32x32x16_bf16 v[0:15], a[72:75], a[0:3], 0
  ds_read_b64_tr_b16 a[88:89], v210 offset:8192
  ds_read_b64_tr_b16 a[90:91], v210 offset:9216
  buffer_load_dwordx4 v215, s[28:31], s71 offen offset:0 lds
  v_add_u32 v245, v245, v246
  v_mul_u32_u24 v212, 64, v245
  v_mfma_f32_32x32x16_bf16 v[0:15], a[76:79], a[4:7], v[0:15]
  ds_read_b64_tr_b16 a[92:93], v210 offset:10240
  ds_read_b64_tr_b16 a[94:95], v210 offset:11264
  s_waitcnt lgkmcnt(4)
  v_mfma_f32_32x32x16_bf16 v[0:15], a[80:83], a[8:11], v[0:15]
  ds_read_b64_tr_b16 a[72:73], v210 offset:12288
  ds_read_b64_tr_b16 a[74:75], v210 offset:13312
  buffer_load_dwordx4 v216, s[28:31], s71 offen offset:1024 lds
  s_add_u32 s84, s61, 8192
  buffer_load_dwordx4 a[128:131], v224, s[40:43], s84 offen sc1
  v_mfma_f32_32x32x16_bf16 v[0:15], a[84:87], a[12:15], v[0:15]
  ds_read_b64_tr_b16 a[76:77], v210 offset:14336
  ds_read_b64_tr_b16 a[78:79], v210 offset:15360
  v_mul_f32 v144, v144, v176
  v_mul_f32 v145, v145, v177
  v_cvt_pk_bf16_f32 v231, v144, v145
  s_waitcnt lgkmcnt(4)
  v_mfma_f32_32x32x16_bf16 v[0:15], a[88:91], a[16:19], v[0:15]
  ds_read_b64_tr_b16 a[80:81], v210 offset:16384
  ds_read_b64_tr_b16 a[82:83], v210 offset:17408
  buffer_load_dwordx4 v217, s[28:31], s71 offen offset:2048 lds
  v_accvgpr_write_b32 a64, v231
  v_mul_f32 v146, v146, v178
  v_mfma_f32_32x32x16_bf16 v[0:15], a[92:95], a[20:23], v[0:15]
  ds_read_b64_tr_b16 a[84:85], v210 offset:18432
  ds_read_b64_tr_b16 a[86:87], v210 offset:19456
  s_add_u32 m0, s73, 135168
  s_add_u32 s71, s49, 221568
  v_mul_f32 v147, v147, v179
  v_cvt_pk_bf16_f32 v232, v146, v147
  v_accvgpr_write_b32 a65, v232
  s_waitcnt lgkmcnt(4)
  v_mfma_f32_32x32x16_bf16 v[0:15], a[72:75], a[24:27], v[0:15]
  ds_read_b64_tr_b16 a[88:89], v210 offset:20480
  ds_read_b64_tr_b16 a[90:91], v210 offset:21504
  buffer_load_dwordx4 v215, s[28:31], s71 offen lds
  v_mul_f32 v148, v148, v180
  v_mul_f32 v149, v149, v181
  v_cvt_pk_bf16_f32 v231, v148, v149
  v_accvgpr_write_b32 a66, v231
  v_mfma_f32_32x32x16_bf16 v[0:15], a[76:79], a[28:31], v[0:15]
  ds_read_b64_tr_b16 a[92:93], v210 offset:22528
  ds_read_b64_tr_b16 a[94:95], v210 offset:23552
  s_add_u32 m0, s73, 139264
  s_add_u32 s71, s49, 258432
  s_add_u32 s84, s61, 9216
  buffer_load_dwordx4 a[132:135], v224, s[40:43], s84 offen sc1
  s_add_u32 s84, s61, 10240
  buffer_load_dwordx4 a[136:139], v224, s[40:43], s84 offen sc1
  s_add_u32 s84, s61, 11264
  buffer_load_dwordx4 a[140:143], v224, s[40:43], s84 offen sc1
  s_lshl_b32 s84, s46, 6
  v_add_u32 v237, s84, v208
  v_min_u32 v237, 239, v237
  v_lshlrev_b32 v237, 2, v237
  buffer_load_dword v227, v237, s[40:43], s78 offen offset:0 sc1
  buffer_load_dword v228, v237, s[40:43], s78 offen offset:1024 sc1
  buffer_load_dword v233, v237, s[40:43], s78 offen offset:2048 sc1
  buffer_load_dword v249, v237, s[40:43], s78 offen offset:3072 sc1
  s_waitcnt lgkmcnt(4)
  v_mfma_f32_32x32x16_bf16 v[0:15], a[80:83], a[32:35], v[0:15]
  ds_read_b64_tr_b16 a[72:73], v210 offset:24576
  ds_read_b64_tr_b16 a[74:75], v210 offset:25600
  buffer_load_dwordx4 v215, s[28:31], s71 offen lds
  v_mul_f32 v150, v150, v182
  v_mul_f32 v151, v151, v183
  v_cvt_pk_bf16_f32 v232, v150, v151
  v_accvgpr_write_b32 a67, v232
  v_mfma_f32_32x32x16_bf16 v[0:15], a[84:87], a[36:39], v[0:15]
  ds_read_b64_tr_b16 a[76:77], v210 offset:26624
  ds_read_b64_tr_b16 a[78:79], v210 offset:27648
  s_add_u32 m0, s73, 143360
  s_add_u32 s71, s50, 295296
  s_add_u32 s81, s60, 16384
  buffer_store_dwordx4 a[64:67], v224, s[40:43], s81 offen sc1
  v_mul_f32 v152, v152, v184
  s_waitcnt lgkmcnt(4)
  v_mfma_f32_32x32x16_bf16 v[0:15], a[88:91], a[40:43], v[0:15]
  ds_read_b64_tr_b16 a[80:81], v210 offset:28672
  ds_read_b64_tr_b16 a[82:83], v210 offset:29696
  buffer_load_dwordx4 v215, s[28:31], s71 offen lds
  v_mul_f32 v153, v153, v185
  v_cvt_pk_bf16_f32 v231, v152, v153
  v_accvgpr_write_b32 a68, v231
  v_mul_f32 v154, v154, v186
  v_mfma_f32_32x32x16_bf16 v[0:15], a[92:95], a[44:47], v[0:15]
  ds_read_b64_tr_b16 a[84:85], v210 offset:30720
  ds_read_b64_tr_b16 a[86:87], v210 offset:31744
  v_mul_f32 v155, v155, v187
  v_cvt_pk_bf16_f32 v232, v154, v155
  v_accvgpr_write_b32 a69, v232
  v_mul_f32 v156, v156, v188
  v_mul_f32 v157, v157, v189
  s_waitcnt lgkmcnt(4)
  v_mfma_f32_32x32x16_bf16 v[0:15], a[72:75], a[48:51], v[0:15]
  ds_read_b64_tr_b16 a[88:89], v210 offset:32768
  ds_read_b64_tr_b16 a[90:91], v210 offset:33792
  v_cvt_pk_bf16_f32 v231, v156, v157
  v_accvgpr_write_b32 a70, v231
  v_mul_f32 v158, v158, v190
  v_mul_f32 v159, v159, v191
  v_cvt_pk_bf16_f32 v232, v158, v159
  v_accvgpr_write_b32 a71, v232
  s_add_u32 s81, s60, 17408
  buffer_store_dwordx4 a[68:71], v224, s[40:43], s81 offen sc1
  v_mfma_f32_32x32x16_bf16 v[0:15], a[76:79], a[52:55], v[0:15]
  ds_read_b64_tr_b16 a[92:93], v210 offset:34816
  ds_read_b64_tr_b16 a[94:95], v210 offset:35840
  s_waitcnt vmcnt(6)
  v_cvt_pk_bf16_f32 v248, v227, v228
  s_waitcnt vmcnt(4)
  v_cvt_pk_bf16_f32 v249, v233, v249
  v_cndmask_b32 v248, 0, v248, s[96:97]
  s_waitcnt lgkmcnt(4)
  v_mfma_f32_32x32x16_bf16 v[0:15], a[80:83], a[56:59], v[0:15]
  v_mov_b32 v209, v211
  ds_read_b64_tr_b16 a[72:73], v209 offset:0
  ds_read_b64_tr_b16 a[74:75], v209 offset:1024
  v_cndmask_b32 v249, 0, v249, s[88:89]
  ds_write_b64 v243, v[248:249]
  ds_write_b64 v244, v[248:249]
  v_mfma_f32_32x32x16_bf16 v[0:15], a[84:87], a[60:63], v[0:15]
  ds_read_b64_tr_b16 a[76:77], v209 offset:2048
  ds_read_b64_tr_b16 a[78:79], v209 offset:3072
  v_bfe_u32 v245, v208, 4, 1
  s_waitcnt lgkmcnt(6)
  v_mfma_f32_32x32x16_bf16 v[0:15], a[88:91], a[64:67], v[0:15]
  ds_read_b64_tr_b16 a[80:81], v209 offset:4096
  ds_read_b64_tr_b16 a[82:83], v209 offset:5120
  v_mfma_f32_32x32x16_bf16 v[0:15], a[92:95], a[68:71], v[0:15]
  s_waitcnt lgkmcnt(0)
  s_barrier
  ds_read_b64_tr_b16 a[84:85], v209 offset:6144
  ds_read_b64_tr_b16 a[86:87], v209 offset:7168
  v_mfma_f32_32x32x16_bf16 v[16:31], a[72:75], a[0:3], 0
  ds_read_b64_tr_b16 a[88:89], v209 offset:8192
  ds_read_b64_tr_b16 a[90:91], v209 offset:9216
  v_and_b32 v234, 31, v208
  v_lshlrev_b32 v234, 6, v234
  v_lshrrev_b32 v238, 5, v208
  v_lshl_add_u32 v234, v238, 4, v234
  v_mfma_f32_32x32x16_bf16 v[16:31], a[76:79], a[4:7], v[16:31]
  ds_read_b64_tr_b16 a[92:93], v209 offset:10240
  ds_read_b64_tr_b16 a[94:95], v209 offset:11264
  v_add_u32 v234, 156672, v234
  ds_read_b128 v[144:147], v234 offset:0
  ds_read_b128 v[148:151], v234 offset:32
  ds_read_b128 v[152:155], v234 offset:2048
  s_waitcnt lgkmcnt(7)
  v_mfma_f32_32x32x16_bf16 v[16:31], a[80:83], a[8:11], v[16:31]
  ds_read_b64_tr_b16 a[72:73], v209 offset:12288
  ds_read_b64_tr_b16 a[74:75], v209 offset:13312
  ds_read_b128 v[156:159], v234 offset:2080
  v_bfe_u32 v235, v208, 4, 1
  v_lshlrev_b32 v235, 5, v235
  v_and_b32 v238, 3, v208
  v_mfma_f32_32x32x16_bf16 v[16:31], a[84:87], a[12:15], v[16:31]
  ds_read_b64_tr_b16 a[76:77], v209 offset:14336
  ds_read_b64_tr_b16 a[78:79], v209 offset:15360
  v_lshl_add_u32 v235, v238, 3, v235
  s_lshl_b32 s47, s46, 6
  s_add_u32 s47, s47, 147456
  v_add_u32 v235, s47, v235
  s_waitcnt lgkmcnt(8)
  v_mfma_f32_32x32x16_bf16 v[16:31], a[88:91], a[16:19], v[16:31]
  ds_read_b64_tr_b16 a[80:81], v209 offset:16384
  ds_read_b64_tr_b16 a[82:83], v209 offset:17408
  v_lshrrev_b32 v236, 5, v208
  v_lshlrev_b32 v236, 3, v236
  v_bfe_u32 v238, v208, 2, 2
  v_add_u32 v236, v236, v238
  v_mfma_f32_32x32x16_bf16 v[16:31], a[92:95], a[20:23], v[16:31]
  ds_read_b64_tr_b16 a[84:85], v209 offset:18432
  ds_read_b64_tr_b16 a[86:87], v209 offset:19456
  v_add_u32 v239, 0, v236
  v_min_u32 v239, 35, v239
  v_lshl_add_u32 v239, v239, 8, v235
  ds_read_b64_tr_b16 v[160:161], v239
  s_waitcnt lgkmcnt(5)
  v_mfma_f32_32x32x16_bf16 v[16:31], a[72:75], a[24:27], v[16:31]
  ds_read_b64_tr_b16 a[88:89], v209 offset:20480
  ds_read_b64_tr_b16 a[90:91], v209 offset:21504
  v_add_u32 v240, 4, v236
  v_min_u32 v240, 35, v240
  v_lshl_add_u32 v240, v240, 8, v235
  ds_read_b64_tr_b16 v[162:163], v240
  v_mfma_f32_32x32x16_bf16 v[16:31], a[76:79], a[28:31], v[16:31]
  ds_read_b64_tr_b16 a[92:93], v209 offset:22528
  ds_read_b64_tr_b16 a[94:95], v209 offset:23552
  v_add_u32 v239, 16, v236
  v_min_u32 v239, 35, v239
  v_lshl_add_u32 v239, v239, 8, v235
  s_waitcnt lgkmcnt(6)
  v_mfma_f32_32x32x16_bf16 v[16:31], a[80:83], a[32:35], v[16:31]
  ds_read_b64_tr_b16 a[72:73], v209 offset:24576
  ds_read_b64_tr_b16 a[74:75], v209 offset:25600
  ds_read_b64_tr_b16 v[164:165], v239
  v_add_u32 v240, 20, v236
  v_min_u32 v240, 35, v240
  v_lshl_add_u32 v240, v240, 8, v235
  v_mfma_f32_32x32x16_bf16 v[16:31], a[84:87], a[36:39], v[16:31]
  ds_read_b64_tr_b16 a[76:77], v209 offset:26624
  ds_read_b64_tr_b16 a[78:79], v209 offset:27648
  ds_read_b64_tr_b16 v[166:167], v240
  v_add_u32 v239, 16, v236
  v_min_u32 v239, 35, v239
  s_waitcnt lgkmcnt(6)
  v_mfma_f32_32x32x16_bf16 v[16:31], a[88:91], a[40:43], v[16:31]
  ds_read_b64_tr_b16 a[80:81], v209 offset:28672
  ds_read_b64_tr_b16 a[82:83], v209 offset:29696
  v_lshl_add_u32 v239, v239, 8, v235
  ds_read_b64_tr_b16 v[168:169], v239
  v_add_u32 v240, 20, v236
  v_min_u32 v240, 35, v240
  v_mfma_f32_32x32x16_bf16 v[16:31], a[92:95], a[44:47], v[16:31]
  ds_read_b64_tr_b16 a[84:85], v209 offset:30720
  ds_read_b64_tr_b16 a[86:87], v209 offset:31744
  v_lshl_add_u32 v240, v240, 8, v235
  ds_read_b64_tr_b16 v[170:171], v240
  v_add_u32 v239, 32, v236
  s_waitcnt lgkmcnt(7)
  v_mfma_f32_32x32x16_bf16 v[16:31], a[72:75], a[48:51], v[16:31]
  ds_read_b64_tr_b16 a[88:89], v209 offset:32768
  ds_read_b64_tr_b16 a[90:91], v209 offset:33792
  v_min_u32 v239, 35, v239
  v_lshl_add_u32 v239, v239, 8, v235
  ds_read_b64_tr_b16 v[172:173], v239
  v_add_u32 v240, 36, v236
  v_min_u32 v240, 35, v240
  v_lshl_add_u32 v240, v240, 8, v235
  ds_read_b64_tr_b16 v[174:175], v240
  v_mfma_f32_32x32x16_bf16 v[16:31], a[76:79], a[52:55], v[16:31]
  ds_read_b64_tr_b16 a[92:93], v209 offset:34816
  ds_read_b64_tr_b16 a[94:95], v209 offset:35840
  v_lshlrev_b32 v245, 5, v245
  s_waitcnt lgkmcnt(7)
  v_mfma_f32_32x32x16_bf16 v[16:31], a[80:83], a[56:59], v[16:31]
  ds_read_b64_tr_b16 a[72:73], v210 offset:36864
  ds_read_b64_tr_b16 a[74:75], v210 offset:37888
  v_mfma_f32_32x32x16_bf16 v[16:31], a[84:87], a[60:63], v[16:31]
  ds_read_b64_tr_b16 a[76:77], v210 offset:38912
  ds_read_b64_tr_b16 a[78:79], v210 offset:39936
  s_waitcnt lgkmcnt(4)
  v_mfma_f32_32x32x16_bf16 v[16:31], a[88:91], a[64:67], v[16:31]
  ds_read_b64_tr_b16 a[80:81], v210 offset:40960
  ds_read_b64_tr_b16 a[82:83], v210 offset:41984
  v_mfma_f32_32x32x16_bf16 v[16:31], a[92:95], a[68:71], v[16:31]
  s_barrier
  ds_read_b64_tr_b16 a[84:85], v210 offset:43008
  ds_read_b64_tr_b16 a[86:87], v210 offset:44032
  s_add_u32 m0, s73, 0
  s_add_u32 s71, s54, 0
  v_mov_b32 v255, 8
  buffer_store_dword v255, v253, s[40:43], s65 offen sc1
  s_waitcnt lgkmcnt(4)
  v_mfma_f32_32x32x16_bf16 v[32:47], a[72:75], a[0:3], 0
  ds_read_b64_tr_b16 a[88:89], v210 offset:45056
  ds_read_b64_tr_b16 a[90:91], v210 offset:46080
  buffer_load_dwordx4 v218, s[28:31], s71 offen lds
  v_mfma_f32_32x32x16_bf16 v[32:47], a[76:79], a[4:7], v[32:47]
  ds_read_b64_tr_b16 a[92:93], v210 offset:47104
  ds_read_b64_tr_b16 a[94:95], v210 offset:48128
  s_add_u32 m0, s73, 4096
  s_add_u32 s71, s54, 73728
  s_waitcnt lgkmcnt(4)
  v_mfma_f32_32x32x16_bf16 v[32:47], a[80:83], a[8:11], v[32:47]
  ds_read_b64_tr_b16 a[72:73], v210 offset:49152
  ds_read_b64_tr_b16 a[74:75], v210 offset:50176
  buffer_load_dwordx4 v218, s[28:31], s71 offen lds
  v_mfma_f32_32x32x16_bf16 v[32:47], a[84:87], a[12:15], v[32:47]
  ds_read_b64_tr_b16 a[76:77], v210 offset:51200
  ds_read_b64_tr_b16 a[78:79], v210 offset:52224
  s_add_u32 m0, s73, 8192
  s_add_u32 s71, s54, 147456
  s_waitcnt lgkmcnt(4)
  v_mfma_f32_32x32x16_bf16 v[32:47], a[88:91], a[16:19], v[32:47]
  ds_read_b64_tr_b16 a[80:81], v210 offset:53248
  ds_read_b64_tr_b16 a[82:83], v210 offset:54272
  buffer_load_dwordx4 v218, s[28:31], s71 offen lds
  v_mfma_f32_32x32x16_bf16 v[176:191], v[144:147], v[160:163], 0
  v_mfma_f32_32x32x16_bf16 v[176:191], v[148:151], v[164:167], v[176:191]
  v_mfma_f32_32x32x16_bf16 v[192:207], v[152:155], v[168:171], 0
  v_mfma_f32_32x32x16_bf16 v[192:207], v[156:159], v[172:175], v[192:207]
  v_mfma_f32_32x32x16_bf16 v[32:47], a[92:95], a[20:23], v[32:47]
  ds_read_b64_tr_b16 a[84:85], v210 offset:55296
  ds_read_b64_tr_b16 a[86:87], v210 offset:56320
  s_add_u32 m0, s73, 12288
  s_add_u32 s71, s54, 221184
  s_waitcnt lgkmcnt(4)
  v_mfma_f32_32x32x16_bf16 v[32:47], a[72:75], a[24:27], v[32:47]
  ds_read_b64_tr_b16 a[88:89], v210 offset:57344
  ds_read_b64_tr_b16 a[90:91], v210 offset:58368
  buffer_load_dwordx4 v218, s[28:31], s71 offen lds
  v_mfma_f32_32x32x16_bf16 v[32:47], a[76:79], a[28:31], v[32:47]
  ds_read_b64_tr_b16 a[92:93], v210 offset:59392
  ds_read_b64_tr_b16 a[94:95], v210 offset:60416
  s_and_b32 s71, s73, 1024
  s_add_u32 m0, s71, 16384
  s_mov_b32 s71, s55
  s_waitcnt lgkmcnt(4)
  v_mfma_f32_32x32x16_bf16 v[32:47], a[80:83], a[32:35], v[32:47]
  ds_read_b64_tr_b16 a[72:73], v210 offset:61440
  ds_read_b64_tr_b16 a[74:75], v210 offset:62464
  buffer_load_dwordx4 v218, s[28:31], s71 offen lds
  v_mfma_f32_32x32x16_bf16 v[32:47], a[84:87], a[36:39], v[32:47]
  ds_read_b64_tr_b16 a[76:77], v210 offset:63488
  ds_read_b64_tr_b16 a[78:79], v210 offset:64512
  s_lshl_b32 s47, s45, 2
  s_add_u32 s47, s47, s46
  s_mul_i32 s47, s47, 36
  s_waitcnt lgkmcnt(4)
  v_mfma_f32_32x32x16_bf16 v[32:47], a[88:91], a[40:43], v[32:47]
  v_add_u32 v210, 65536, v214
  ds_read_b64_tr_b16 a[80:81], v210 offset:0
  ds_read_b64_tr_b16 a[82:83], v210 offset:1024
  s_mul_i32 s68, s94, 9
  s_add_u32 s47, s47, s68
  s_lshl_b32 s47, s47, 10
  v_mfma_f32_32x32x16_bf16 v[32:47], a[92:95], a[44:47], v[32:47]
  ds_read_b64_tr_b16 a[84:85], v210 offset:2048
  ds_read_b64_tr_b16 a[86:87], v210 offset:3072
  s_add_u32 s47, s47, 37748736
  s_lshl_b32 s68, s95, 11
  s_waitcnt lgkmcnt(4)
  v_mfma_f32_32x32x16_bf16 v[32:47], a[72:75], a[48:51], v[32:47]
  ds_read_b64_tr_b16 a[88:89], v210 offset:4096
  ds_read_b64_tr_b16 a[90:91], v210 offset:5120
  s_add_u32 s68, s68, s47
  v_add_f32 v237, 0x358637bd, v186
  v_rcp_f32 v237, v237
  v_mfma_f32_32x32x16_bf16 v[32:47], a[76:79], a[52:55], v[32:47]
  ds_read_b64_tr_b16 a[92:93], v210 offset:6144
  ds_read_b64_tr_b16 a[94:95], v210 offset:7168
  v_mul_f32 v176, v176, v237
  v_and_b32 v246, 3, v208
  s_waitcnt lgkmcnt(4)
  v_mfma_f32_32x32x16_bf16 v[32:47], a[80:83], a[56:59], v[32:47]
  ds_read_b64_tr_b16 a[72:73], v209 offset:36864
  ds_read_b64_tr_b16 a[74:75], v209 offset:37888
  v_mul_f32 v177, v177, v237
  v_mul_f32 v178, v178, v237
  v_mul_f32 v179, v179, v237
  v_mfma_f32_32x32x16_bf16 v[32:47], a[84:87], a[60:63], v[32:47]
  ds_read_b64_tr_b16 a[76:77], v209 offset:38912
  ds_read_b64_tr_b16 a[78:79], v209 offset:39936
  v_mul_f32 v180, v180, v237
  v_mul_f32 v181, v181, v237
  s_waitcnt lgkmcnt(4)
  v_mfma_f32_32x32x16_bf16 v[32:47], a[88:91], a[64:67], v[32:47]
  ds_read_b64_tr_b16 a[80:81], v209 offset:40960
  ds_read_b64_tr_b16 a[82:83], v209 offset:41984
  v_mul_f32 v182, v182, v237
  v_mul_f32 v183, v183, v237
  v_mul_f32 v184, v184, v237
  v_mfma_f32_32x32x16_bf16 v[32:47], a[92:95], a[68:71], v[32:47]
  s_barrier
  ds_read_b64_tr_b16 a[84:85], v209 offset:43008
  ds_read_b64_tr_b16 a[86:87], v209 offset:44032
  s_waitcnt lgkmcnt(4)
  v_mfma_f32_32x32x16_bf16 v[48:63], a[72:75], a[0:3], 0
  ds_read_b64_tr_b16 a[88:89], v209 offset:45056
  ds_read_b64_tr_b16 a[90:91], v209 offset:46080
  v_mul_f32 v185, v185, v237
  v_cvt_pk_bf16_f32 v176, v176, v177
  v_cvt_pk_bf16_f32 v177, v178, v179
  v_cvt_pk_bf16_f32 v178, v180, v181
  v_mfma_f32_32x32x16_bf16 v[48:63], a[76:79], a[4:7], v[48:63]
  ds_read_b64_tr_b16 a[92:93], v209 offset:47104
  ds_read_b64_tr_b16 a[94:95], v209 offset:48128
  v_cvt_pk_bf16_f32 v179, v182, v183
  v_cvt_pk_bf16_f32 v180, v184, v185
  v_permlane32_swap_b32 v176, v178
  s_waitcnt lgkmcnt(4)
  v_mfma_f32_32x32x16_bf16 v[48:63], a[80:83], a[8:11], v[48:63]
  ds_read_b64_tr_b16 a[72:73], v209 offset:49152
  ds_read_b64_tr_b16 a[74:75], v209 offset:50176
  v_permlane32_swap_b32 v177, v179
  buffer_store_dwordx4 v[176:179], v224, s[40:43], s68 offen offset:0 sc1
  v_add_f32 v238, 0x358637bd, v202
  v_mfma_f32_32x32x16_bf16 v[48:63], a[84:87], a[12:15], v[48:63]
  ds_read_b64_tr_b16 a[76:77], v209 offset:51200
  ds_read_b64_tr_b16 a[78:79], v209 offset:52224
  v_rcp_f32 v238, v238
  s_waitcnt lgkmcnt(4)
  v_mfma_f32_32x32x16_bf16 v[48:63], a[88:91], a[16:19], v[48:63]
  ds_read_b64_tr_b16 a[80:81], v209 offset:53248
  ds_read_b64_tr_b16 a[82:83], v209 offset:54272
  v_mul_f32 v192, v192, v238
  v_mul_f32 v193, v193, v238
  v_mul_f32 v194, v194, v238
  v_mfma_f32_32x32x16_bf16 v[48:63], a[92:95], a[20:23], v[48:63]
  ds_read_b64_tr_b16 a[84:85], v209 offset:55296
  ds_read_b64_tr_b16 a[86:87], v209 offset:56320
  v_mul_f32 v195, v195, v238
  v_mul_f32 v196, v196, v238
  v_mul_f32 v197, v197, v238
  s_waitcnt lgkmcnt(4)
  v_mfma_f32_32x32x16_bf16 v[48:63], a[72:75], a[24:27], v[48:63]
  ds_read_b64_tr_b16 a[88:89], v209 offset:57344
  ds_read_b64_tr_b16 a[90:91], v209 offset:58368
  v_mul_f32 v198, v198, v238
  v_mul_f32 v199, v199, v238
  v_mfma_f32_32x32x16_bf16 v[48:63], a[76:79], a[28:31], v[48:63]
  ds_read_b64_tr_b16 a[92:93], v209 offset:59392
  ds_read_b64_tr_b16 a[94:95], v209 offset:60416
  v_mul_f32 v200, v200, v238
  v_mul_f32 v201, v201, v238
  v_cvt_pk_bf16_f32 v192, v192, v193
  s_waitcnt lgkmcnt(4)
  v_mfma_f32_32x32x16_bf16 v[48:63], a[80:83], a[32:35], v[48:63]
  ds_read_b64_tr_b16 a[72:73], v209 offset:61440
  ds_read_b64_tr_b16 a[74:75], v209 offset:62464
  v_cvt_pk_bf16_f32 v193, v194, v195
  v_cvt_pk_bf16_f32 v194, v196, v197
  v_mfma_f32_32x32x16_bf16 v[48:63], a[84:87], a[36:39], v[48:63]
  ds_read_b64_tr_b16 a[76:77], v209 offset:63488
  ds_read_b64_tr_b16 a[78:79], v209 offset:64512
  v_cvt_pk_bf16_f32 v195, v198, v199
  v_cvt_pk_bf16_f32 v196, v200, v201
  v_permlane32_swap_b32 v192, v194
  s_waitcnt lgkmcnt(4)
  v_mfma_f32_32x32x16_bf16 v[48:63], a[88:91], a[40:43], v[48:63]
  v_add_u32 v209, 65536, v211
  ds_read_b64_tr_b16 a[80:81], v209 offset:0
  ds_read_b64_tr_b16 a[82:83], v209 offset:1024
  v_permlane32_swap_b32 v193, v195
  buffer_store_dwordx4 v[192:195], v224, s[40:43], s68 offen offset:1024 sc1
  v_mfma_f32_32x32x16_bf16 v[48:63], a[92:95], a[44:47], v[48:63]
  ds_read_b64_tr_b16 a[84:85], v209 offset:2048
  ds_read_b64_tr_b16 a[86:87], v209 offset:3072
  v_mov_b32 v234, v180
  v_mov_b32 v235, v196
  v_lshrrev_b32 v236, 5, v208
  s_waitcnt lgkmcnt(4)
  v_mfma_f32_32x32x16_bf16 v[48:63], a[72:75], a[48:51], v[48:63]
  ds_read_b64_tr_b16 a[88:89], v209 offset:4096
  ds_read_b64_tr_b16 a[90:91], v209 offset:5120
  v_mul_u32_u24 v236, 0x700000, v236
  v_lshlrev_b32 v236, 8, v236
  v_lshl_add_u32 v245, v246, 3, v245
  v_mfma_f32_32x32x16_bf16 v[48:63], a[76:79], a[52:55], v[48:63]
  ds_read_b64_tr_b16 a[92:93], v209 offset:6144
  ds_read_b64_tr_b16 a[94:95], v209 offset:7168
  v_and_b32 v239, 31, v208
  v_lshl_add_u32 v236, v239, 4, v236
  s_lshr_b32 s68, s95, 1
  s_waitcnt lgkmcnt(4)
  v_mfma_f32_32x32x16_bf16 v[48:63], a[80:83], a[56:59], v[48:63]
  ds_read_b64_tr_b16 a[72:73], v210 offset:8192
  ds_read_b64_tr_b16 a[74:75], v210 offset:9216
  s_lshl_b32 s68, s68, 9
  s_add_u32 s47, s47, s68
  v_mfma_f32_32x32x16_bf16 v[48:63], a[84:87], a[60:63], v[48:63]
  ds_read_b64_tr_b16 a[76:77], v210 offset:10240
  ds_read_b64_tr_b16 a[78:79], v210 offset:11264
  s_and_b32 s68, s95, 1
  s_lshl_b32 s68, s68, 3
  s_add_u32 s47, s47, s68
  s_waitcnt lgkmcnt(4)
  v_mfma_f32_32x32x16_bf16 v[48:63], a[88:91], a[64:67], v[48:63]
  ds_read_b64_tr_b16 a[80:81], v210 offset:12288
  ds_read_b64_tr_b16 a[82:83], v210 offset:13312
  s_add_u32 s47, s47, 8192
  buffer_store_dwordx2 v[234:235], v236, s[40:43], s47 offen sc1
  v_mfma_f32_32x32x16_bf16 v[48:63], a[92:95], a[68:71], v[48:63]
  s_waitcnt vmcnt(9)
  s_barrier
  ds_read_b64_tr_b16 a[84:85], v210 offset:14336
  ds_read_b64_tr_b16 a[86:87], v210 offset:15360
  s_add_u32 m0, s72, 36864
  s_add_u32 s71, s51, 0
  v_mov_b32 v255, 9
  buffer_store_dword v255, v253, s[40:43], s65 offen sc1
  s_waitcnt lgkmcnt(4)
  v_mfma_f32_32x32x16_bf16 v[64:79], a[72:75], a[0:3], 0
  ds_read_b64_tr_b16 a[88:89], v210 offset:16384
  ds_read_b64_tr_b16 a[90:91], v210 offset:17408
  buffer_load_dwordx4 v215, s[28:31], s71 offen offset:0 lds
  v_mfma_f32_32x32x16_bf16 v[64:79], a[76:79], a[4:7], v[64:79]
  ds_read_b64_tr_b16 a[92:93], v210 offset:18432
  ds_read_b64_tr_b16 a[94:95], v210 offset:19456
  s_waitcnt lgkmcnt(4)
  v_mfma_f32_32x32x16_bf16 v[64:79], a[80:83], a[8:11], v[64:79]
  ds_read_b64_tr_b16 a[72:73], v210 offset:20480
  ds_read_b64_tr_b16 a[74:75], v210 offset:21504
  buffer_load_dwordx4 v216, s[28:31], s71 offen offset:1024 lds
  v_mfma_f32_32x32x16_bf16 v[64:79], a[84:87], a[12:15], v[64:79]
  ds_read_b64_tr_b16 a[76:77], v210 offset:22528
  ds_read_b64_tr_b16 a[78:79], v210 offset:23552
  s_waitcnt lgkmcnt(4)
  v_mfma_f32_32x32x16_bf16 v[64:79], a[88:91], a[16:19], v[64:79]
  ds_read_b64_tr_b16 a[80:81], v210 offset:24576
  ds_read_b64_tr_b16 a[82:83], v210 offset:25600
  buffer_load_dwordx4 v217, s[28:31], s71 offen offset:2048 lds
  v_mfma_f32_32x32x16_bf16 v[64:79], a[92:95], a[20:23], v[64:79]
  ds_read_b64_tr_b16 a[84:85], v210 offset:26624
  ds_read_b64_tr_b16 a[86:87], v210 offset:27648
  s_add_u32 m0, s72, 49152
  s_add_u32 s71, s51, 110592
  buffer_load_dword v251, v252, s[40:43], s67 offen sc1
  s_waitcnt lgkmcnt(4)
  v_mfma_f32_32x32x16_bf16 v[64:79], a[72:75], a[24:27], v[64:79]
  ds_read_b64_tr_b16 a[88:89], v210 offset:28672
  ds_read_b64_tr_b16 a[90:91], v210 offset:29696
  buffer_load_dwordx4 v215, s[28:31], s71 offen offset:0 lds
  v_mfma_f32_32x32x16_bf16 v[64:79], a[76:79], a[28:31], v[64:79]
  ds_read_b64_tr_b16 a[92:93], v210 offset:30720
  ds_read_b64_tr_b16 a[94:95], v210 offset:31744
  s_waitcnt lgkmcnt(4)
  v_mfma_f32_32x32x16_bf16 v[64:79], a[80:83], a[32:35], v[64:79]
  ds_read_b64_tr_b16 a[72:73], v210 offset:32768
  ds_read_b64_tr_b16 a[74:75], v210 offset:33792
  buffer_load_dwordx4 v216, s[28:31], s71 offen offset:1024 lds
  v_mfma_f32_32x32x16_bf16 v[64:79], a[84:87], a[36:39], v[64:79]
  ds_read_b64_tr_b16 a[76:77], v210 offset:34816
  ds_read_b64_tr_b16 a[78:79], v210 offset:35840
  s_waitcnt lgkmcnt(4)
  v_mfma_f32_32x32x16_bf16 v[64:79], a[88:91], a[40:43], v[64:79]
  ds_read_b64_tr_b16 a[80:81], v210 offset:36864
  ds_read_b64_tr_b16 a[82:83], v210 offset:37888
  buffer_load_dwordx4 v217, s[28:31], s71 offen offset:2048 lds
  v_add_u32 v212, v212, v245
  v_add_u32 v245, 0, v208
  v_mfma_f32_32x32x16_bf16 v[64:79], a[92:95], a[44:47], v[64:79]
  ds_read_b64_tr_b16 a[84:85], v210 offset:38912
  ds_read_b64_tr_b16 a[86:87], v210 offset:39936
  s_add_u32 m0, s73, 61440
  s_add_u32 s71, s52, 221184
  v_mul_u32_u24 v246, 205, v245
  s_waitcnt lgkmcnt(4)
  v_mfma_f32_32x32x16_bf16 v[64:79], a[72:75], a[48:51], v[64:79]
  ds_read_b64_tr_b16 a[88:89], v210 offset:40960
  ds_read_b64_tr_b16 a[90:91], v210 offset:41984
  buffer_load_dwordx4 v215, s[28:31], s71 offen lds
  v_lshrrev_b32 v246, 12, v246
  v_mul_u32_u24 v247, 20, v246
  v_mfma_f32_32x32x16_bf16 v[64:79], a[76:79], a[52:55], v[64:79]
  ds_read_b64_tr_b16 a[92:93], v210 offset:43008
  ds_read_b64_tr_b16 a[94:95], v210 offset:44032
  s_add_u32 m0, s73, 65536
  s_add_u32 s71, s52, 258048
  v_sub_u32 v245, v245, v247
  s_waitcnt lgkmcnt(4)
  v_mfma_f32_32x32x16_bf16 v[64:79], a[80:83], a[56:59], v[64:79]
  ds_read_b64_tr_b16 a[72:73], v209 offset:8192
  ds_read_b64_tr_b16 a[74:75], v209 offset:9216
  buffer_load_dwordx4 v215, s[28:31], s71 offen lds
  v_mul_u32_u24 v246, 1152, v246
  v_lshl_add_u32 v219, v245, 4, v246
  v_mfma_f32_32x32x16_bf16 v[64:79], a[84:87], a[60:63], v[64:79]
  ds_read_b64_tr_b16 a[76:77], v209 offset:10240
  ds_read_b64_tr_b16 a[78:79], v209 offset:11264
  s_add_u32 m0, s73, 69632
  s_add_u32 s71, s53, 294912
  v_add_u32 v245, 64, v208
  s_waitcnt lgkmcnt(4)
  v_mfma_f32_32x32x16_bf16 v[64:79], a[88:91], a[64:67], v[64:79]
  ds_read_b64_tr_b16 a[80:81], v209 offset:12288
  ds_read_b64_tr_b16 a[82:83], v209 offset:13312
  buffer_load_dwordx4 v215, s[28:31], s71 offen lds
  v_mul_u32_u24 v246, 205, v245
  v_lshrrev_b32 v246, 12, v246
  v_mfma_f32_32x32x16_bf16 v[64:79], a[92:95], a[68:71], v[64:79]
  s_barrier
  ds_read_b64_tr_b16 a[84:85], v209 offset:14336
  ds_read_b64_tr_b16 a[86:87], v209 offset:15360
  s_waitcnt lgkmcnt(4)
  v_mfma_f32_32x32x16_bf16 v[80:95], a[72:75], a[0:3], 0
  ds_read_b64_tr_b16 a[88:89], v209 offset:16384
  ds_read_b64_tr_b16 a[90:91], v209 offset:17408
  v_mul_u32_u24 v247, 20, v246
  v_sub_u32 v245, v245, v247
  v_mul_u32_u24 v246, 1152, v246
  v_lshl_add_u32 v220, v245, 4, v246
  v_mfma_f32_32x32x16_bf16 v[80:95], a[76:79], a[4:7], v[80:95]
  ds_read_b64_tr_b16 a[92:93], v209 offset:18432
  ds_read_b64_tr_b16 a[94:95], v209 offset:19456
  v_subrev_u32 v220, 1024, v220
  v_add_u32 v245, 128, v208
  v_mul_u32_u24 v246, 205, v245
  s_waitcnt lgkmcnt(4)
  v_mfma_f32_32x32x16_bf16 v[80:95], a[80:83], a[8:11], v[80:95]
  ds_read_b64_tr_b16 a[72:73], v209 offset:20480
  ds_read_b64_tr_b16 a[74:75], v209 offset:21504
  v_lshrrev_b32 v246, 12, v246
  v_mul_u32_u24 v247, 20, v246
  v_sub_u32 v245, v245, v247
  v_mfma_f32_32x32x16_bf16 v[80:95], a[84:87], a[12:15], v[80:95]
  ds_read_b64_tr_b16 a[76:77], v209 offset:22528
  ds_read_b64_tr_b16 a[78:79], v209 offset:23552
  s_waitcnt lgkmcnt(4)
  v_mfma_f32_32x32x16_bf16 v[80:95], a[88:91], a[16:19], v[80:95]
  ds_read_b64_tr_b16 a[80:81], v209 offset:24576
  ds_read_b64_tr_b16 a[82:83], v209 offset:25600
  v_mfma_f32_32x32x16_bf16 v[80:95], a[92:95], a[20:23], v[80:95]
  ds_read_b64_tr_b16 a[84:85], v209 offset:26624
  ds_read_b64_tr_b16 a[86:87], v209 offset:27648
  s_waitcnt lgkmcnt(4)
  v_mfma_f32_32x32x16_bf16 v[80:95], a[72:75], a[24:27], v[80:95]
  ds_read_b64_tr_b16 a[88:89], v209 offset:28672
  ds_read_b64_tr_b16 a[90:91], v209 offset:29696
  v_mfma_f32_32x32x16_bf16 v[80:95], a[76:79], a[28:31], v[80:95]
  ds_read_b64_tr_b16 a[92:93], v209 offset:30720
  ds_read_b64_tr_b16 a[94:95], v209 offset:31744
  v_mul_u32_u24 v246, 1152, v246
  s_waitcnt lgkmcnt(4)
  v_mfma_f32_32x32x16_bf16 v[80:95], a[80:83], a[32:35], v[80:95]
  ds_read_b64_tr_b16 a[72:73], v209 offset:32768
  ds_read_b64_tr_b16 a[74:75], v209 offset:33792
  v_mfma_f32_32x32x16_bf16 v[80:95], a[84:87], a[36:39], v[80:95]
  ds_read_b64_tr_b16 a[76:77], v209 offset:34816
  ds_read_b64_tr_b16 a[78:79], v209 offset:35840
  s_waitcnt lgkmcnt(4)
  v_mfma_f32_32x32x16_bf16 v[80:95], a[88:91], a[40:43], v[80:95]
  ds_read_b64_tr_b16 a[80:81], v209 offset:36864
  ds_read_b64_tr_b16 a[82:83], v209 offset:37888
  v_mfma_f32_32x32x16_bf16 v[80:95], a[92:95], a[44:47], v[80:95]
  ds_read_b64_tr_b16 a[84:85], v209 offset:38912
  ds_read_b64_tr_b16 a[86:87], v209 offset:39936
  s_waitcnt lgkmcnt(4)
  v_mfma_f32_32x32x16_bf16 v[80:95], a[72:75], a[48:51], v[80:95]
  ds_read_b64_tr_b16 a[88:89], v209 offset:40960
  ds_read_b64_tr_b16 a[90:91], v209 offset:41984
  v_mfma_f32_32x32x16_bf16 v[80:95], a[76:79], a[52:55], v[80:95]
  ds_read_b64_tr_b16 a[92:93], v209 offset:43008
  ds_read_b64_tr_b16 a[94:95], v209 offset:44032
  s_waitcnt lgkmcnt(4)
  v_mfma_f32_32x32x16_bf16 v[80:95], a[80:83], a[56:59], v[80:95]
  ds_read_b64_tr_b16 a[72:73], v210 offset:45056
  ds_read_b64_tr_b16 a[74:75], v210 offset:46080
  v_lshl_add_u32 v221, v245, 4, v246
  v_mfma_f32_32x32x16_bf16 v[80:95], a[84:87], a[60:63], v[80:95]
  ds_read_b64_tr_b16 a[76:77], v210 offset:47104
  ds_read_b64_tr_b16 a[78:79], v210 offset:48128
  s_waitcnt lgkmcnt(4)
  v_mfma_f32_32x32x16_bf16 v[80:95], a[88:91], a[64:67], v[80:95]
  ds_read_b64_tr_b16 a[80:81], v210 offset:49152
  ds_read_b64_tr_b16 a[82:83], v210 offset:50176
  v_mfma_f32_32x32x16_bf16 v[80:95], a[92:95], a[68:71], v[80:95]
  s_waitcnt vmcnt(11)
  s_barrier
  ds_read_b64_tr_b16 a[84:85], v210 offset:51200
  ds_read_b64_tr_b16 a[86:87], v210 offset:52224
  s_add_u32 m0, s72, 73728
  s_add_u32 s71, s51, 128
  v_mov_b32 v255, 1
  buffer_store_dword v255, v253, s[40:43], s64 offen sc1
  s_waitcnt lgkmcnt(4)
  v_mfma_f32_32x32x16_bf16 v[96:111], a[72:75], a[0:3], 0
  ds_read_b64_tr_b16 a[88:89], v210 offset:53248
  ds_read_b64_tr_b16 a[90:91], v210 offset:54272
  buffer_load_dwordx4 v215, s[28:31], s71 offen offset:0 lds
  v_mfma_f32_32x32x16_bf16 v[96:111], a[76:79], a[4:7], v[96:111]
  ds_read_b64_tr_b16 a[92:93], v210 offset:55296
  ds_read_b64_tr_b16 a[94:95], v210 offset:56320
  s_waitcnt lgkmcnt(4)
  v_mfma_f32_32x32x16_bf16 v[96:111], a[80:83], a[8:11], v[96:111]
  ds_read_b64_tr_b16 a[72:73], v210 offset:57344
  ds_read_b64_tr_b16 a[74:75], v210 offset:58368
  buffer_load_dwordx4 v216, s[28:31], s71 offen offset:1024 lds
  v_mfma_f32_32x32x16_bf16 v[96:111], a[84:87], a[12:15], v[96:111]
  ds_read_b64_tr_b16 a[76:77], v210 offset:59392
  ds_read_b64_tr_b16 a[78:79], v210 offset:60416
  s_waitcnt lgkmcnt(4)
  v_mfma_f32_32x32x16_bf16 v[96:111], a[88:91], a[16:19], v[96:111]
  ds_read_b64_tr_b16 a[80:81], v210 offset:61440
  ds_read_b64_tr_b16 a[82:83], v210 offset:62464
  buffer_load_dwordx4 v217, s[28:31], s71 offen offset:2048 lds
  v_subrev_u32 v221, 2048, v221
  v_mfma_f32_32x32x16_bf16 v[96:111], a[92:95], a[20:23], v[96:111]
  ds_read_b64_tr_b16 a[84:85], v210 offset:63488
  ds_read_b64_tr_b16 a[86:87], v210 offset:64512
  s_add_u32 m0, s72, 86016
  s_add_u32 s71, s51, 110720
  s_waitcnt lgkmcnt(4)
  v_mfma_f32_32x32x16_bf16 v[96:111], a[72:75], a[24:27], v[96:111]
  v_add_u32 v210, 131072, v214
  ds_read_b64_tr_b16 a[88:89], v210 offset:0
  ds_read_b64_tr_b16 a[90:91], v210 offset:1024
  buffer_load_dwordx4 v215, s[28:31], s71 offen offset:0 lds
  v_mfma_f32_32x32x16_bf16 v[96:111], a[76:79], a[28:31], v[96:111]
  ds_read_b64_tr_b16 a[92:93], v210 offset:2048
  ds_read_b64_tr_b16 a[94:95], v210 offset:3072
  s_waitcnt lgkmcnt(4)
  v_mfma_f32_32x32x16_bf16 v[96:111], a[80:83], a[32:35], v[96:111]
  ds_read_b64_tr_b16 a[72:73], v210 offset:4096
  ds_read_b64_tr_b16 a[74:75], v210 offset:5120
  buffer_load_dwordx4 v216, s[28:31], s71 offen offset:1024 lds
  v_mfma_f32_32x32x16_bf16 v[96:111], a[84:87], a[36:39], v[96:111]
  ds_read_b64_tr_b16 a[76:77], v210 offset:6144
  ds_read_b64_tr_b16 a[78:79], v210 offset:7168
  s_waitcnt lgkmcnt(4)
  v_mfma_f32_32x32x16_bf16 v[96:111], a[88:91], a[40:43], v[96:111]
  ds_read_b64_tr_b16 a[80:81], v210 offset:8192
  ds_read_b64_tr_b16 a[82:83], v210 offset:9216
  buffer_load_dwordx4 v217, s[28:31], s71 offen offset:2048 lds
  v_mfma_f32_32x32x16_bf16 v[96:111], a[92:95], a[44:47], v[96:111]
  ds_read_b64_tr_b16 a[84:85], v210 offset:10240
  ds_read_b64_tr_b16 a[86:87], v210 offset:11264
  s_add_u32 m0, s73, 98304
  s_add_u32 s71, s52, 221312
  v_add_u32 v245, 192, v208
  s_waitcnt lgkmcnt(4)
  v_mfma_f32_32x32x16_bf16 v[96:111], a[72:75], a[48:51], v[96:111]
  ds_read_b64_tr_b16 a[88:89], v210 offset:12288
  ds_read_b64_tr_b16 a[90:91], v210 offset:13312
  buffer_load_dwordx4 v215, s[28:31], s71 offen lds
  v_mfma_f32_32x32x16_bf16 v[96:111], a[76:79], a[52:55], v[96:111]
  ds_read_b64_tr_b16 a[92:93], v210 offset:14336
  ds_read_b64_tr_b16 a[94:95], v210 offset:15360
  s_add_u32 m0, s73, 102400
  s_add_u32 s71, s52, 258176
  s_waitcnt lgkmcnt(4)
  v_mfma_f32_32x32x16_bf16 v[96:111], a[80:83], a[56:59], v[96:111]
  ds_read_b64_tr_b16 a[72:73], v209 offset:45056
  ds_read_b64_tr_b16 a[74:75], v209 offset:46080
  buffer_load_dwordx4 v215, s[28:31], s71 offen lds
  v_mfma_f32_32x32x16_bf16 v[96:111], a[84:87], a[60:63], v[96:111]
  ds_read_b64_tr_b16 a[76:77], v209 offset:47104
  ds_read_b64_tr_b16 a[78:79], v209 offset:48128
  s_add_u32 m0, s73, 106496
  s_add_u32 s71, s53, 295040
  s_waitcnt lgkmcnt(4)
  v_mfma_f32_32x32x16_bf16 v[96:111], a[88:91], a[64:67], v[96:111]
  ds_read_b64_tr_b16 a[80:81], v209 offset:49152
  ds_read_b64_tr_b16 a[82:83], v209 offset:50176
  buffer_load_dwordx4 v215, s[28:31], s71 offen lds
  v_mfma_f32_32x32x16_bf16 v[96:111], a[92:95], a[68:71], v[96:111]
  s_barrier
  ds_read_b64_tr_b16 a[84:85], v209 offset:51200
  ds_read_b64_tr_b16 a[86:87], v209 offset:52224
  s_waitcnt lgkmcnt(4)
  v_mfma_f32_32x32x16_bf16 v[112:127], a[72:75], a[0:3], 0
  ds_read_b64_tr_b16 a[88:89], v209 offset:53248
  ds_read_b64_tr_b16 a[90:91], v209 offset:54272
  v_mfma_f32_32x32x16_bf16 v[112:127], a[76:79], a[4:7], v[112:127]
  ds_read_b64_tr_b16 a[92:93], v209 offset:55296
  ds_read_b64_tr_b16 a[94:95], v209 offset:56320
  s_waitcnt vmcnt(16)
  v_cmp_gt_u32 vcc, 8, v251
  s_nop 3
  s_cbranch_vccnz L_slow5
L_ret5:
  v_mul_u32_u24 v246, 205, v245
  s_waitcnt lgkmcnt(4)
  v_mfma_f32_32x32x16_bf16 v[112:127], a[80:83], a[8:11], v[112:127]
  ds_read_b64_tr_b16 a[72:73], v209 offset:57344
  ds_read_b64_tr_b16 a[74:75], v209 offset:58368
  s_add_u32 s84, s61, 12288
  buffer_load_dwordx4 a[144:147], v224, s[40:43], s84 offen sc1
  s_add_u32 s84, s61, 13312
  buffer_load_dwordx4 a[148:151], v224, s[40:43], s84 offen sc1
  v_mfma_f32_32x32x16_bf16 v[112:127], a[84:87], a[12:15], v[112:127]
  ds_read_b64_tr_b16 a[76:77], v209 offset:59392
  ds_read_b64_tr_b16 a[78:79], v209 offset:60416
  s_add_u32 s84, s61, 14336
  buffer_load_dwordx4 a[152:155], v224, s[40:43], s84 offen sc1
  s_add_u32 s84, s61, 15360
  s_waitcnt lgkmcnt(4)
  v_mfma_f32_32x32x16_bf16 v[112:127], a[88:91], a[16:19], v[112:127]
  ds_read_b64_tr_b16 a[80:81], v209 offset:61440
  ds_read_b64_tr_b16 a[82:83], v209 offset:62464
  buffer_load_dwordx4 a[156:159], v224, s[40:43], s84 offen sc1
  v_mfma_f32_32x32x16_bf16 v[112:127], a[92:95], a[20:23], v[112:127]
  ds_read_b64_tr_b16 a[84:85], v209 offset:63488
  ds_read_b64_tr_b16 a[86:87], v209 offset:64512
  s_waitcnt lgkmcnt(4)
  v_mfma_f32_32x32x16_bf16 v[112:127], a[72:75], a[24:27], v[112:127]
  v_add_u32 v209, 131072, v211
  ds_read_b64_tr_b16 a[88:89], v209 offset:0
  ds_read_b64_tr_b16 a[90:91], v209 offset:1024
  v_mfma_f32_32x32x16_bf16 v[112:127], a[76:79], a[28:31], v[112:127]
  ds_read_b64_tr_b16 a[92:93], v209 offset:2048
  ds_read_b64_tr_b16 a[94:95], v209 offset:3072
  buffer_load_dword v251, v252, s[40:43], s67 offen sc1
  s_waitcnt lgkmcnt(4)
  v_mfma_f32_32x32x16_bf16 v[112:127], a[80:83], a[32:35], v[112:127]
  ds_read_b64_tr_b16 a[72:73], v209 offset:4096
  ds_read_b64_tr_b16 a[74:75], v209 offset:5120
  v_lshrrev_b32 v246, 12, v246
  v_mfma_f32_32x32x16_bf16 v[112:127], a[84:87], a[36:39], v[112:127]
  ds_read_b64_tr_b16 a[76:77], v209 offset:6144
  ds_read_b64_tr_b16 a[78:79], v209 offset:7168
  s_waitcnt lgkmcnt(4)
  v_mfma_f32_32x32x16_bf16 v[112:127], a[88:91], a[40:43], v[112:127]
  ds_read_b64_tr_b16 a[80:81], v209 offset:8192
  ds_read_b64_tr_b16 a[82:83], v209 offset:9216
  v_mfma_f32_32x32x16_bf16 v[112:127], a[92:95], a[44:47], v[112:127]
  ds_read_b64_tr_b16 a[84:85], v209 offset:10240
  ds_read_b64_tr_b16 a[86:87], v209 offset:11264
  s_waitcnt lgkmcnt(4)
  v_mfma_f32_32x32x16_bf16 v[112:127], a[72:75], a[48:51], v[112:127]
  ds_read_b64_tr_b16 a[88:89], v209 offset:12288
  ds_read_b64_tr_b16 a[90:91], v209 offset:13312
  v_mfma_f32_32x32x16_bf16 v[112:127], a[76:79], a[52:55], v[112:127]
  ds_read_b64_tr_b16 a[92:93], v209 offset:14336
  ds_read_b64_tr_b16 a[94:95], v209 offset:15360
  s_waitcnt lgkmcnt(4)
  v_mfma_f32_32x32x16_bf16 v[112:127], a[80:83], a[56:59], v[112:127]
  v_mov_b32 v210, v212
  ds_read_b64_tr_b16 a[72:73], v210 offset:0
  ds_read_b64_tr_b16 a[74:75], v210 offset:512
  v_mfma_f32_32x32x16_bf16 v[112:127], a[84:87], a[60:63], v[112:127]
  ds_read_b64_tr_b16 a[76:77], v210 offset:1024
  ds_read_b64_tr_b16 a[78:79], v210 offset:1536
  s_waitcnt lgkmcnt(4)
  v_mfma_f32_32x32x16_bf16 v[112:127], a[88:91], a[64:67], v[112:127]
  ds_read_b64_tr_b16 a[80:81], v210 offset:2048
  ds_read_b64_tr_b16 a[82:83], v210 offset:2560
  v_mul_u32_u24 v247, 20, v246
  v_mfma_f32_32x32x16_bf16 v[112:127], a[92:95], a[68:71], v[112:127]
  s_barrier
  ds_read_b64_tr_b16 a[84:85], v210 offset:3072
  ds_read_b64_tr_b16 a[86:87], v210 offset:3584
  s_add_u32 m0, s72, 110592
  s_add_u32 s71, s51, 256
  s_waitcnt lgkmcnt(4)
  v_mfma_f32_32x32x16_bf16 v[128:143], a[72:75], a[0:3], 0
  ds_read_b64_tr_b16 a[88:89], v210 offset:4096
  ds_read_b64_tr_b16 a[90:91], v210 offset:4608
  buffer_load_dwordx4 v215, s[28:31], s71 offen offset:0 lds
  v_mfma_f32_32x32x16_bf16 v[128:143], a[76:79], a[4:7], v[128:143]
  ds_read_b64_tr_b16 a[92:93], v210 offset:5120
  ds_read_b64_tr_b16 a[94:95], v210 offset:5632
  s_waitcnt lgkmcnt(4)
  v_mfma_f32_32x32x16_bf16 v[128:143], a[80:83], a[8:11], v[128:143]
  ds_read_b64_tr_b16 a[72:73], v210 offset:6144
  ds_read_b64_tr_b16 a[74:75], v210 offset:6656
  buffer_load_dwordx4 v216, s[28:31], s71 offen offset:1024 lds
  v_mfma_f32_32x32x16_bf16 v[128:143], a[84:87], a[12:15], v[128:143]
  ds_read_b64_tr_b16 a[76:77], v210 offset:7168
  ds_read_b64_tr_b16 a[78:79], v210 offset:7680
  s_waitcnt lgkmcnt(4)
  v_mfma_f32_32x32x16_bf16 v[128:143], a[88:91], a[16:19], v[128:143]
  ds_read_b64_tr_b16 a[80:81], v210 offset:8192
  ds_read_b64_tr_b16 a[82:83], v210 offset:8704
  buffer_load_dwordx4 v217, s[28:31], s71 offen offset:2048 lds
  v_mfma_f32_32x32x16_bf16 v[128:143], a[92:95], a[20:23], v[128:143]
  ds_read_b64_tr_b16 a[84:85], v210 offset:9216
  ds_read_b64_tr_b16 a[86:87], v210 offset:9728
  s_add_u32 m0, s72, 122880
  s_add_u32 s71, s51, 110848
  v_sub_u32 v245, v245, v247
  s_waitcnt lgkmcnt(4)
  v_mfma_f32_32x32x16_bf16 v[128:143], a[72:75], a[24:27], v[128:143]
  ds_read_b64_tr_b16 a[88:89], v210 offset:10240
  ds_read_b64_tr_b16 a[90:91], v210 offset:10752
  buffer_load_dwordx4 v215, s[28:31], s71 offen offset:0 lds
  v_mfma_f32_32x32x16_bf16 v[128:143], a[76:79], a[28:31], v[128:143]
  ds_read_b64_tr_b16 a[92:93], v210 offset:11264
  ds_read_b64_tr_b16 a[94:95], v210 offset:11776
  s_waitcnt lgkmcnt(4)
  v_mfma_f32_32x32x16_bf16 v[128:143], a[80:83], a[32:35], v[128:143]
  ds_read_b64_tr_b16 a[72:73], v210 offset:12288
  ds_read_b64_tr_b16 a[74:75], v210 offset:12800
  buffer_load_dwordx4 v216, s[28:31], s71 offen offset:1024 lds
  v_mfma_f32_32x32x16_bf16 v[128:143], a[84:87], a[36:39], v[128:143]
  ds_read_b64_tr_b16 a[76:77], v210 offset:13312
  ds_read_b64_tr_b16 a[78:79], v210 offset:13824
  s_waitcnt lgkmcnt(4)
  v_mfma_f32_32x32x16_bf16 v[128:143], a[88:91], a[40:43], v[128:143]
  ds_read_b64_tr_b16 a[80:81], v210 offset:14336
  ds_read_b64_tr_b16 a[82:83], v210 offset:14848
  buffer_load_dwordx4 v217, s[28:31], s71 offen offset:2048 lds
  v_mfma_f32_32x32x16_bf16 v[128:143], a[92:95], a[44:47], v[128:143]
  ds_read_b64_tr_b16 a[84:85], v210 offset:15360
  ds_read_b64_tr_b16 a[86:87], v210 offset:15872
  s_add_u32 m0, s73, 135168
  s_add_u32 s71, s52, 221440
  s_waitcnt lgkmcnt(4)
  v_mfma_f32_32x32x16_bf16 v[128:143], a[72:75], a[48:51], v[128:143]
  ds_read_b64_tr_b16 a[88:89], v210 offset:16384
  ds_read_b64_tr_b16 a[90:91], v210 offset:16896
  buffer_load_dwordx4 v215, s[28:31], s71 offen lds
  v_mfma_f32_32x32x16_bf16 v[128:143], a[76:79], a[52:55], v[128:143]
  ds_read_b64_tr_b16 a[92:93], v210 offset:17408
  ds_read_b64_tr_b16 a[94:95], v210 offset:17920
  s_add_u32 m0, s73, 139264
  s_add_u32 s71, s52, 258304
  v_mul_u32_u24 v246, 1152, v246
  s_waitcnt lgkmcnt(4)
  v_mfma_f32_32x32x16_bf16 v[128:143], a[80:83], a[56:59], v[128:143]
  v_add_u32 v209, 36864, v214
  ds_read_b64_tr_b16 a[72:73], v209 offset:0
  ds_read_b64_tr_b16 a[74:75], v209 offset:1024
  buffer_load_dwordx4 v215, s[28:31], s71 offen lds
  v_mfma_f32_32x32x16_bf16 v[128:143], a[84:87], a[60:63], v[128:143]
  ds_read_b64_tr_b16 a[76:77], v209 offset:2048
  ds_read_b64_tr_b16 a[78:79], v209 offset:3072
  s_add_u32 m0, s73, 143360
  s_add_u32 s71, s53, 295168
  s_waitcnt lgkmcnt(4)
  v_mfma_f32_32x32x16_bf16 v[128:143], a[88:91], a[64:67], v[128:143]
  ds_read_b64_tr_b16 a[80:81], v209 offset:4096
  ds_read_b64_tr_b16 a[82:83], v209 offset:5120
  buffer_load_dwordx4 v215, s[28:31], s71 offen lds
  v_mfma_f32_32x32x16_bf16 v[128:143], a[92:95], a[68:71], v[128:143]
  s_waitcnt vmcnt(27)
  s_barrier
  ds_read_b64_tr_b16 a[84:85], v209 offset:6144
  ds_read_b64_tr_b16 a[86:87], v209 offset:7168
  s_add_u32 m0, s72, 0
  s_add_u32 s71, s51, 384
  s_waitcnt lgkmcnt(4)
  v_mfma_f32_32x32x16_bf16 v[0:15], a[72:75], a[96:99], v[0:15]
  ds_read_b64_tr_b16 a[88:89], v209 offset:8192
  ds_read_b64_tr_b16 a[90:91], v209 offset:9216
  buffer_load_dwordx4 v215, s[28:31], s71 offen offset:0 lds
  v_mfma_f32_32x32x16_bf16 v[0:15], a[76:79], a[100:103], v[0:15]
  ds_read_b64_tr_b16 a[92:93], v209 offset:10240
  ds_read_b64_tr_b16 a[94:95], v209 offset:11264
  s_waitcnt lgkmcnt(4)
  v_mfma_f32_32x32x16_bf16 v[0:15], a[80:83], a[104:107], v[0:15]
  ds_read_b64_tr_b16 a[72:73], v209 offset:12288
  ds_read_b64_tr_b16 a[74:75], v209 offset:13312
  buffer_load_dwordx4 v216, s[28:31], s71 offen offset:1024 lds
  v_lshl_add_u32 v222, v245, 4, v246
  v_mfma_f32_32x32x16_bf16 v[0:15], a[84:87], a[108:111], v[0:15]
  ds_read_b64_tr_b16 a[76:77], v209 offset:14336
  ds_read_b64_tr_b16 a[78:79], v209 offset:15360
  s_waitcnt lgkmcnt(4)
  v_mfma_f32_32x32x16_bf16 v[0:15], a[88:91], a[112:115], v[0:15]
  ds_read_b64_tr_b16 a[80:81], v209 offset:16384
  ds_read_b64_tr_b16 a[82:83], v209 offset:17408
  buffer_load_dwordx4 v217, s[28:31], s71 offen offset:2048 lds
  v_mfma_f32_32x32x16_bf16 v[0:15], a[92:95], a[116:119], v[0:15]
  ds_read_b64_tr_b16 a[84:85], v209 offset:18432
  ds_read_b64_tr_b16 a[86:87], v209 offset:19456
  s_add_u32 m0, s72, 12288
  s_add_u32 s71, s51, 110976
  s_waitcnt lgkmcnt(4)
  v_mfma_f32_32x32x16_bf16 v[0:15], a[72:75], a[120:123], v[0:15]
  ds_read_b64_tr_b16 a[88:89], v209 offset:20480
  ds_read_b64_tr_b16 a[90:91], v209 offset:21504
  buffer_load_dwordx4 v215, s[28:31], s71 offen offset:0 lds
  v_mfma_f32_32x32x16_bf16 v[0:15], a[76:79], a[124:127], v[0:15]
  ds_read_b64_tr_b16 a[92:93], v209 offset:22528
  ds_read_b64_tr_b16 a[94:95], v209 offset:23552
  s_waitcnt lgkmcnt(4)
  v_mfma_f32_32x32x16_bf16 v[0:15], a[80:83], a[128:131], v[0:15]
  v_add_u32 v210, 36864, v211
  ds_read_b64_tr_b16 a[72:73], v210 offset:0
  ds_read_b64_tr_b16 a[74:75], v210 offset:1024
  buffer_load_dwordx4 v216, s[28:31], s71 offen offset:1024 lds
  v_mfma_f32_32x32x16_bf16 v[0:15], a[84:87], a[132:135], v[0:15]
  ds_read_b64_tr_b16 a[76:77], v210 offset:2048
  ds_read_b64_tr_b16 a[78:79], v210 offset:3072
  s_waitcnt lgkmcnt(4)
  v_mfma_f32_32x32x16_bf16 v[0:15], a[88:91], a[136:139], v[0:15]
  ds_read_b64_tr_b16 a[80:81], v210 offset:4096
  ds_read_b64_tr_b16 a[82:83], v210 offset:5120
  buffer_load_dwordx4 v217, s[28:31], s71 offen offset:2048 lds
  v_subrev_u32 v222, 3072, v222
  v_mfma_f32_32x32x16_bf16 v[0:15], a[92:95], a[140:143], v[0:15]
  ds_read_b64_tr_b16 a[84:85], v210 offset:6144
  ds_read_b64_tr_b16 a[86:87], v210 offset:7168
  s_add_u32 m0, s73, 24576
  s_add_u32 s71, s52, 221568
  s_waitcnt lgkmcnt(4)
  v_mfma_f32_32x32x16_bf16 v[16:31], a[72:75], a[96:99], v[16:31]
  ds_read_b64_tr_b16 a[88:89], v210 offset:8192
  ds_read_b64_tr_b16 a[90:91], v210 offset:9216
  buffer_load_dwordx4 v215, s[28:31], s71 offen lds
  v_mfma_f32_32x32x16_bf16 v[16:31], a[76:79], a[100:103], v[16:31]
  ds_read_b64_tr_b16 a[92:93], v210 offset:10240
  ds_read_b64_tr_b16 a[94:95], v210 offset:11264
  s_add_u32 m0, s73, 28672
  s_add_u32 s71, s52, 258432
  s_waitcnt lgkmcnt(4)
  v_mfma_f32_32x32x16_bf16 v[16:31], a[80:83], a[104:107], v[16:31]
  ds_read_b64_tr_b16 a[72:73], v210 offset:12288
  ds_read_b64_tr_b16 a[74:75], v210 offset:13312
  buffer_load_dwordx4 v215, s[28:31], s71 offen lds
  v_mfma_f32_32x32x16_bf16 v[16:31], a[84:87], a[108:111], v[16:31]
  ds_read_b64_tr_b16 a[76:77], v210 offset:14336
  ds_read_b64_tr_b16 a[78:79], v210 offset:15360
  s_add_u32 m0, s73, 32768
  s_add_u32 s71, s53, 295296
  s_waitcnt lgkmcnt(4)
  v_mfma_f32_32x32x16_bf16 v[16:31], a[88:91], a[112:115], v[16:31]
  ds_read_b64_tr_b16 a[80:81], v210 offset:16384
  ds_read_b64_tr_b16 a[82:83], v210 offset:17408
  buffer_load_dwordx4 v215, s[28:31], s71 offen lds
  v_mfma_f32_32x32x16_bf16 v[16:31], a[92:95], a[116:119], v[16:31]
  s_waitcnt vmcnt(29)
  s_barrier
  ds_read_b64_tr_b16 a[84:85], v210 offset:18432
  ds_read_b64_tr_b16 a[86:87], v210 offset:19456
  s_add_u32 m0, s73, 36864
  s_add_u32 s71, s56, 0
  s_waitcnt lgkmcnt(4)
  v_mfma_f32_32x32x16_bf16 v[16:31], a[72:75], a[120:123], v[16:31]
  ds_read_b64_tr_b16 a[88:89], v210 offset:20480
  ds_read_b64_tr_b16 a[90:91], v210 offset:21504
  buffer_load_dwordx4 v218, s[28:31], s71 offen lds
  v_add_u32 v245, 256, v208
  v_mfma_f32_32x32x16_bf16 v[16:31], a[76:79], a[124:127], v[16:31]
  ds_read_b64_tr_b16 a[92:93], v210 offset:22528
  ds_read_b64_tr_b16 a[94:95], v210 offset:23552
  s_add_u32 m0, s73, 40960
  s_add_u32 s71, s56, 73728
  s_waitcnt lgkmcnt(4)
  v_mfma_f32_32x32x16_bf16 v[16:31], a[80:83], a[128:131], v[16:31]
  ds_read_b64_tr_b16 a[72:73], v209 offset:24576
  ds_read_b64_tr_b16 a[74:75], v209 offset:25600
  buffer_load_dwordx4 v218, s[28:31], s71 offen lds
  v_mfma_f32_32x32x16_bf16 v[16:31], a[84:87], a[132:135], v[16:31]
  ds_read_b64_tr_b16 a[76:77], v209 offset:26624
  ds_read_b64_tr_b16 a[78:79], v209 offset:27648
  s_add_u32 m0, s73, 45056
  s_add_u32 s71, s56, 147456
  s_waitcnt vmcnt(20)
  v_cmp_gt_u32 vcc, 9, v251
  s_nop 3
  s_cbranch_vccnz L_slow6
L_ret6:
  s_waitcnt lgkmcnt(4)
  v_mfma_f32_32x32x16_bf16 v[16:31], a[88:91], a[136:139], v[16:31]
  ds_read_b64_tr_b16 a[80:81], v209 offset:28672
  ds_read_b64_tr_b16 a[82:83], v209 offset:29696
  buffer_load_dwordx4 v218, s[28:31], s71 offen lds
  s_add_u32 s84, s61, 16384
  buffer_load_dwordx4 a[160:163], v224, s[40:43], s84 offen sc1
  v_mfma_f32_32x32x16_bf16 v[16:31], a[92:95], a[140:143], v[16:31]
  ds_read_b64_tr_b16 a[84:85], v209 offset:30720
  ds_read_b64_tr_b16 a[86:87], v209 offset:31744
  s_add_u32 s84, s61, 17408
  buffer_load_dwordx4 a[164:167], v224, s[40:43], s84 offen sc1
  s_waitcnt lgkmcnt(4)
  v_mfma_f32_32x32x16_bf16 v[0:15], a[72:75], a[144:147], v[0:15]
  ds_read_b64_tr_b16 a[88:89], v210 offset:24576
  ds_read_b64_tr_b16 a[90:91], v210 offset:25600
  v_mfma_f32_32x32x16_bf16 v[0:15], a[76:79], a[148:151], v[0:15]
  ds_read_b64_tr_b16 a[92:93], v210 offset:26624
  ds_read_b64_tr_b16 a[94:95], v210 offset:27648
  v_mul_u32_u24 v246, 205, v245
  s_waitcnt lgkmcnt(4)
  v_mfma_f32_32x32x16_bf16 v[0:15], a[80:83], a[152:155], v[0:15]
  ds_read_b64_tr_b16 a[72:73], v210 offset:28672
  ds_read_b64_tr_b16 a[74:75], v210 offset:29696
  v_mfma_f32_32x32x16_bf16 v[0:15], a[84:87], a[156:159], v[0:15]
  ds_read_b64_tr_b16 a[76:77], v210 offset:30720
  ds_read_b64_tr_b16 a[78:79], v210 offset:31744
  s_waitcnt lgkmcnt(4)
  v_mfma_f32_32x32x16_bf16 v[16:31], a[88:91], a[144:147], v[16:31]
  ds_read_b64_tr_b16 a[80:81], v209 offset:36864
  ds_read_b64_tr_b16 a[82:83], v209 offset:37888
  v_mfma_f32_32x32x16_bf16 v[16:31], a[92:95], a[148:151], v[16:31]
  ds_read_b64_tr_b16 a[84:85], v209 offset:38912
  ds_read_b64_tr_b16 a[86:87], v209 offset:39936
  s_waitcnt lgkmcnt(4)
  v_mfma_f32_32x32x16_bf16 v[16:31], a[72:75], a[152:155], v[16:31]
  ds_read_b64_tr_b16 a[88:89], v209 offset:40960
  ds_read_b64_tr_b16 a[90:91], v209 offset:41984
  v_mfma_f32_32x32x16_bf16 v[16:31], a[76:79], a[156:159], v[16:31]
  s_barrier
  ds_read_b64_tr_b16 a[92:93], v209 offset:43008
  ds_read_b64_tr_b16 a[94:95], v209 offset:44032
  s_add_u32 m0, s73, 49152
  s_add_u32 s71, s56, 221184
  s_waitcnt lgkmcnt(4)
  v_mfma_f32_32x32x16_bf16 v[32:47], a[80:83], a[96:99], v[32:47]
  ds_read_b64_tr_b16 a[72:73], v209 offset:45056
  ds_read_b64_tr_b16 a[74:75], v209 offset:46080
  buffer_load_dwordx4 v218, s[28:31], s71 offen lds
  v_lshrrev_b32 v246, 12, v246
  v_mfma_f32_32x32x16_bf16 v[32:47], a[84:87], a[100:103], v[32:47]
  ds_read_b64_tr_b16 a[76:77], v209 offset:47104
  ds_read_b64_tr_b16 a[78:79], v209 offset:48128
  s_and_b32 s71, s73, 1024
  s_add_u32 m0, s71, 53248
  s_mov_b32 s71, s57
  s_waitcnt lgkmcnt(4)
  v_mfma_f32_32x32x16_bf16 v[32:47], a[88:91], a[104:107], v[32:47]
  ds_read_b64_tr_b16 a[80:81], v209 offset:49152
  ds_read_b64_tr_b16 a[82:83], v209 offset:50176
  buffer_load_dwordx4 v218, s[28:31], s71 offen lds
  v_mfma_f32_32x32x16_bf16 v[32:47], a[92:95], a[108:111], v[32:47]
  ds_read_b64_tr_b16 a[84:85], v209 offset:51200
  ds_read_b64_tr_b16 a[86:87], v209 offset:52224
  s_waitcnt lgkmcnt(4)
  v_mfma_f32_32x32x16_bf16 v[32:47], a[72:75], a[112:115], v[32:47]
  ds_read_b64_tr_b16 a[88:89], v209 offset:53248
  ds_read_b64_tr_b16 a[90:91], v209 offset:54272
  v_mfma_f32_32x32x16_bf16 v[32:47], a[76:79], a[116:119], v[32:47]
  ds_read_b64_tr_b16 a[92:93], v209 offset:55296
  ds_read_b64_tr_b16 a[94:95], v209 offset:56320
  s_waitcnt lgkmcnt(4)
  v_mfma_f32_32x32x16_bf16 v[32:47], a[80:83], a[120:123], v[32:47]
  ds_read_b64_tr_b16 a[72:73], v209 offset:57344
  ds_read_b64_tr_b16 a[74:75], v209 offset:58368
  v_mfma_f32_32x32x16_bf16 v[32:47], a[84:87], a[124:127], v[32:47]
  ds_read_b64_tr_b16 a[76:77], v209 offset:59392
  ds_read_b64_tr_b16 a[78:79], v209 offset:60416
  s_waitcnt lgkmcnt(4)
  v_mfma_f32_32x32x16_bf16 v[32:47], a[88:91], a[128:131], v[32:47]
  ds_read_b64_tr_b16 a[80:81], v209 offset:61440
  ds_read_b64_tr_b16 a[82:83], v209 offset:62464
  v_mul_u32_u24 v247, 20, v246
  v_mfma_f32_32x32x16_bf16 v[32:47], a[92:95], a[132:135], v[32:47]
  ds_read_b64_tr_b16 a[84:85], v209 offset:63488
  ds_read_b64_tr_b16 a[86:87], v209 offset:64512
  s_waitcnt lgkmcnt(4)
  v_mfma_f32_32x32x16_bf16 v[32:47], a[72:75], a[136:139], v[32:47]
  v_add_u32 v209, 102400, v214
  ds_read_b64_tr_b16 a[88:89], v209 offset:0
  ds_read_b64_tr_b16 a[90:91], v209 offset:1024
  v_mfma_f32_32x32x16_bf16 v[32:47], a[76:79], a[140:143], v[32:47]
  ds_read_b64_tr_b16 a[92:93], v209 offset:2048
  ds_read_b64_tr_b16 a[94:95], v209 offset:3072
  s_waitcnt lgkmcnt(4)
  v_mfma_f32_32x32x16_bf16 v[32:47], a[80:83], a[144:147], v[32:47]
  ds_read_b64_tr_b16 a[72:73], v210 offset:36864
  ds_read_b64_tr_b16 a[74:75], v210 offset:37888
  v_mfma_f32_32x32x16_bf16 v[32:47], a[84:87], a[148:151], v[32:47]
  ds_read_b64_tr_b16 a[76:77], v210 offset:38912
  ds_read_b64_tr_b16 a[78:79], v210 offset:39936
  s_waitcnt lgkmcnt(4)
  v_mfma_f32_32x32x16_bf16 v[32:47], a[88:91], a[152:155], v[32:47]
  ds_read_b64_tr_b16 a[80:81], v210 offset:40960
  ds_read_b64_tr_b16 a[82:83], v210 offset:41984
  v_mfma_f32_32x32x16_bf16 v[32:47], a[92:95], a[156:159], v[32:47]
  ds_read_b64_tr_b16 a[84:85], v210 offset:43008
  ds_read_b64_tr_b16 a[86:87], v210 offset:44032
  v_sub_u32 v245, v245, v247
  s_waitcnt lgkmcnt(4)
  v_mfma_f32_32x32x16_bf16 v[48:63], a[72:75], a[96:99], v[48:63]
  ds_read_b64_tr_b16 a[88:89], v210 offset:45056
  ds_read_b64_tr_b16 a[90:91], v210 offset:46080
  v_mfma_f32_32x32x16_bf16 v[48:63], a[76:79], a[100:103], v[48:63]
  s_waitcnt vmcnt(22)
  s_barrier
  ds_read_b64_tr_b16 a[92:93], v210 offset:47104
  ds_read_b64_tr_b16 a[94:95], v210 offset:48128
  s_waitcnt lgkmcnt(4)
  v_mfma_f32_32x32x16_bf16 v[48:63], a[80:83], a[104:107], v[48:63]
  ds_read_b64_tr_b16 a[72:73], v210 offset:49152
  ds_read_b64_tr_b16 a[74:75], v210 offset:50176
  v_mfma_f32_32x32x16_bf16 v[48:63], a[84:87], a[108:111], v[48:63]
  ds_read_b64_tr_b16 a[76:77], v210 offset:51200
  ds_read_b64_tr_b16 a[78:79], v210 offset:52224
  s_waitcnt lgkmcnt(4)
  v_mfma_f32_32x32x16_bf16 v[48:63], a[88:91], a[112:115], v[48:63]
  ds_read_b64_tr_b16 a[80:81], v210 offset:53248
  ds_read_b64_tr_b16 a[82:83], v210 offset:54272
  v_mfma_f32_32x32x16_bf16 v[48:63], a[92:95], a[116:119], v[48:63]
  ds_read_b64_tr_b16 a[84:85], v210 offset:55296
  ds_read_b64_tr_b16 a[86:87], v210 offset:56320
  s_waitcnt lgkmcnt(4)
  v_mfma_f32_32x32x16_bf16 v[48:63], a[72:75], a[120:123], v[48:63]
  ds_read_b64_tr_b16 a[88:89], v210 offset:57344
  ds_read_b64_tr_b16 a[90:91], v210 offset:58368
  buffer_load_dword v251, v254, s[40:43], s4 offen sc1
  v_mfma_f32_32x32x16_bf16 v[48:63], a[76:79], a[124:127], v[48:63]
  ds_read_b64_tr_b16 a[92:93], v210 offset:59392
  ds_read_b64_tr_b16 a[94:95], v210 offset:60416
  v_mul_u32_u24 v246, 1152, v246
  s_waitcnt lgkmcnt(4)
  v_mfma_f32_32x32x16_bf16 v[48:63], a[80:83], a[128:131], v[48:63]
  ds_read_b64_tr_b16 a[72:73], v210 offset:61440
  ds_read_b64_tr_b16 a[74:75], v210 offset:62464
  v_mfma_f32_32x32x16_bf16 v[48:63], a[84:87], a[132:135], v[48:63]
  ds_read_b64_tr_b16 a[76:77], v210 offset:63488
  ds_read_b64_tr_b16 a[78:79], v210 offset:64512
  s_waitcnt lgkmcnt(4)
  v_mfma_f32_32x32x16_bf16 v[48:63], a[88:91], a[136:139], v[48:63]
  v_add_u32 v210, 102400, v211
  ds_read_b64_tr_b16 a[80:81], v210 offset:0
  ds_read_b64_tr_b16 a[82:83], v210 offset:1024
  v_mfma_f32_32x32x16_bf16 v[48:63], a[92:95], a[140:143], v[48:63]
  ds_read_b64_tr_b16 a[84:85], v210 offset:2048
  ds_read_b64_tr_b16 a[86:87], v210 offset:3072
  s_waitcnt lgkmcnt(4)
  v_mfma_f32_32x32x16_bf16 v[48:63], a[72:75], a[144:147], v[48:63]
  v_add_u32 v209, 69632, v214
  ds_read_b64_tr_b16 a[88:89], v209 offset:0
  ds_read_b64_tr_b16 a[90:91], v209 offset:1024
  v_mfma_f32_32x32x16_bf16 v[48:63], a[76:79], a[148:151], v[48:63]
  ds_read_b64_tr_b16 a[92:93], v209 offset:2048
  ds_read_b64_tr_b16 a[94:95], v209 offset:3072
  s_waitcnt lgkmcnt(4)
  v_mfma_f32_32x32x16_bf16 v[48:63], a[80:83], a[152:155], v[48:63]
  v_add_u32 v210, 69632, v211
  ds_read_b64_tr_b16 a[72:73], v210 offset:0
  ds_read_b64_tr_b16 a[74:75], v210 offset:1024
  v_lshl_add_u32 v250, v245, 4, v246
  v_lshrrev_b32 v245, 5, v208
  v_mul_u32_u24 v245, 8, v245
  v_mfma_f32_32x32x16_bf16 v[48:63], a[84:87], a[156:159], v[48:63]
  ds_read_b64_tr_b16 a[76:77], v210 offset:2048
  ds_read_b64_tr_b16 a[78:79], v210 offset:3072
  v_bfe_u32 v246, v208, 2, 2
  v_add_u32 v245, v245, v246
  v_mul_u32_u24 v213, 320, v245
  s_waitcnt vmcnt(4) lgkmcnt(4)
  v_mfma_f32_32x32x16_bf16 v[0:15], a[88:91], a[160:163], v[0:15]
  ds_read_b64_tr_b16 a[80:81], v209 offset:36864
  ds_read_b64_tr_b16 a[82:83], v209 offset:37888
  v_bfe_u32 v245, v208, 4, 1
  v_lshlrev_b32 v245, 5, v245
  v_and_b32 v246, 3, v208
  v_lshl_add_u32 v245, v246, 3, v245
  s_waitcnt vmcnt(3)
  v_mfma_f32_32x32x16_bf16 v[0:15], a[92:95], a[164:167], v[0:15]
  ds_read_b64_tr_b16 a[84:85], v209 offset:38912
  ds_read_b64_tr_b16 a[86:87], v209 offset:39936
  v_add_u32 v245, s85, v245
  v_add_u32 v213, v213, v245
  s_waitcnt lgkmcnt(4)
  v_mfma_f32_32x32x16_bf16 v[16:31], a[72:75], a[160:163], v[16:31]
  ds_read_b64_tr_b16 a[88:89], v210 offset:36864
  ds_read_b64_tr_b16 a[90:91], v210 offset:37888
  v_mfma_f32_32x32x16_bf16 v[16:31], a[76:79], a[164:167], v[16:31]
  ds_read_b64_tr_b16 a[92:93], v210 offset:38912
  ds_read_b64_tr_b16 a[94:95], v210 offset:39936
  s_waitcnt lgkmcnt(4)
  v_mfma_f32_32x32x16_bf16 v[32:47], a[80:83], a[160:163], v[32:47]
  ds_read_b64_tr_b16 a[72:73], v209 offset:40960
  ds_read_b64_tr_b16 a[74:75], v209 offset:41984
  v_cvt_pk_bf16_f32 v0, v0, v1
  v_mfma_f32_32x32x16_bf16 v[32:47], a[84:87], a[164:167], v[32:47]
  ds_read_b64_tr_b16 a[76:77], v209 offset:43008
  ds_read_b64_tr_b16 a[78:79], v209 offset:44032
  v_cvt_pk_bf16_f32 v1, v2, v3
  s_waitcnt lgkmcnt(4)
  v_mfma_f32_32x32x16_bf16 v[48:63], a[88:91], a[160:163], v[48:63]
  ds_read_b64_tr_b16 a[80:81], v209 offset:45056
  ds_read_b64_tr_b16 a[82:83], v209 offset:46080
  v_cvt_pk_bf16_f32 v2, v4, v5
  v_mfma_f32_32x32x16_bf16 v[48:63], a[92:95], a[164:167], v[48:63]
  s_barrier
  ds_read_b64_tr_b16 a[84:85], v209 offset:47104
  ds_read_b64_tr_b16 a[86:87], v209 offset:48128
  s_add_u32 m0, s85, 55296
  s_add_u32 s71, s62, 0
  s_waitcnt lgkmcnt(4)
  v_mfma_f32_32x32x16_bf16 v[64:79], a[72:75], a[96:99], v[64:79]
  ds_read_b64_tr_b16 a[88:89], v209 offset:49152
  ds_read_b64_tr_b16 a[90:91], v209 offset:50176
  buffer_load_dwordx4 v219, s[16:19], s71 offen offset:0 lds
  v_cvt_pk_bf16_f32 v3, v6, v7
  v_mfma_f32_32x32x16_bf16 v[64:79], a[76:79], a[100:103], v[64:79]
  ds_read_b64_tr_b16 a[92:93], v209 offset:51200
  ds_read_b64_tr_b16 a[94:95], v209 offset:52224
  v_cvt_pk_bf16_f32 v4, v8, v9
  s_waitcnt lgkmcnt(4)
  v_mfma_f32_32x32x16_bf16 v[64:79], a[80:83], a[104:107], v[64:79]
  ds_read_b64_tr_b16 a[72:73], v209 offset:53248
  ds_read_b64_tr_b16 a[74:75], v209 offset:54272
  buffer_load_dwordx4 v220, s[16:19], s71 offen offset:1024 lds
  v_cvt_pk_bf16_f32 v5, v10, v11
  v_mfma_f32_32x32x16_bf16 v[64:79], a[84:87], a[108:111], v[64:79]
  ds_read_b64_tr_b16 a[76:77], v209 offset:55296
  ds_read_b64_tr_b16 a[78:79], v209 offset:56320
  s_waitcnt lgkmcnt(4)
  v_mfma_f32_32x32x16_bf16 v[64:79], a[88:91], a[112:115], v[64:79]
  ds_read_b64_tr_b16 a[80:81], v209 offset:57344
  ds_read_b64_tr_b16 a[82:83], v209 offset:58368
  buffer_load_dwordx4 v221, s[16:19], s71 offen offset:2048 lds
  v_cvt_pk_bf16_f32 v6, v12, v13
  v_mfma_f32_32x32x16_bf16 v[64:79], a[92:95], a[116:119], v[64:79]
  ds_read_b64_tr_b16 a[84:85], v209 offset:59392
  ds_read_b64_tr_b16 a[86:87], v209 offset:60416
  v_cvt_pk_bf16_f32 v7, v14, v15
  s_waitcnt lgkmcnt(4)
  v_mfma_f32_32x32x16_bf16 v[64:79], a[72:75], a[120:123], v[64:79]
  ds_read_b64_tr_b16 a[88:89], v209 offset:61440
  ds_read_b64_tr_b16 a[90:91], v209 offset:62464
  buffer_load_dwordx4 v222, s[16:19], s71 offen offset:3072 lds
  s_add_u32 s82, s58, 0
  v_mfma_f32_32x32x16_bf16 v[64:79], a[76:79], a[124:127], v[64:79]
  ds_read_b64_tr_b16 a[92:93], v209 offset:63488
  ds_read_b64_tr_b16 a[94:95], v209 offset:64512
  s_add_u32 m0, s85, 59392
  s_and_b32 s69, s95, 1
  s_waitcnt lgkmcnt(4)
  v_mfma_f32_32x32x16_bf16 v[64:79], a[80:83], a[128:131], v[64:79]
  v_add_u32 v209, 135168, v214
  ds_read_b64_tr_b16 a[72:73], v209 offset:0
  ds_read_b64_tr_b16 a[74:75], v209 offset:1024
  buffer_load_dwordx4 v250, s[16:19], s71 offen lds
  buffer_store_dwordx4 v[0:3], v224, s[40:43], s82 offen sc1
  v_mfma_f32_32x32x16_bf16 v[64:79], a[84:87], a[132:135], v[64:79]
  ds_read_b64_tr_b16 a[76:77], v209 offset:2048
  ds_read_b64_tr_b16 a[78:79], v209 offset:3072
  s_add_u32 m0, s85, 75776
  s_add_u32 s71, s62, 20736
  s_add_u32 s82, s58, 8192
  s_waitcnt lgkmcnt(4)
  v_mfma_f32_32x32x16_bf16 v[64:79], a[88:91], a[136:139], v[64:79]
  ds_read_b64_tr_b16 a[80:81], v209 offset:4096
  ds_read_b64_tr_b16 a[82:83], v209 offset:5120
  buffer_load_dwordx4 v219, s[16:19], s71 offen offset:0 lds
  buffer_store_dwordx4 v[4:7], v224, s[40:43], s82 offen sc1
  v_cvt_pk_bf16_f32 v16, v16, v17
  v_mfma_f32_32x32x16_bf16 v[64:79], a[92:95], a[140:143], v[64:79]
  ds_read_b64_tr_b16 a[84:85], v209 offset:6144
  ds_read_b64_tr_b16 a[86:87], v209 offset:7168
  v_cvt_pk_bf16_f32 v17, v18, v19
  v_cvt_pk_bf16_f32 v18, v20, v21
  v_cvt_pk_bf16_f32 v19, v22, v23
  s_waitcnt lgkmcnt(4)
  v_mfma_f32_32x32x16_bf16 v[64:79], a[72:75], a[144:147], v[64:79]
  ds_read_b64_tr_b16 a[88:89], v209 offset:8192
  ds_read_b64_tr_b16 a[90:91], v209 offset:9216
  buffer_load_dwordx4 v220, s[16:19], s71 offen offset:1024 lds
  v_cvt_pk_bf16_f32 v20, v24, v25
  v_cvt_pk_bf16_f32 v21, v26, v27
  v_mfma_f32_32x32x16_bf16 v[64:79], a[76:79], a[148:151], v[64:79]
  ds_read_b64_tr_b16 a[92:93], v209 offset:10240
  ds_read_b64_tr_b16 a[94:95], v209 offset:11264
  v_cvt_pk_bf16_f32 v22, v28, v29
  v_cvt_pk_bf16_f32 v23, v30, v31
  s_add_u32 s82, s58, 16384
  buffer_store_dwordx4 v[16:19], v224, s[40:43], s82 offen sc1
  s_add_u32 s82, s58, 24576
  buffer_store_dwordx4 v[20:23], v224, s[40:43], s82 offen sc1
  s_waitcnt lgkmcnt(4)
  v_mfma_f32_32x32x16_bf16 v[64:79], a[80:83], a[152:155], v[64:79]
  ds_read_b64_tr_b16 a[72:73], v210 offset:40960
  ds_read_b64_tr_b16 a[74:75], v210 offset:41984
  buffer_load_dwordx4 v221, s[16:19], s71 offen offset:2048 lds
  v_cvt_pk_bf16_f32 v32, v32, v33
  v_cvt_pk_bf16_f32 v33, v34, v35
  v_cvt_pk_bf16_f32 v34, v36, v37
  v_cvt_pk_bf16_f32 v35, v38, v39
  v_mfma_f32_32x32x16_bf16 v[64:79], a[84:87], a[156:159], v[64:79]
  ds_read_b64_tr_b16 a[76:77], v210 offset:43008
  ds_read_b64_tr_b16 a[78:79], v210 offset:44032
  v_cvt_pk_bf16_f32 v36, v40, v41
  v_cvt_pk_bf16_f32 v37, v42, v43
  v_cvt_pk_bf16_f32 v38, v44, v45
  v_cvt_pk_bf16_f32 v39, v46, v47
  s_add_u32 s82, s58, 32768
  buffer_store_dwordx4 v[32:35], v224, s[40:43], s82 offen sc1
  s_add_u32 s82, s58, 40960
  buffer_store_dwordx4 v[36:39], v224, s[40:43], s82 offen sc1
  s_waitcnt lgkmcnt(4)
  v_mfma_f32_32x32x16_bf16 v[64:79], a[88:91], a[160:163], v[64:79]
  ds_read_b64_tr_b16 a[80:81], v210 offset:45056
  ds_read_b64_tr_b16 a[82:83], v210 offset:46080
  buffer_load_dwordx4 v222, s[16:19], s71 offen offset:3072 lds
  v_cvt_pk_bf16_f32 v48, v48, v49
  v_cvt_pk_bf16_f32 v49, v50, v51
  v_cvt_pk_bf16_f32 v50, v52, v53
  v_cvt_pk_bf16_f32 v51, v54, v55
  v_mfma_f32_32x32x16_bf16 v[64:79], a[92:95], a[164:167], v[64:79]
  s_barrier
  ds_read_b64_tr_b16 a[84:85], v210 offset:47104
  ds_read_b64_tr_b16 a[86:87], v210 offset:48128
  s_add_u32 m0, s85, 79872
  v_cvt_pk_bf16_f32 v52, v56, v57
  v_cvt_pk_bf16_f32 v53, v58, v59
  v_cvt_pk_bf16_f32 v54, v60, v61
  v_cvt_pk_bf16_f32 v55, v62, v63
  s_add_u32 s82, s58, 49152
  buffer_store_dwordx4 v[48:51], v224, s[40:43], s82 offen sc1
  s_add_u32 s82, s58, 57344
  buffer_store_dwordx4 v[52:55], v224, s[40:43], s82 offen sc1
  s_waitcnt lgkmcnt(4)
  v_mfma_f32_32x32x16_bf16 v[80:95], a[72:75], a[96:99], v[80:95]
  ds_read_b64_tr_b16 a[88:89], v210 offset:49152
  ds_read_b64_tr_b16 a[90:91], v210 offset:50176
  buffer_load_dwordx4 v250, s[16:19], s71 offen lds
  v_mfma_f32_32x32x16_bf16 v[80:95], a[76:79], a[100:103], v[80:95]
  ds_read_b64_tr_b16 a[92:93], v210 offset:51200
  ds_read_b64_tr_b16 a[94:95], v210 offset:52224
  s_waitcnt lgkmcnt(4)
  v_mfma_f32_32x32x16_bf16 v[80:95], a[80:83], a[104:107], v[80:95]
  ds_read_b64_tr_b16 a[72:73], v210 offset:53248
  ds_read_b64_tr_b16 a[74:75], v210 offset:54272
  v_cvt_pk_bf16_f32 v64, v64, v65
  v_mfma_f32_32x32x16_bf16 v[80:95], a[84:87], a[108:111], v[80:95]
  ds_read_b64_tr_b16 a[76:77], v210 offset:55296
  ds_read_b64_tr_b16 a[78:79], v210 offset:56320
  v_cvt_pk_bf16_f32 v65, v66, v67
  s_waitcnt lgkmcnt(4)
  v_mfma_f32_32x32x16_bf16 v[80:95], a[88:91], a[112:115], v[80:95]
  ds_read_b64_tr_b16 a[80:81], v210 offset:57344
  ds_read_b64_tr_b16 a[82:83], v210 offset:58368
  v_cvt_pk_bf16_f32 v66, v68, v69
  v_mfma_f32_32x32x16_bf16 v[80:95], a[92:95], a[116:119], v[80:95]
  ds_read_b64_tr_b16 a[84:85], v210 offset:59392
  ds_read_b64_tr_b16 a[86:87], v210 offset:60416
  s_waitcnt lgkmcnt(4)
  v_mfma_f32_32x32x16_bf16 v[80:95], a[72:75], a[120:123], v[80:95]
  ds_read_b64_tr_b16 a[88:89], v210 offset:61440
  ds_read_b64_tr_b16 a[90:91], v210 offset:62464
  v_cvt_pk_bf16_f32 v67, v70, v71
  v_mfma_f32_32x32x16_bf16 v[80:95], a[76:79], a[124:127], v[80:95]
  ds_read_b64_tr_b16 a[92:93], v210 offset:63488
  ds_read_b64_tr_b16 a[94:95], v210 offset:64512
  v_cvt_pk_bf16_f32 v68, v72, v73
  s_waitcnt lgkmcnt(4)
  v_mfma_f32_32x32x16_bf16 v[80:95], a[80:83], a[128:131], v[80:95]
  v_add_u32 v210, 135168, v211
  ds_read_b64_tr_b16 a[72:73], v210 offset:0
  ds_read_b64_tr_b16 a[74:75], v210 offset:1024
  v_cvt_pk_bf16_f32 v69, v74, v75
  v_mfma_f32_32x32x16_bf16 v[80:95], a[84:87], a[132:135], v[80:95]
  ds_read_b64_tr_b16 a[76:77], v210 offset:2048
  ds_read_b64_tr_b16 a[78:79], v210 offset:3072
  s_waitcnt lgkmcnt(4)
  v_mfma_f32_32x32x16_bf16 v[80:95], a[88:91], a[136:139], v[80:95]
  ds_read_b64_tr_b16 a[80:81], v210 offset:4096
  ds_read_b64_tr_b16 a[82:83], v210 offset:5120
  v_cvt_pk_bf16_f32 v70, v76, v77
  s_lshl_b32 s69, s69, 5
  v_mfma_f32_32x32x16_bf16 v[80:95], a[92:95], a[140:143], v[80:95]
  ds_read_b64_tr_b16 a[84:85], v210 offset:6144
  ds_read_b64_tr_b16 a[86:87], v210 offset:7168
  v_cvt_pk_bf16_f32 v71, v78, v79
  s_waitcnt lgkmcnt(4)
  v_mfma_f32_32x32x16_bf16 v[80:95], a[72:75], a[144:147], v[80:95]
  ds_read_b64_tr_b16 a[88:89], v210 offset:8192
  ds_read_b64_tr_b16 a[90:91], v210 offset:9216
  s_add_u32 s82, s58, 65536
  v_mfma_f32_32x32x16_bf16 v[80:95], a[76:79], a[148:151], v[80:95]
  ds_read_b64_tr_b16 a[92:93], v210 offset:10240
  ds_read_b64_tr_b16 a[94:95], v210 offset:11264
  s_waitcnt lgkmcnt(4)
  v_mfma_f32_32x32x16_bf16 v[80:95], a[80:83], a[152:155], v[80:95]
  v_mov_b32 v209, v214
  ds_read_b64_tr_b16 a[72:73], v209 offset:0
  ds_read_b64_tr_b16 a[74:75], v209 offset:1024
  buffer_store_dwordx4 v[64:67], v224, s[40:43], s82 offen sc1
  v_mfma_f32_32x32x16_bf16 v[80:95], a[84:87], a[156:159], v[80:95]
  ds_read_b64_tr_b16 a[76:77], v209 offset:2048
  ds_read_b64_tr_b16 a[78:79], v209 offset:3072
  s_add_u32 s82, s58, 73728
  s_waitcnt lgkmcnt(4)
  v_mfma_f32_32x32x16_bf16 v[80:95], a[88:91], a[160:163], v[80:95]
  ds_read_b64_tr_b16 a[80:81], v209 offset:4096
  ds_read_b64_tr_b16 a[82:83], v209 offset:5120
  buffer_store_dwordx4 v[68:71], v224, s[40:43], s82 offen sc1
  v_mfma_f32_32x32x16_bf16 v[80:95], a[92:95], a[164:167], v[80:95]
  s_barrier
  ds_read_b64_tr_b16 a[84:85], v209 offset:6144
  ds_read_b64_tr_b16 a[86:87], v209 offset:7168
  s_add_u32 m0, s85, 96256
  s_add_u32 s71, s62, 41472
  s_waitcnt lgkmcnt(4)
  v_mfma_f32_32x32x16_bf16 v[96:111], a[72:75], a[96:99], v[96:111]
  ds_read_b64_tr_b16 a[88:89], v209 offset:8192
  ds_read_b64_tr_b16 a[90:91], v209 offset:9216
  buffer_load_dwordx4 v219, s[16:19], s71 offen offset:0 lds
  v_mfma_f32_32x32x16_bf16 v[96:111], a[76:79], a[100:103], v[96:111]
  ds_read_b64_tr_b16 a[92:93], v209 offset:10240
  ds_read_b64_tr_b16 a[94:95], v209 offset:11264
  s_waitcnt vmcnt(21)
  v_cmp_ne_u32 vcc, 1, v251
  s_nop 3
  s_cbranch_vccnz L_slow7
L_ret7:
  s_waitcnt lgkmcnt(4)
  v_mfma_f32_32x32x16_bf16 v[96:111], a[80:83], a[104:107], v[96:111]
  ds_read_b64_tr_b16 a[72:73], v209 offset:12288
  ds_read_b64_tr_b16 a[74:75], v209 offset:13312
  buffer_load_dwordx4 v220, s[16:19], s71 offen offset:1024 lds
  s_add_u32 s84, s63, 0
  buffer_load_dwordx4 v[144:147], v224, s[40:43], s84 offen sc1
  v_mfma_f32_32x32x16_bf16 v[96:111], a[84:87], a[108:111], v[96:111]
  ds_read_b64_tr_b16 a[76:77], v209 offset:14336
  ds_read_b64_tr_b16 a[78:79], v209 offset:15360
  s_add_u32 s84, s63, 1024
  buffer_load_dwordx4 v[148:151], v224, s[40:43], s84 offen sc1
  s_add_u32 s84, s63, 2048
  s_waitcnt lgkmcnt(4)
  v_mfma_f32_32x32x16_bf16 v[96:111], a[88:91], a[112:115], v[96:111]
  ds_read_b64_tr_b16 a[80:81], v209 offset:16384
  ds_read_b64_tr_b16 a[82:83], v209 offset:17408
  buffer_load_dwordx4 v221, s[16:19], s71 offen offset:2048 lds
  buffer_load_dwordx4 v[152:155], v224, s[40:43], s84 offen sc1
  s_add_u32 s84, s63, 3072
  v_mfma_f32_32x32x16_bf16 v[96:111], a[92:95], a[116:119], v[96:111]
  ds_read_b64_tr_b16 a[84:85], v209 offset:18432
  ds_read_b64_tr_b16 a[86:87], v209 offset:19456
  buffer_load_dwordx4 v[156:159], v224, s[40:43], s84 offen sc1
  s_add_u32 s84, s63, 4096
  buffer_load_dwordx4 v[160:163], v224, s[40:43], s84 offen sc1
  s_waitcnt lgkmcnt(4)
  v_mfma_f32_32x32x16_bf16 v[96:111], a[72:75], a[120:123], v[96:111]
  ds_read_b64_tr_b16 a[88:89], v209 offset:20480
  ds_read_b64_tr_b16 a[90:91], v209 offset:21504
  buffer_load_dwordx4 v222, s[16:19], s71 offen offset:3072 lds
  s_add_u32 s84, s63, 5120
  buffer_load_dwordx4 v[164:167], v224, s[40:43], s84 offen sc1
  v_mfma_f32_32x32x16_bf16 v[96:111], a[76:79], a[124:127], v[96:111]
  ds_read_b64_tr_b16 a[92:93], v209 offset:22528
  ds_read_b64_tr_b16 a[94:95], v209 offset:23552
  s_add_u32 m0, s85, 100352
  s_add_u32 s84, s63, 6144
  buffer_load_dwordx4 v[168:171], v224, s[40:43], s84 offen sc1
  s_waitcnt lgkmcnt(4)
  v_mfma_f32_32x32x16_bf16 v[96:111], a[80:83], a[128:131], v[96:111]
  ds_read_b64_tr_b16 a[72:73], v209 offset:24576
  ds_read_b64_tr_b16 a[74:75], v209 offset:25600
  buffer_load_dwordx4 v250, s[16:19], s71 offen lds
  s_add_u32 s84, s63, 7168
  v_cvt_pk_bf16_f32 v80, v80, v81
  v_mfma_f32_32x32x16_bf16 v[96:111], a[84:87], a[132:135], v[96:111]
  ds_read_b64_tr_b16 a[76:77], v209 offset:26624
  ds_read_b64_tr_b16 a[78:79], v209 offset:27648
  s_add_u32 m0, s85, 116736
  s_add_u32 s71, s62, 62208
  buffer_load_dwordx4 v[172:175], v224, s[40:43], s84 offen sc1
  s_waitcnt lgkmcnt(4)
  v_mfma_f32_32x32x16_bf16 v[96:111], a[88:91], a[136:139], v[96:111]
  ds_read_b64_tr_b16 a[80:81], v209 offset:28672
  ds_read_b64_tr_b16 a[82:83], v209 offset:29696
  buffer_load_dwordx4 v219, s[16:19], s71 offen offset:0 lds
  s_add_u32 s84, s63, 8192
  v_cvt_pk_bf16_f32 v81, v82, v83
  buffer_load_dwordx4 v[176:179], v224, s[40:43], s84 offen sc1
  v_mfma_f32_32x32x16_bf16 v[96:111], a[92:95], a[140:143], v[96:111]
  ds_read_b64_tr_b16 a[84:85], v209 offset:30720
  ds_read_b64_tr_b16 a[86:87], v209 offset:31744
  v_cvt_pk_bf16_f32 v82, v84, v85
  v_cvt_pk_bf16_f32 v83, v86, v87
  v_cvt_pk_bf16_f32 v84, v88, v89
  s_waitcnt lgkmcnt(4)
  v_mfma_f32_32x32x16_bf16 v[96:111], a[72:75], a[144:147], v[96:111]
  ds_read_b64_tr_b16 a[88:89], v209 offset:32768
  ds_read_b64_tr_b16 a[90:91], v209 offset:33792
  buffer_load_dwordx4 v220, s[16:19], s71 offen offset:1024 lds
  v_cvt_pk_bf16_f32 v85, v90, v91
  v_cvt_pk_bf16_f32 v86, v92, v93
  v_mfma_f32_32x32x16_bf16 v[96:111], a[76:79], a[148:151], v[96:111]
  ds_read_b64_tr_b16 a[92:93], v209 offset:34816
  ds_read_b64_tr_b16 a[94:95], v209 offset:35840
  v_cvt_pk_bf16_f32 v87, v94, v95
  s_add_u32 s82, s58, 81920
  v_add_u32 v213, s69, v213
  s_waitcnt lgkmcnt(4)
  v_mfma_f32_32x32x16_bf16 v[96:111], a[80:83], a[152:155], v[96:111]
  v_mov_b32 v210, v211
  ds_read_b64_tr_b16 a[72:73], v210 offset:0
  ds_read_b64_tr_b16 a[74:75], v210 offset:1024
  buffer_load_dwordx4 v221, s[16:19], s71 offen offset:2048 lds
  v_add_u32 v245, 0, v208
  v_mfma_f32_32x32x16_bf16 v[96:111], a[84:87], a[156:159], v[96:111]
  ds_read_b64_tr_b16 a[76:77], v210 offset:2048
  ds_read_b64_tr_b16 a[78:79], v210 offset:3072
  v_mul_u32_u24 v246, 205, v245
  v_lshrrev_b32 v246, 12, v246
  v_mul_u32_u24 v247, 20, v246
  s_waitcnt lgkmcnt(4)
  v_mfma_f32_32x32x16_bf16 v[96:111], a[88:91], a[160:163], v[96:111]
  ds_read_b64_tr_b16 a[80:81], v210 offset:4096
  ds_read_b64_tr_b16 a[82:83], v210 offset:5120
  buffer_load_dwordx4 v222, s[16:19], s71 offen offset:3072 lds
  buffer_store_dwordx4 v[80:83], v224, s[40:43], s82 offen sc1
  v_sub_u32 v245, v245, v247
  v_mfma_f32_32x32x16_bf16 v[96:111], a[92:95], a[164:167], v[96:111]
  s_barrier
  ds_read_b64_tr_b16 a[84:85], v210 offset:6144
  ds_read_b64_tr_b16 a[86:87], v210 offset:7168
  s_add_u32 m0, s85, 120832
  s_add_u32 s82, s58, 90112
  buffer_store_dwordx4 v[84:87], v224, s[40:43], s82 offen sc1
  s_waitcnt lgkmcnt(4)
  v_mfma_f32_32x32x16_bf16 v[112:127], a[72:75], a[96:99], v[112:127]
  ds_read_b64_tr_b16 a[88:89], v210 offset:8192
  ds_read_b64_tr_b16 a[90:91], v210 offset:9216
  buffer_load_dwordx4 v250, s[16:19], s71 offen lds
  v_lshrrev_b32 v247, 2, v246
  v_mul_u32_u24 v180, 36, v247
  v_mfma_f32_32x32x16_bf16 v[112:127], a[76:79], a[100:103], v[112:127]
  ds_read_b64_tr_b16 a[92:93], v210 offset:10240
  ds_read_b64_tr_b16 a[94:95], v210 offset:11264
  s_add_u32 m0, s85, 137216
  s_add_u32 s71, s62, 82944
  v_bfe_u32 v247, v246, 1, 1
  s_waitcnt lgkmcnt(4)
  v_mfma_f32_32x32x16_bf16 v[112:127], a[80:83], a[104:107], v[112:127]
  ds_read_b64_tr_b16 a[72:73], v210 offset:12288
  ds_read_b64_tr_b16 a[74:75], v210 offset:13312
  buffer_load_dwordx4 v219, s[16:19], s71 offen offset:0 lds
  v_mul_u32_u24 v247, 18, v247
  v_add_u32 v180, v180, v247
  v_mfma_f32_32x32x16_bf16 v[112:127], a[84:87], a[108:111], v[112:127]
  ds_read_b64_tr_b16 a[76:77], v210 offset:14336
  ds_read_b64_tr_b16 a[78:79], v210 offset:15360
  v_and_b32 v247, 1, v246
  v_add_u32 v180, v180, v247
  v_add_u32 v180, 16, v180
  s_waitcnt lgkmcnt(4)
  v_mfma_f32_32x32x16_bf16 v[112:127], a[88:91], a[112:115], v[112:127]
  ds_read_b64_tr_b16 a[80:81], v210 offset:16384
  ds_read_b64_tr_b16 a[82:83], v210 offset:17408
  buffer_load_dwordx4 v220, s[16:19], s71 offen offset:1024 lds
  v_mul_u32_u24 v180, 1152, v180
  v_lshl_add_u32 v180, v245, 4, v180
  v_mfma_f32_32x32x16_bf16 v[112:127], a[92:95], a[116:119], v[112:127]
  ds_read_b64_tr_b16 a[84:85], v210 offset:18432
  ds_read_b64_tr_b16 a[86:87], v210 offset:19456
  v_add_u32 v245, 64, v208
  v_mul_u32_u24 v246, 205, v245
  v_lshrrev_b32 v246, 12, v246
  s_waitcnt lgkmcnt(4)
  v_mfma_f32_32x32x16_bf16 v[112:127], a[72:75], a[120:123], v[112:127]
  ds_read_b64_tr_b16 a[88:89], v210 offset:20480
  ds_read_b64_tr_b16 a[90:91], v210 offset:21504
  buffer_load_dwordx4 v221, s[16:19], s71 offen offset:2048 lds
  v_mul_u32_u24 v247, 20, v246
  v_sub_u32 v245, v245, v247
  v_mfma_f32_32x32x16_bf16 v[112:127], a[76:79], a[124:127], v[112:127]
  ds_read_b64_tr_b16 a[92:93], v210 offset:22528
  ds_read_b64_tr_b16 a[94:95], v210 offset:23552
  v_lshrrev_b32 v247, 2, v246
  v_mul_u32_u24 v181, 36, v247
  v_bfe_u32 v247, v246, 1, 1
  s_waitcnt lgkmcnt(4)
  v_mfma_f32_32x32x16_bf16 v[112:127], a[80:83], a[128:131], v[112:127]
  ds_read_b64_tr_b16 a[72:73], v210 offset:24576
  ds_read_b64_tr_b16 a[74:75], v210 offset:25600
  buffer_load_dwordx4 v222, s[16:19], s71 offen offset:3072 lds
  v_cvt_pk_bf16_f32 v96, v96, v97
  v_mul_u32_u24 v247, 18, v247
  v_mfma_f32_32x32x16_bf16 v[112:127], a[84:87], a[132:135], v[112:127]
  ds_read_b64_tr_b16 a[76:77], v210 offset:26624
  ds_read_b64_tr_b16 a[78:79], v210 offset:27648
  s_add_u32 m0, s85, 141312
  v_cvt_pk_bf16_f32 v97, v98, v99
  v_add_u32 v181, v181, v247
  s_waitcnt lgkmcnt(4)
  v_mfma_f32_32x32x16_bf16 v[112:127], a[88:91], a[136:139], v[112:127]
  ds_read_b64_tr_b16 a[80:81], v210 offset:28672
  ds_read_b64_tr_b16 a[82:83], v210 offset:29696
  buffer_load_dwordx4 v250, s[16:19], s71 offen lds
  v_cvt_pk_bf16_f32 v98, v100, v101
  v_and_b32 v247, 1, v246
  v_mfma_f32_32x32x16_bf16 v[112:127], a[92:95], a[140:143], v[112:127]
  ds_read_b64_tr_b16 a[84:85], v210 offset:30720
  ds_read_b64_tr_b16 a[86:87], v210 offset:31744
  v_cvt_pk_bf16_f32 v99, v102, v103
  v_add_u32 v181, v181, v247
  v_add_u32 v181, 16, v181
  s_waitcnt lgkmcnt(4)
  v_mfma_f32_32x32x16_bf16 v[112:127], a[72:75], a[144:147], v[112:127]
  ds_read_b64_tr_b16 a[88:89], v210 offset:32768
  ds_read_b64_tr_b16 a[90:91], v210 offset:33792
  v_cvt_pk_bf16_f32 v100, v104, v105
  v_mul_u32_u24 v181, 1152, v181
  v_cvt_pk_bf16_f32 v101, v106, v107
  v_lshl_add_u32 v181, v245, 4, v181
  v_mfma_f32_32x32x16_bf16 v[112:127], a[76:79], a[148:151], v[112:127]
  ds_read_b64_tr_b16 a[92:93], v210 offset:34816
  ds_read_b64_tr_b16 a[94:95], v210 offset:35840
  v_cvt_pk_bf16_f32 v102, v108, v109
  v_subrev_u32 v181, 1024, v181
  v_add_u32 v245, 128, v208
  s_waitcnt lgkmcnt(4)
  v_mfma_f32_32x32x16_bf16 v[112:127], a[80:83], a[152:155], v[112:127]
  v_add_u32 v209, 36864, v212
  ds_read_b64_tr_b16 a[72:73], v209 offset:0
  ds_read_b64_tr_b16 a[74:75], v209 offset:512
  v_cvt_pk_bf16_f32 v103, v110, v111
  v_mul_u32_u24 v246, 205, v245
  v_lshrrev_b32 v246, 12, v246
  v_mfma_f32_32x32x16_bf16 v[112:127], a[84:87], a[156:159], v[112:127]
  ds_read_b64_tr_b16 a[76:77], v209 offset:1024
  ds_read_b64_tr_b16 a[78:79], v209 offset:1536
  s_add_u32 s82, s58, 98304
  v_mul_u32_u24 v247, 20, v246
  v_sub_u32 v245, v245, v247
  s_waitcnt lgkmcnt(4)
  v_mfma_f32_32x32x16_bf16 v[112:127], a[88:91], a[160:163], v[112:127]
  ds_read_b64_tr_b16 a[80:81], v209 offset:2048
  ds_read_b64_tr_b16 a[82:83], v209 offset:2560
  buffer_store_dwordx4 v[96:99], v224, s[40:43], s82 offen sc1
  v_lshrrev_b32 v247, 2, v246
  v_mul_u32_u24 v182, 36, v247
  v_bfe_u32 v247, v246, 1, 1
  v_mfma_f32_32x32x16_bf16 v[112:127], a[92:95], a[164:167], v[112:127]
  s_barrier
  ds_read_b64_tr_b16 a[84:85], v209 offset:3072
  ds_read_b64_tr_b16 a[86:87], v209 offset:3584
  s_add_u32 m0, s85, 0
  s_add_u32 s71, s62, 103680
  s_add_u32 s82, s58, 106496
  buffer_store_dwordx4 v[100:103], v224, s[40:43], s82 offen sc1
  s_waitcnt lgkmcnt(4)
  v_mfma_f32_32x32x16_bf16 v[128:143], a[72:75], a[96:99], v[128:143]
  ds_read_b64_tr_b16 a[88:89], v209 offset:4096
  ds_read_b64_tr_b16 a[90:91], v209 offset:4608
  buffer_load_dwordx4 v219, s[16:19], s71 offen offset:0 lds
  v_mul_u32_u24 v247, 18, v247
  v_add_u32 v182, v182, v247
  v_mfma_f32_32x32x16_bf16 v[128:143], a[76:79], a[100:103], v[128:143]
  ds_read_b64_tr_b16 a[92:93], v209 offset:5120
  ds_read_b64_tr_b16 a[94:95], v209 offset:5632
  v_and_b32 v247, 1, v246
  v_add_u32 v182, v182, v247
  v_add_u32 v182, 16, v182
  s_waitcnt lgkmcnt(4)
  v_mfma_f32_32x32x16_bf16 v[128:143], a[80:83], a[104:107], v[128:143]
  ds_read_b64_tr_b16 a[72:73], v209 offset:6144
  ds_read_b64_tr_b16 a[74:75], v209 offset:6656
  buffer_load_dwordx4 v220, s[16:19], s71 offen offset:1024 lds
  v_mul_u32_u24 v182, 1152, v182
  v_lshl_add_u32 v182, v245, 4, v182
  v_mfma_f32_32x32x16_bf16 v[128:143], a[84:87], a[108:111], v[128:143]
  ds_read_b64_tr_b16 a[76:77], v209 offset:7168
  ds_read_b64_tr_b16 a[78:79], v209 offset:7680
  v_subrev_u32 v182, 2048, v182
  v_add_u32 v245, 192, v208
  v_mul_u32_u24 v246, 205, v245
  s_waitcnt lgkmcnt(4)
  v_mfma_f32_32x32x16_bf16 v[128:143], a[88:91], a[112:115], v[128:143]
  ds_read_b64_tr_b16 a[80:81], v209 offset:8192
  ds_read_b64_tr_b16 a[82:83], v209 offset:8704
  buffer_load_dwordx4 v221, s[16:19], s71 offen offset:2048 lds
  v_lshrrev_b32 v246, 12, v246
  v_mul_u32_u24 v247, 20, v246
  v_mfma_f32_32x32x16_bf16 v[128:143], a[92:95], a[116:119], v[128:143]
  ds_read_b64_tr_b16 a[84:85], v209 offset:9216
  ds_read_b64_tr_b16 a[86:87], v209 offset:9728
  v_cvt_pk_bf16_f32 v112, v112, v113
  v_sub_u32 v245, v245, v247
  v_cvt_pk_bf16_f32 v113, v114, v115
  s_waitcnt lgkmcnt(4)
  v_mfma_f32_32x32x16_bf16 v[128:143], a[72:75], a[120:123], v[128:143]
  ds_read_b64_tr_b16 a[88:89], v209 offset:10240
  ds_read_b64_tr_b16 a[90:91], v209 offset:10752
  buffer_load_dwordx4 v222, s[16:19], s71 offen offset:3072 lds
  v_lshrrev_b32 v247, 2, v246
  v_cvt_pk_bf16_f32 v114, v116, v117
  v_mfma_f32_32x32x16_bf16 v[128:143], a[76:79], a[124:127], v[128:143]
  ds_read_b64_tr_b16 a[92:93], v209 offset:11264
  ds_read_b64_tr_b16 a[94:95], v209 offset:11776
  s_add_u32 m0, s85, 4096
  v_mul_u32_u24 v183, 36, v247
  v_bfe_u32 v247, v246, 1, 1
  s_waitcnt lgkmcnt(4)
  v_mfma_f32_32x32x16_bf16 v[128:143], a[80:83], a[128:131], v[128:143]
  ds_read_b64_tr_b16 a[72:73], v209 offset:12288
  ds_read_b64_tr_b16 a[74:75], v209 offset:12800
  buffer_load_dwordx4 v250, s[16:19], s71 offen lds
  v_cvt_pk_bf16_f32 v115, v118, v119
  v_mul_u32_u24 v247, 18, v247
  v_mfma_f32_32x32x16_bf16 v[128:143], a[84:87], a[132:135], v[128:143]
  ds_read_b64_tr_b16 a[76:77], v209 offset:13312
  ds_read_b64_tr_b16 a[78:79], v209 offset:13824
  v_cvt_pk_bf16_f32 v116, v120, v121
  v_add_u32 v183, v183, v247
  v_cvt_pk_bf16_f32 v117, v122, v123
  s_waitcnt lgkmcnt(4)
  v_mfma_f32_32x32x16_bf16 v[128:143], a[88:91], a[136:139], v[128:143]
  ds_read_b64_tr_b16 a[80:81], v209 offset:14336
  ds_read_b64_tr_b16 a[82:83], v209 offset:14848
  v_and_b32 v247, 1, v246
  v_add_u32 v183, v183, v247
  v_cvt_pk_bf16_f32 v118, v124, v125
  v_add_u32 v183, 16, v183
  v_mfma_f32_32x32x16_bf16 v[128:143], a[92:95], a[140:143], v[128:143]
  ds_read_b64_tr_b16 a[84:85], v209 offset:15360
  ds_read_b64_tr_b16 a[86:87], v209 offset:15872
  v_mul_u32_u24 v183, 1152, v183
  v_cvt_pk_bf16_f32 v119, v126, v127
  s_waitcnt lgkmcnt(4)
  v_mfma_f32_32x32x16_bf16 v[128:143], a[72:75], a[144:147], v[128:143]
  ds_read_b64_tr_b16 a[88:89], v209 offset:16384
  ds_read_b64_tr_b16 a[90:91], v209 offset:16896
  v_lshl_add_u32 v183, v245, 4, v183
  s_add_u32 s82, s58, 114688
  v_mfma_f32_32x32x16_bf16 v[128:143], a[76:79], a[148:151], v[128:143]
  ds_read_b64_tr_b16 a[92:93], v209 offset:17408
  ds_read_b64_tr_b16 a[94:95], v209 offset:17920
  v_subrev_u32 v183, 3072, v183
  s_waitcnt lgkmcnt(4)
  v_mfma_f32_32x32x16_bf16 v[128:143], a[80:83], a[152:155], v[128:143]
  v_add_u32 v210, 55296, v213
  s_waitcnt vmcnt(48)
  ds_read_b64_tr_b16 a[72:73], v210 offset:0
  ds_read_b64_tr_b16 a[74:75], v210 offset:1280
  buffer_store_dwordx4 v[112:115], v224, s[40:43], s82 offen sc1
  v_mfma_f32_32x32x16_bf16 v[128:143], a[84:87], a[156:159], v[128:143]
  ds_read_b64_tr_b16 a[76:77], v210 offset:64
  ds_read_b64_tr_b16 a[78:79], v210 offset:1344
  v_add_u32 v245, 256, v208
  s_add_u32 s82, s58, 122880
  s_waitcnt lgkmcnt(4)
  v_mfma_f32_32x32x16_bf16 v[128:143], a[88:91], a[160:163], v[128:143]
  ds_read_b64_tr_b16 a[80:81], v210 offset:128
  ds_read_b64_tr_b16 a[82:83], v210 offset:1408
  v_mul_u32_u24 v246, 205, v245
  buffer_store_dwordx4 v[116:119], v224, s[40:43], s82 offen sc1
  v_mfma_f32_32x32x16_bf16 v[128:143], a[92:95], a[164:167], v[128:143]
  s_barrier
  ds_read_b64_tr_b16 a[84:85], v210 offset:192
  ds_read_b64_tr_b16 a[86:87], v210 offset:1472
  s_add_u32 m0, s85, 20480
  s_add_u32 s71, s62, 124416
  s_waitcnt vmcnt(32) lgkmcnt(4)
  v_mfma_f32_32x32x16_bf16 v[0:15], a[72:75], v[144:147], 0
  ds_read_b64_tr_b16 a[88:89], v210 offset:256
  ds_read_b64_tr_b16 a[90:91], v210 offset:1536
  buffer_load_dwordx4 v219, s[16:19], s71 offen offset:0 lds
  v_lshrrev_b32 v246, 12, v246
  v_mfma_f32_32x32x16_bf16 v[16:31], a[76:79], v[144:147], 0
  ds_read_b64_tr_b16 a[92:93], v210 offset:20480
  ds_read_b64_tr_b16 a[94:95], v210 offset:21760
  v_mul_u32_u24 v247, 20, v246
  s_waitcnt lgkmcnt(4)
  v_mfma_f32_32x32x16_bf16 v[32:47], a[80:83], v[144:147], 0
  ds_read_b64_tr_b16 a[72:73], v210 offset:20544
  ds_read_b64_tr_b16 a[74:75], v210 offset:21824
  buffer_load_dwordx4 v220, s[16:19], s71 offen offset:1024 lds
  v_cvt_pk_bf16_f32 v128, v128, v129
  v_cvt_pk_bf16_f32 v129, v130, v131
  v_mfma_f32_32x32x16_bf16 v[48:63], a[84:87], v[144:147], 0
  ds_read_b64_tr_b16 a[76:77], v210 offset:20608
  ds_read_b64_tr_b16 a[78:79], v210 offset:21888
  v_cvt_pk_bf16_f32 v130, v132, v133
  v_sub_u32 v245, v245, v247
  s_waitcnt lgkmcnt(4)
  v_mfma_f32_32x32x16_bf16 v[64:79], a[88:91], v[144:147], 0
  ds_read_b64_tr_b16 a[80:81], v210 offset:20672
  ds_read_b64_tr_b16 a[82:83], v210 offset:21952
  buffer_load_dwordx4 v221, s[16:19], s71 offen offset:2048 lds
  v_cvt_pk_bf16_f32 v131, v134, v135
  v_cvt_pk_bf16_f32 v132, v136, v137
  s_waitcnt vmcnt(34)
  v_mfma_f32_32x32x16_bf16 v[0:15], a[92:95], v[148:151], v[0:15]
  ds_read_b64_tr_b16 a[84:85], v210 offset:20736
  ds_read_b64_tr_b16 a[86:87], v210 offset:22016
  v_cvt_pk_bf16_f32 v133, v138, v139
  v_lshrrev_b32 v247, 2, v246
  v_mul_u32_u24 v184, 36, v247
  s_waitcnt lgkmcnt(4)
  v_mfma_f32_32x32x16_bf16 v[16:31], a[72:75], v[148:151], v[16:31]
  s_waitcnt vmcnt(26)
  ds_read_b64_tr_b16 a[88:89], v210 offset:40960
  ds_read_b64_tr_b16 a[90:91], v210 offset:42240
  buffer_load_dwordx4 v222, s[16:19], s71 offen offset:3072 lds
  v_cvt_pk_bf16_f32 v134, v140, v141
  v_cvt_pk_bf16_f32 v135, v142, v143
  v_mfma_f32_32x32x16_bf16 v[32:47], a[76:79], v[148:151], v[32:47]
  ds_read_b64_tr_b16 a[92:93], v210 offset:41024
  ds_read_b64_tr_b16 a[94:95], v210 offset:42304
  s_add_u32 m0, s85, 24576
  s_add_u32 s82, s59, 0
  v_bfe_u32 v247, v246, 1, 1
  s_waitcnt lgkmcnt(4)
  v_mfma_f32_32x32x16_bf16 v[48:63], a[80:83], v[148:151], v[48:63]
  ds_read_b64_tr_b16 a[72:73], v210 offset:41088
  ds_read_b64_tr_b16 a[74:75], v210 offset:42368
  buffer_load_dwordx4 v250, s[16:19], s71 offen lds
  buffer_store_dwordx4 v[128:131], v224, s[40:43], s82 offen sc1
  s_add_u32 s82, s59, 8192
  v_mfma_f32_32x32x16_bf16 v[64:79], a[84:87], v[148:151], v[64:79]
  ds_read_b64_tr_b16 a[76:77], v210 offset:41152
  ds_read_b64_tr_b16 a[78:79], v210 offset:42432
  s_add_u32 m0, s85, 55296
  s_add_u32 s71, s62, 145152
  buffer_store_dwordx4 v[132:135], v224, s[40:43], s82 offen sc1
  s_waitcnt lgkmcnt(4)
  v_mfma_f32_32x32x16_bf16 v[0:15], a[88:91], v[152:155], v[0:15]
  ds_read_b64_tr_b16 a[80:81], v210 offset:41216
  ds_read_b64_tr_b16 a[82:83], v210 offset:42496
  buffer_load_dwordx4 v219, s[16:19], s71 offen offset:0 lds
  v_mul_u32_u24 v247, 18, v247
  v_add_u32 v184, v184, v247
  v_mfma_f32_32x32x16_bf16 v[16:31], a[92:95], v[152:155], v[16:31]
  s_waitcnt vmcnt(22)
  ds_read_b64_tr_b16 a[84:85], v210 offset:61440
  ds_read_b64_tr_b16 a[86:87], v210 offset:62720
  v_and_b32 v247, 1, v246
  s_waitcnt lgkmcnt(4)
  v_mfma_f32_32x32x16_bf16 v[32:47], a[72:75], v[152:155], v[32:47]
  s_waitcnt vmcnt(1)
  s_barrier
  ds_read_b64_tr_b16 a[88:89], v210 offset:61504
  ds_read_b64_tr_b16 a[90:91], v210 offset:62784
  buffer_load_dwordx4 v220, s[16:19], s71 offen offset:1024 lds
  v_mov_b32 v255, 1
  buffer_store_dword v255, v253, s[40:43], s66 offen sc1
  v_mfma_f32_32x32x16_bf16 v[48:63], a[76:79], v[152:155], v[48:63]
  ds_read_b64_tr_b16 a[92:93], v210 offset:61568
  ds_read_b64_tr_b16 a[94:95], v210 offset:62848
  v_add_u32 v184, v184, v247
  v_add_u32 v184, 16, v184
  s_waitcnt lgkmcnt(4)
  v_mfma_f32_32x32x16_bf16 v[64:79], a[80:83], v[152:155], v[64:79]
  ds_read_b64_tr_b16 a[72:73], v210 offset:61632
  ds_read_b64_tr_b16 a[74:75], v210 offset:62912
  buffer_load_dwordx4 v221, s[16:19], s71 offen offset:2048 lds
  v_mfma_f32_32x32x16_bf16 v[0:15], a[84:87], v[156:159], v[0:15]
  ds_read_b64_tr_b16 a[76:77], v210 offset:61696
  ds_read_b64_tr_b16 a[78:79], v210 offset:62976
  v_mul_u32_u24 v184, 1152, v184
  s_waitcnt lgkmcnt(4)
  v_mfma_f32_32x32x16_bf16 v[16:31], a[88:91], v[156:159], v[16:31]
  v_add_u32 v210, 137216, v213
  ds_read_b64_tr_b16 a[80:81], v210 offset:0
  ds_read_b64_tr_b16 a[82:83], v210 offset:1280
  buffer_load_dwordx4 v222, s[16:19], s71 offen offset:3072 lds
  v_lshl_add_u32 v184, v245, 4, v184
  v_mfma_f32_32x32x16_bf16 v[32:47], a[92:95], v[156:159], v[32:47]
  ds_read_b64_tr_b16 a[84:85], v210 offset:64
  ds_read_b64_tr_b16 a[86:87], v210 offset:1344
  s_add_u32 m0, s85, 59392
  v_and_b32 v233, 31, v208
  v_mul_u32_u24 v233, 1152, v233
  s_waitcnt lgkmcnt(4)
  v_mfma_f32_32x32x16_bf16 v[48:63], a[72:75], v[156:159], v[48:63]
  ds_read_b64_tr_b16 a[88:89], v210 offset:128
  ds_read_b64_tr_b16 a[90:91], v210 offset:1408
  buffer_load_dwordx4 v250, s[16:19], s71 offen lds
  v_lshrrev_b32 v235, 5, v208
  v_lshl_add_u32 v233, v235, 3, v233
  v_mfma_f32_32x32x16_bf16 v[64:79], a[76:79], v[156:159], v[64:79]
  ds_read_b64_tr_b16 a[92:93], v210 offset:192
  ds_read_b64_tr_b16 a[94:95], v210 offset:1472
  s_add_u32 m0, s85, 75776
  s_add_u32 s71, s62, 0
  s_lshl_b32 s47, s45, 2
  s_waitcnt lgkmcnt(4)
  v_mfma_f32_32x32x16_bf16 v[0:15], a[80:83], v[160:163], v[0:15]
  ds_read_b64_tr_b16 a[72:73], v210 offset:256
  ds_read_b64_tr_b16 a[74:75], v210 offset:1536
  buffer_load_dwordx4 v180, s[16:19], s71 offen offset:0 lds
  s_add_u32 s47, s47, s94
  s_mul_i32 s47, s47, 36864
  v_mfma_f32_32x32x16_bf16 v[16:31], a[84:87], v[160:163], v[16:31]
  v_mov_b32 v210, v213
  ds_read_b64_tr_b16 a[76:77], v210 offset:0
  ds_read_b64_tr_b16 a[78:79], v210 offset:1280
  s_mul_i32 s68, s95, 288
  s_waitcnt lgkmcnt(4)
  v_mfma_f32_32x32x16_bf16 v[32:47], a[88:91], v[160:163], v[32:47]
  ds_read_b64_tr_b16 a[80:81], v210 offset:64
  ds_read_b64_tr_b16 a[82:83], v210 offset:1344
  buffer_load_dwordx4 v181, s[16:19], s71 offen offset:1024 lds
  v_mfma_f32_32x32x16_bf16 v[48:63], a[92:95], v[160:163], v[48:63]
  ds_read_b64_tr_b16 a[84:85], v210 offset:128
  ds_read_b64_tr_b16 a[86:87], v210 offset:1408
  s_add_u32 s79, s47, s68
  s_waitcnt lgkmcnt(4)
  v_mfma_f32_32x32x16_bf16 v[64:79], a[72:75], v[160:163], v[64:79]
  ds_read_b64_tr_b16 a[88:89], v210 offset:192
  ds_read_b64_tr_b16 a[90:91], v210 offset:1472
  buffer_load_dwordx4 v182, s[16:19], s71 offen offset:2048 lds
  s_lshl_b32 s68, s46, 6
  v_mfma_f32_32x32x16_bf16 v[0:15], a[76:79], v[164:167], v[0:15]
  ds_read_b64_tr_b16 a[92:93], v210 offset:256
  ds_read_b64_tr_b16 a[94:95], v210 offset:1536
  s_add_u32 s98, s68, s79
  s_waitcnt lgkmcnt(4)
  v_mfma_f32_32x32x16_bf16 v[16:31], a[80:83], v[164:167], v[16:31]
  ds_read_b64_tr_b16 a[72:73], v210 offset:20480
  ds_read_b64_tr_b16 a[74:75], v210 offset:21760
  buffer_load_dwordx4 v183, s[16:19], s71 offen offset:3072 lds
  buffer_load_dwordx2 v[96:97], v233, s[8:11], s98 offen offset:0
  v_mfma_f32_32x32x16_bf16 v[32:47], a[84:87], v[164:167], v[32:47]
  ds_read_b64_tr_b16 a[76:77], v210 offset:20544
  ds_read_b64_tr_b16 a[78:79], v210 offset:21824
  s_add_u32 m0, s85, 79872
  buffer_load_dwordx2 v[98:99], v233, s[8:11], s98 offen offset:16
  s_waitcnt lgkmcnt(4)
  v_mfma_f32_32x32x16_bf16 v[48:63], a[88:91], v[164:167], v[48:63]
  ds_read_b64_tr_b16 a[80:81], v210 offset:20608
  ds_read_b64_tr_b16 a[82:83], v210 offset:21888
  buffer_load_dwordx4 v184, s[16:19], s71 offen lds
  buffer_load_dwordx2 v[100:101], v233, s[8:11], s98 offen offset:32
  v_mfma_f32_32x32x16_bf16 v[64:79], a[92:95], v[164:167], v[64:79]
  ds_read_b64_tr_b16 a[84:85], v210 offset:20672
  ds_read_b64_tr_b16 a[86:87], v210 offset:21952
  buffer_load_dwordx2 v[102:103], v233, s[8:11], s98 offen offset:48
  s_waitcnt lgkmcnt(4)
  v_mfma_f32_32x32x16_bf16 v[0:15], a[72:75], v[168:171], v[0:15]
  ds_read_b64_tr_b16 a[88:89], v210 offset:20736
  ds_read_b64_tr_b16 a[90:91], v210 offset:22016
  s_lshr_b32 s69, s46, 1
  v_mfma_f32_32x32x16_bf16 v[16:31], a[76:79], v[168:171], v[16:31]
  s_waitcnt vmcnt(9)
  ds_read_b64_tr_b16 a[92:93], v210 offset:55296
  ds_read_b64_tr_b16 a[94:95], v210 offset:56576
  s_waitcnt lgkmcnt(4)
  v_mfma_f32_32x32x16_bf16 v[32:47], a[80:83], v[168:171], v[32:47]
  ds_read_b64_tr_b16 a[72:73], v210 offset:55360
  ds_read_b64_tr_b16 a[74:75], v210 offset:56640
  s_lshl_b32 s69, s69, 4
  v_mfma_f32_32x32x16_bf16 v[48:63], a[84:87], v[168:171], v[48:63]
  ds_read_b64_tr_b16 a[76:77], v210 offset:55424
  ds_read_b64_tr_b16 a[78:79], v210 offset:56704
  s_and_b32 s70, s46, 1
  s_waitcnt lgkmcnt(4)
  v_mfma_f32_32x32x16_bf16 v[64:79], a[88:91], v[168:171], v[64:79]
  ds_read_b64_tr_b16 a[80:81], v210 offset:55488
  ds_read_b64_tr_b16 a[82:83], v210 offset:56768
  s_lshl_b32 s70, s70, 2
  v_mfma_f32_32x32x16_bf16 v[0:15], a[92:95], v[172:175], v[0:15]
  ds_read_b64_tr_b16 a[84:85], v210 offset:55552
  ds_read_b64_tr_b16 a[86:87], v210 offset:56832
  s_add_u32 s69, s69, s70
  s_waitcnt lgkmcnt(4)
  v_mfma_f32_32x32x16_bf16 v[16:31], a[72:75], v[172:175], v[16:31]
  v_add_u32 v210, 75776, v213
  s_waitcnt vmcnt(2)
  ds_read_b64_tr_b16 a[88:89], v210 offset:0
  ds_read_b64_tr_b16 a[90:91], v210 offset:1280
  s_add_u32 s69, s69, 256
  v_mfma_f32_32x32x16_bf16 v[32:47], a[76:79], v[172:175], v[32:47]
  ds_read_b64_tr_b16 a[92:93], v210 offset:64
  ds_read_b64_tr_b16 a[94:95], v210 offset:1344
  s_add_u32 s79, s79, s69
  s_waitcnt lgkmcnt(4)
  v_mfma_f32_32x32x16_bf16 v[48:63], a[80:83], v[172:175], v[48:63]
  ds_read_b64_tr_b16 a[72:73], v210 offset:128
  ds_read_b64_tr_b16 a[74:75], v210 offset:1408
  buffer_load_dword v104, v233, s[8:11], s79 offen
  v_mfma_f32_32x32x16_bf16 v[64:79], a[84:87], v[172:175], v[64:79]
  ds_read_b64_tr_b16 a[76:77], v210 offset:192
  ds_read_b64_tr_b16 a[78:79], v210 offset:1472
  s_waitcnt lgkmcnt(4)
  v_mfma_f32_32x32x16_bf16 v[0:15], a[88:91], v[176:179], v[0:15]
  ds_read_b64_tr_b16 a[80:81], v210 offset:256
  ds_read_b64_tr_b16 a[82:83], v210 offset:1536
  v_mfma_f32_32x32x16_bf16 v[16:31], a[92:95], v[176:179], v[16:31]
  s_waitcnt lgkmcnt(2)
  v_mfma_f32_32x32x16_bf16 v[32:47], a[72:75], v[176:179], v[32:47]
  v_mfma_f32_32x32x16_bf16 v[48:63], a[76:79], v[176:179], v[48:63]
  s_waitcnt lgkmcnt(0)
  v_mfma_f32_32x32x16_bf16 v[64:79], a[80:83], v[176:179], v[64:79]
  v_and_b32 v234, 7, v208
  v_lshlrev_b32 v234, 2, v234
  s_mov_b32 s83, 0x10000
L_fspin0:
  buffer_load_dword v251, v234, s[40:43], s5 offen sc1
  s_waitcnt vmcnt(0)
  v_cmp_ne_u32 vcc, 1, v251
  s_nop 4
  s_cbranch_vccz L_fspin0_done
  s_sleep 2
  s_sub_u32 s83, s83, 1
  s_cmp_lg_u32 s83, 0
  s_cbranch_scc1 L_fspin0
L_fspin0_done:
  s_lshl_b32 s47, s46, 14
  s_add_u32 s47, s47, s80
  s_add_u32 s47, s47, 0
  buffer_load_dwordx4 v[144:147], v224, s[40:43], s47 offen offset:0 sc1
  buffer_load_dwordx4 v[148:151], v224, s[40:43], s47 offen offset:1024 sc1
  buffer_load_dwordx4 v[152:155], v224, s[40:43], s47 offen offset:2048 sc1
  buffer_load_dwordx4 v[156:159], v224, s[40:43], s47 offen offset:3072 sc1
  s_add_u32 s47, s47, 4096
  buffer_load_dwordx4 v[160:163], v224, s[40:43], s47 offen offset:0 sc1
  buffer_load_dwordx4 v[164:167], v224, s[40:43], s47 offen offset:1024 sc1
  buffer_load_dwordx4 v[168:171], v224, s[40:43], s47 offen offset:2048 sc1
  buffer_load_dwordx4 v[172:175], v224, s[40:43], s47 offen offset:3072 sc1
  s_add_u32 s47, s47, 4096
  buffer_load_dwordx4 v[176:179], v224, s[40:43], s47 offen offset:0 sc1
  buffer_load_dwordx4 v[180:183], v224, s[40:43], s47 offen offset:1024 sc1
  buffer_load_dwordx4 v[184:187], v224, s[40:43], s47 offen offset:2048 sc1
  buffer_load_dwordx4 v[188:191], v224, s[40:43], s47 offen offset:3072 sc1
  s_add_u32 s47, s47, 4096
  buffer_load_dwordx4 v[192:195], v224, s[40:43], s47 offen offset:0 sc1
  buffer_load_dwordx4 v[196:199], v224, s[40:43], s47 offen offset:1024 sc1
  buffer_load_dwordx4 v[200:203], v224, s[40:43], s47 offen offset:2048 sc1
  buffer_load_dwordx4 v[204:207], v224, s[40:43], s47 offen offset:3072 sc1
  s_lshl_b32 s47, s46, 11
  s_add_u32 s47, s47, s80
  s_add_u32 s47, s47, 65536
  buffer_load_dwordx4 v[72:75], v224, s[40:43], s47 offen offset:0 sc1
  buffer_load_dwordx4 v[76:79], v224, s[40:43], s47 offen offset:1024 sc1
  s_mul_i32 s47, s46, 18432
  s_add_u32 s47, s47, 0
  v_add_u32 v238, s47, v224
  s_barrier
  ds_write_b128 v238, v[0:3] offset:0
  ds_write_b128 v238, v[4:7] offset:1024
  ds_write_b128 v238, v[8:11] offset:2048
  ds_write_b128 v238, v[12:15] offset:3072
  ds_write_b128 v238, v[16:19] offset:4096
  ds_write_b128 v238, v[20:23] offset:5120
  ds_write_b128 v238, v[24:27] offset:6144
  ds_write_b128 v238, v[28:31] offset:7168
  ds_write_b128 v238, v[32:35] offset:8192
  ds_write_b128 v238, v[36:39] offset:9216
  ds_write_b128 v238, v[40:43] offset:10240
  ds_write_b128 v238, v[44:47] offset:11264
  ds_write_b128 v238, v[48:51] offset:12288
  ds_write_b128 v238, v[52:55] offset:13312
  ds_write_b128 v238, v[56:59] offset:14336
  ds_write_b128 v238, v[60:63] offset:15360
  ds_write_b128 v238, v[64:67] offset:16384
  ds_write_b128 v238, v[68:71] offset:17408
  s_waitcnt lgkmcnt(0)
  s_barrier
  s_lshl_b32 s47, s46, 12
  s_add_u32 s47, s47, 0
  v_add_u32 v238, s47, v224
  ds_read_b128 v[0:3], v238 offset:0
  ds_read_b128 v[4:7], v238 offset:1024
  ds_read_b128 v[8:11], v238 offset:2048
  ds_read_b128 v[12:15], v238 offset:3072
  ds_read_b128 v[16:19], v238 offset:18432
  ds_read_b128 v[20:23], v238 offset:19456
  ds_read_b128 v[24:27], v238 offset:20480
  ds_read_b128 v[28:31], v238 offset:21504
  ds_read_b128 v[32:35], v238 offset:36864
  ds_read_b128 v[36:39], v238 offset:37888
  ds_read_b128 v[40:43], v238 offset:38912
  ds_read_b128 v[44:47], v238 offset:39936
  ds_read_b128 v[48:51], v238 offset:55296
  ds_read_b128 v[52:55], v238 offset:56320
  ds_read_b128 v[56:59], v238 offset:57344
  ds_read_b128 v[60:63], v238 offset:58368
  s_lshr_b32 s47, s46, 1
  s_lshl_b32 s47, s47, 10
  s_and_b32 s68, s46, 1
  s_lshl_b32 s68, s68, 3
  s_add_u32 s47, s47, s68
  s_add_u32 s47, s47, 16384
  v_add_u32 v239, s47, v224
  ds_read_b64 v[64:65], v239 offset:0
  ds_read_b64 v[66:67], v239 offset:18432
  ds_read_b64 v[68:69], v239 offset:36864
  ds_read_b64 v[70:71], v239 offset:55296
  v_add_f32 v0, v0, v16
  s_waitcnt lgkmcnt(7)
  v_add_f32 v32, v32, v48
  v_add_f32 v1, v1, v17
  v_add_f32 v33, v33, v49
  v_add_f32 v2, v2, v18
  v_add_f32 v34, v34, v50
  v_add_f32 v3, v3, v19
  v_add_f32 v35, v35, v51
  v_add_f32 v4, v4, v20
  s_waitcnt lgkmcnt(6)
  v_add_f32 v36, v36, v52
  v_add_f32 v5, v5, v21
  v_add_f32 v37, v37, v53
  v_add_f32 v6, v6, v22
  v_add_f32 v38, v38, v54
  v_add_f32 v7, v7, v23
  v_add_f32 v39, v39, v55
  v_add_f32 v8, v8, v24
  s_waitcnt lgkmcnt(5)
  v_add_f32 v40, v40, v56
  v_add_f32 v9, v9, v25
  v_add_f32 v41, v41, v57
  v_add_f32 v10, v10, v26
  v_add_f32 v42, v42, v58
  v_add_f32 v11, v11, v27
  v_add_f32 v43, v43, v59
  v_add_f32 v12, v12, v28
  s_waitcnt lgkmcnt(4)
  v_add_f32 v44, v44, v60
  v_add_f32 v13, v13, v29
  v_add_f32 v45, v45, v61
  v_add_f32 v14, v14, v30
  v_add_f32 v46, v46, v62
  v_add_f32 v15, v15, v31
  v_add_f32 v47, v47, v63
  v_add_f32 v0, v0, v32
  v_add_f32 v1, v1, v33
  v_add_f32 v2, v2, v34
  v_add_f32 v3, v3, v35
  v_add_f32 v4, v4, v36
  v_add_f32 v5, v5, v37
  v_add_f32 v6, v6, v38
  v_add_f32 v7, v7, v39
  v_add_f32 v8, v8, v40
  v_add_f32 v9, v9, v41
  v_add_f32 v10, v10, v42
  v_add_f32 v11, v11, v43
  v_add_f32 v12, v12, v44
  v_add_f32 v13, v13, v45
  v_add_f32 v14, v14, v46
  v_add_f32 v15, v15, v47
  s_waitcnt lgkmcnt(2)
  v_add_f32 v64, v64, v66
  s_waitcnt lgkmcnt(0)
  v_add_f32 v68, v68, v70
  v_add_f32 v65, v65, v67
  v_add_f32 v69, v69, v71
  v_add_f32 v64, v64, v68
  v_add_f32 v65, v65, v69
  v_mov_b32 v236, 0x00003f80
  v_mov_b32 v237, 0x3f800000
  v_mov_b32 v16, 0
  v_mov_b32 v17, 0
  v_mov_b32 v18, 0
  v_mov_b32 v19, 0
  v_mov_b32 v20, 0
  v_mov_b32 v21, 0
  v_mov_b32 v22, 0
  v_mov_b32 v23, 0
  v_mov_b32 v24, 0
  v_mov_b32 v25, 0
  v_mov_b32 v26, 0
  v_mov_b32 v27, 0
  v_mov_b32 v28, 0
  v_mov_b32 v29, 0
  v_mov_b32 v30, 0
  v_mov_b32 v31, 0
  v_mov_b32 v32, 0
  v_mov_b32 v33, 0
  v_mov_b32 v34, 0
  v_mov_b32 v35, 0
  v_mov_b32 v36, 0
  v_mov_b32 v37, 0
  v_mov_b32 v38, 0
  v_mov_b32 v39, 0
  s_waitcnt vmcnt(17)
  v_dot2c_f32_bf16 v16, v144, v236
  v_dot2c_f32_bf16 v17, v144, v237
  v_dot2c_f32_bf16 v18, v145, v236
  v_dot2c_f32_bf16 v19, v145, v237
  v_dot2c_f32_bf16 v20, v146, v236
  v_dot2c_f32_bf16 v21, v146, v237
  v_dot2c_f32_bf16 v22, v147, v236
  v_dot2c_f32_bf16 v23, v147, v237
  s_waitcnt vmcnt(16)
  v_dot2c_f32_bf16 v16, v148, v236
  v_dot2c_f32_bf16 v17, v148, v237
  v_dot2c_f32_bf16 v18, v149, v236
  v_dot2c_f32_bf16 v19, v149, v237
  v_dot2c_f32_bf16 v20, v150, v236
  v_dot2c_f32_bf16 v21, v150, v237
  v_dot2c_f32_bf16 v22, v151, v236
  v_dot2c_f32_bf16 v23, v151, v237
  s_waitcnt vmcnt(15)
  v_dot2c_f32_bf16 v16, v152, v236
  v_dot2c_f32_bf16 v17, v152, v237
  v_dot2c_f32_bf16 v18, v153, v236
  v_dot2c_f32_bf16 v19, v153, v237
  v_dot2c_f32_bf16 v20, v154, v236
  v_dot2c_f32_bf16 v21, v154, v237
  v_dot2c_f32_bf16 v22, v155, v236
  v_dot2c_f32_bf16 v23, v155, v237
  s_waitcnt vmcnt(14)
  v_dot2c_f32_bf16 v16, v156, v236
  v_dot2c_f32_bf16 v17, v156, v237
  v_dot2c_f32_bf16 v18, v157, v236
  v_dot2c_f32_bf16 v19, v157, v237
  v_dot2c_f32_bf16 v20, v158, v236
  v_dot2c_f32_bf16 v21, v158, v237
  v_dot2c_f32_bf16 v22, v159, v236
  v_dot2c_f32_bf16 v23, v159, v237
  s_waitcnt vmcnt(13)
  v_dot2c_f32_bf16 v16, v160, v236
  v_dot2c_f32_bf16 v17, v160, v237
  v_dot2c_f32_bf16 v18, v161, v236
  v_dot2c_f32_bf16 v19, v161, v237
  v_dot2c_f32_bf16 v20, v162, v236
  v_dot2c_f32_bf16 v21, v162, v237
  v_dot2c_f32_bf16 v22, v163, v236
  v_dot2c_f32_bf16 v23, v163, v237
  s_waitcnt vmcnt(12)
  v_dot2c_f32_bf16 v16, v164, v236
  v_dot2c_f32_bf16 v17, v164, v237
  v_dot2c_f32_bf16 v18, v165, v236
  v_dot2c_f32_bf16 v19, v165, v237
  v_dot2c_f32_bf16 v20, v166, v236
  v_dot2c_f32_bf16 v21, v166, v237
  v_dot2c_f32_bf16 v22, v167, v236
  v_dot2c_f32_bf16 v23, v167, v237
  s_waitcnt vmcnt(11)
  v_dot2c_f32_bf16 v16, v168, v236
  v_dot2c_f32_bf16 v17, v168, v237
  v_dot2c_f32_bf16 v18, v169, v236
  v_dot2c_f32_bf16 v19, v169, v237
  v_dot2c_f32_bf16 v20, v170, v236
  v_dot2c_f32_bf16 v21, v170, v237
  v_dot2c_f32_bf16 v22, v171, v236
  v_dot2c_f32_bf16 v23, v171, v237
  s_waitcnt vmcnt(10)
  v_dot2c_f32_bf16 v16, v172, v236
  v_dot2c_f32_bf16 v17, v172, v237
  v_dot2c_f32_bf16 v18, v173, v236
  v_dot2c_f32_bf16 v19, v173, v237
  v_dot2c_f32_bf16 v20, v174, v236
  v_dot2c_f32_bf16 v21, v174, v237
  v_dot2c_f32_bf16 v22, v175, v236
  v_dot2c_f32_bf16 v23, v175, v237
  s_waitcnt vmcnt(9)
  v_dot2c_f32_bf16 v24, v176, v236
  v_dot2c_f32_bf16 v25, v176, v237
  v_dot2c_f32_bf16 v26, v177, v236
  v_dot2c_f32_bf16 v27, v177, v237
  v_dot2c_f32_bf16 v28, v178, v236
  v_dot2c_f32_bf16 v29, v178, v237
  v_dot2c_f32_bf16 v30, v179, v236
  v_dot2c_f32_bf16 v31, v179, v237
  s_waitcnt vmcnt(8)
  v_dot2c_f32_bf16 v24, v180, v236
  v_dot2c_f32_bf16 v25, v180, v237
  v_dot2c_f32_bf16 v26, v181, v236
  v_dot2c_f32_bf16 v27, v181, v237
  v_dot2c_f32_bf16 v28, v182, v236
  v_dot2c_f32_bf16 v29, v182, v237
  v_dot2c_f32_bf16 v30, v183, v236
  v_dot2c_f32_bf16 v31, v183, v237
  s_waitcnt vmcnt(7)
  v_dot2c_f32_bf16 v24, v184, v236
  v_dot2c_f32_bf16 v25, v184, v237
  v_dot2c_f32_bf16 v26, v185, v236
  v_dot2c_f32_bf16 v27, v185, v237
  v_dot2c_f32_bf16 v28, v186, v236
  v_dot2c_f32_bf16 v29, v186, v237
  v_dot2c_f32_bf16 v30, v187, v236
  v_dot2c_f32_bf16 v31, v187, v237
  s_waitcnt vmcnt(6)
  v_dot2c_f32_bf16 v24, v188, v236
  v_dot2c_f32_bf16 v25, v188, v237
  v_dot2c_f32_bf16 v26, v189, v236
  v_dot2c_f32_bf16 v27, v189, v237
  v_dot2c_f32_bf16 v28, v190, v236
  v_dot2c_f32_bf16 v29, v190, v237
  v_dot2c_f32_bf16 v30, v191, v236
  v_dot2c_f32_bf16 v31, v191, v237
  s_waitcnt vmcnt(5)
  v_dot2c_f32_bf16 v24, v192, v236
  v_dot2c_f32_bf16 v25, v192, v237
  v_dot2c_f32_bf16 v26, v193, v236
  v_dot2c_f32_bf16 v27, v193, v237
  v_dot2c_f32_bf16 v28, v194, v236
  v_dot2c_f32_bf16 v29, v194, v237
  v_dot2c_f32_bf16 v30, v195, v236
  v_dot2c_f32_bf16 v31, v195, v237
  s_waitcnt vmcnt(4)
  v_dot2c_f32_bf16 v24, v196, v236
  v_dot2c_f32_bf16 v25, v196, v237
  v_dot2c_f32_bf16 v26, v197, v236
  v_dot2c_f32_bf16 v27, v197, v237
  v_dot2c_f32_bf16 v28, v198, v236
  v_dot2c_f32_bf16 v29, v198, v237
  v_dot2c_f32_bf16 v30, v199, v236
  v_dot2c_f32_bf16 v31, v199, v237
  s_waitcnt vmcnt(3)
  v_dot2c_f32_bf16 v24, v200, v236
  v_dot2c_f32_bf16 v25, v200, v237
  v_dot2c_f32_bf16 v26, v201, v236
  v_dot2c_f32_bf16 v27, v201, v237
  v_dot2c_f32_bf16 v28, v202, v236
  v_dot2c_f32_bf16 v29, v202, v237
  v_dot2c_f32_bf16 v30, v203, v236
  v_dot2c_f32_bf16 v31, v203, v237
  s_waitcnt vmcnt(2)
  v_dot2c_f32_bf16 v24, v204, v236
  v_dot2c_f32_bf16 v25, v204, v237
  v_dot2c_f32_bf16 v26, v205, v236
  v_dot2c_f32_bf16 v27, v205, v237
  v_dot2c_f32_bf16 v28, v206, v236
  v_dot2c_f32_bf16 v29, v206, v237
  v_dot2c_f32_bf16 v30, v207, v236
  v_dot2c_f32_bf16 v31, v207, v237
  s_waitcnt vmcnt(1)
  v_dot2c_f32_bf16 v32, v72, v236
  v_dot2c_f32_bf16 v33, v72, v237
  v_dot2c_f32_bf16 v34, v73, v236
  v_dot2c_f32_bf16 v35, v73, v237
  v_dot2c_f32_bf16 v36, v74, v236
  v_dot2c_f32_bf16 v37, v74, v237
  v_dot2c_f32_bf16 v38, v75, v236
  v_dot2c_f32_bf16 v39, v75, v237
  s_waitcnt vmcnt(0)
  v_dot2c_f32_bf16 v32, v76, v236
  v_dot2c_f32_bf16 v33, v76, v237
  v_dot2c_f32_bf16 v34, v77, v236
  v_dot2c_f32_bf16 v35, v77, v237
  v_dot2c_f32_bf16 v36, v78, v236
  v_dot2c_f32_bf16 v37, v78, v237
  v_dot2c_f32_bf16 v38, v79, v236
  v_dot2c_f32_bf16 v39, v79, v237
  s_lshl_b32 s47, s46, 11
  s_add_u32 s47, s47, 73728
  v_add_u32 v238, s47, v224
  ds_write_b128 v238, v[32:35]
  ds_write_b128 v238, v[36:39] offset:1024
  v_mul_f32 v240, 0xbfb8aa3b, v16
  v_mul_f32 v241, 0xbfb8aa3b, v17
  v_mul_f32 v242, 0xbfb8aa3b, v18
  v_mul_f32 v243, 0xbfb8aa3b, v19
  v_exp_f32 v240, v240
  v_exp_f32 v241, v241
  v_exp_f32 v242, v242
  v_exp_f32 v243, v243
  v_add_f32 v240, 1.0, v240
  v_add_f32 v241, 1.0, v241
  v_add_f32 v242, 1.0, v242
  v_add_f32 v243, 1.0, v243
  v_rcp_f32 v240, v240
  v_rcp_f32 v241, v241
  v_rcp_f32 v242, v242
  v_rcp_f32 v243, v243
  v_mul_f32 v16, v16, v240
  v_mul_f32 v17, v17, v241
  v_mul_f32 v18, v18, v242
  v_mul_f32 v19, v19, v243
  v_lshlrev_b32 v240, 16, v96
  v_and_b32 v241, 0xffff0000, v96
  v_lshlrev_b32 v242, 16, v97
  v_and_b32 v243, 0xffff0000, v97
  v_fma_f32 v16, v0, v16, v240
  v_fma_f32 v17, v1, v17, v241
  v_fma_f32 v18, v2, v18, v242
  v_fma_f32 v19, v3, v19, v243
  v_cvt_pk_bf16_f32 v48, v16, v17
  v_cvt_pk_bf16_f32 v49, v18, v19
  buffer_store_dwordx2 v[48:49], v233, s[32:35], s98 offen offset:0
  v_mul_f32 v240, 0xbfb8aa3b, v20
  v_mul_f32 v241, 0xbfb8aa3b, v21
  v_mul_f32 v242, 0xbfb8aa3b, v22
  v_mul_f32 v243, 0xbfb8aa3b, v23
  v_exp_f32 v240, v240
  v_exp_f32 v241, v241
  v_exp_f32 v242, v242
  v_exp_f32 v243, v243
  v_add_f32 v240, 1.0, v240
  v_add_f32 v241, 1.0, v241
  v_add_f32 v242, 1.0, v242
  v_add_f32 v243, 1.0, v243
  v_rcp_f32 v240, v240
  v_rcp_f32 v241, v241
  v_rcp_f32 v242, v242
  v_rcp_f32 v243, v243
  v_mul_f32 v20, v20, v240
  v_mul_f32 v21, v21, v241
  v_mul_f32 v22, v22, v242
  v_mul_f32 v23, v23, v243
  v_lshlrev_b32 v240, 16, v98
  v_and_b32 v241, 0xffff0000, v98
  v_lshlrev_b32 v242, 16, v99
  v_and_b32 v243, 0xffff0000, v99
  v_fma_f32 v20, v4, v20, v240
  v_fma_f32 v21, v5, v21, v241
  v_fma_f32 v22, v6, v22, v242
  v_fma_f32 v23, v7, v23, v243
  v_cvt_pk_bf16_f32 v50, v20, v21
  v_cvt_pk_bf16_f32 v51, v22, v23
  buffer_store_dwordx2 v[50:51], v233, s[32:35], s98 offen offset:16
  v_mul_f32 v240, 0xbfb8aa3b, v24
  v_mul_f32 v241, 0xbfb8aa3b, v25
  v_mul_f32 v242, 0xbfb8aa3b, v26
  v_mul_f32 v243, 0xbfb8aa3b, v27
  v_exp_f32 v240, v240
  v_exp_f32 v241, v241
  v_exp_f32 v242, v242
  v_exp_f32 v243, v243
  v_add_f32 v240, 1.0, v240
  v_add_f32 v241, 1.0, v241
  v_add_f32 v242, 1.0, v242
  v_add_f32 v243, 1.0, v243
  v_rcp_f32 v240, v240
  v_rcp_f32 v241, v241
  v_rcp_f32 v242, v242
  v_rcp_f32 v243, v243
  v_mul_f32 v24, v24, v240
  v_mul_f32 v25, v25, v241
  v_mul_f32 v26, v26, v242
  v_mul_f32 v27, v27, v243
  v_lshlrev_b32 v240, 16, v100
  v_and_b32 v241, 0xffff0000, v100
  v_lshlrev_b32 v242, 16, v101
  v_and_b32 v243, 0xffff0000, v101
  v_fma_f32 v24, v8, v24, v240
  v_fma_f32 v25, v9, v25, v241
  v_fma_f32 v26, v10, v26, v242
  v_fma_f32 v27, v11, v27, v243
  v_cvt_pk_bf16_f32 v52, v24, v25
  v_cvt_pk_bf16_f32 v53, v26, v27
  buffer_store_dwordx2 v[52:53], v233, s[32:35], s98 offen offset:32
  v_mul_f32 v240, 0xbfb8aa3b, v28
  v_mul_f32 v241, 0xbfb8aa3b, v29
  v_mul_f32 v242, 0xbfb8aa3b, v30
  v_mul_f32 v243, 0xbfb8aa3b, v31
  v_exp_f32 v240, v240
  v_exp_f32 v241, v241
  v_exp_f32 v242, v242
  v_exp_f32 v243, v243
  v_add_f32 v240, 1.0, v240
  v_add_f32 v241, 1.0, v241
  v_add_f32 v242, 1.0, v242
  v_add_f32 v243, 1.0, v243
  v_rcp_f32 v240, v240
  v_rcp_f32 v241, v241
  v_rcp_f32 v242, v242
  v_rcp_f32 v243, v243
  v_mul_f32 v28, v28, v240
  v_mul_f32 v29, v29, v241
  v_mul_f32 v30, v30, v242
  v_mul_f32 v31, v31, v243
  v_lshlrev_b32 v240, 16, v102
  v_and_b32 v241, 0xffff0000, v102
  v_lshlrev_b32 v242, 16, v103
  v_and_b32 v243, 0xffff0000, v103
  v_fma_f32 v28, v12, v28, v240
  v_fma_f32 v29, v13, v29, v241
  v_fma_f32 v30, v14, v30, v242
  v_fma_f32 v31, v15, v31, v243
  v_cvt_pk_bf16_f32 v54, v28, v29
  v_cvt_pk_bf16_f32 v55, v30, v31
  buffer_store_dwordx2 v[54:55], v233, s[32:35], s98 offen offset:48
  s_waitcnt lgkmcnt(0)
  s_barrier
  s_lshr_b32 s47, s46, 1
  s_lshl_b32 s47, s47, 10
  s_and_b32 s68, s46, 1
  s_lshl_b32 s68, s68, 3
  s_add_u32 s47, s47, s68
  s_add_u32 s47, s47, 73728
  v_add_u32 v239, s47, v224
  ds_read_b64 v[40:41], v239 offset:0
  ds_read_b64 v[42:43], v239 offset:2048
  ds_read_b64 v[44:45], v239 offset:4096
  ds_read_b64 v[46:47], v239 offset:6144
  s_waitcnt lgkmcnt(2)
  v_add_f32 v40, v40, v42
  s_waitcnt lgkmcnt(0)
  v_add_f32 v44, v44, v46
  v_add_f32 v41, v41, v43
  v_add_f32 v45, v45, v47
  v_add_f32 v40, v40, v44
  v_add_f32 v41, v41, v45
  v_mul_f32 v240, 0xbfb8aa3b, v40
  v_mul_f32 v241, 0xbfb8aa3b, v41
  v_exp_f32 v240, v240
  v_exp_f32 v241, v241
  v_add_f32 v240, 1.0, v240
  v_add_f32 v241, 1.0, v241
  v_rcp_f32 v240, v240
  v_rcp_f32 v241, v241
  v_mul_f32 v40, v40, v240
  v_mul_f32 v41, v41, v241
  v_lshlrev_b32 v240, 16, v104
  v_and_b32 v241, 0xffff0000, v104
  v_fma_f32 v40, v64, v40, v240
  v_fma_f32 v41, v65, v41, v241
  v_cvt_pk_bf16_f32 v56, v40, v41
  buffer_store_dword v56, v233, s[32:35], s79 offen
  s_endpgm
L_slow0:
  s_mov_b32 s83, 0x4000
L_spin0:
  s_sleep 8
  buffer_load_dword v251, v252, s[36:39], s0 offen sc1
  s_waitcnt vmcnt(0)
  v_cmp_gt_u32 vcc, 16, v251
  s_nop 4
  s_cbranch_vccz L_ret0
  s_sub_u32 s83, s83, 1
  s_cmp_lg_u32 s83, 0
  s_cbranch_scc1 L_spin0
  s_branch L_ret0
L_slow1:
  s_mov_b32 s83, 0x4000
L_spin1:
  s_sleep 8
  buffer_load_dword v251, v254, s[36:39], 0 offen sc1
  s_waitcnt vmcnt(0)
  v_cmp_gt_u32 vcc, 16, v251
  s_nop 4
  s_cbranch_vccz L_ret1
  s_sub_u32 s83, s83, 1
  s_cmp_lg_u32 s83, 0
  s_cbranch_scc1 L_spin1
  s_branch L_ret1
L_slow2:
  s_mov_b32 s83, 0x4000
L_spin2:
  s_sleep 8
  buffer_load_dword v251, v252, s[40:43], s67 offen sc1
  s_waitcnt vmcnt(0)
  v_cmp_gt_u32 vcc, 2, v251
  s_nop 4
  s_cbranch_vccz L_ret2
  s_sub_u32 s83, s83, 1
  s_cmp_lg_u32 s83, 0
  s_cbranch_scc1 L_spin2
  s_branch L_ret2
L_slow3:
  s_mov_b32 s83, 0x4000
L_spin3:
  s_sleep 8
  buffer_load_dword v251, v252, s[40:43], s67 offen sc1
  s_waitcnt vmcnt(0)
  v_cmp_gt_u32 vcc, 4, v251
  s_nop 4
  s_cbranch_vccz L_ret3
  s_sub_u32 s83, s83, 1
  s_cmp_lg_u32 s83, 0
  s_cbranch_scc1 L_spin3
  s_branch L_ret3
L_slow4:
  s_mov_b32 s83, 0x4000
L_spin4:
  s_sleep 8
  buffer_load_dword v251, v252, s[40:43], s67 offen sc1
  s_waitcnt vmcnt(0)
  v_cmp_gt_u32 vcc, 6, v251
  s_nop 4
  s_cbranch_vccz L_ret4
  s_sub_u32 s83, s83, 1
  s_cmp_lg_u32 s83, 0
  s_cbranch_scc1 L_spin4
  s_branch L_ret4
L_slow5:
  s_mov_b32 s83, 0x4000
L_spin5:
  s_sleep 8
  buffer_load_dword v251, v252, s[40:43], s67 offen sc1
  s_waitcnt vmcnt(0)
  v_cmp_gt_u32 vcc, 8, v251
  s_nop 4
  s_cbranch_vccz L_ret5
  s_sub_u32 s83, s83, 1
  s_cmp_lg_u32 s83, 0
  s_cbranch_scc1 L_spin5
  s_branch L_ret5
L_slow6:
  s_mov_b32 s83, 0x4000
L_spin6:
  s_sleep 8
  buffer_load_dword v251, v252, s[40:43], s67 offen sc1
  s_waitcnt vmcnt(0)
  v_cmp_gt_u32 vcc, 9, v251
  s_nop 4
  s_cbranch_vccz L_ret6
  s_sub_u32 s83, s83, 1
  s_cmp_lg_u32 s83, 0
  s_cbranch_scc1 L_spin6
  s_branch L_ret6
L_slow7:
  s_mov_b32 s83, 0x4000
L_spin7:
  s_sleep 8
  buffer_load_dword v251, v254, s[40:43], s4 offen sc1
  s_waitcnt vmcnt(0)
  v_cmp_ne_u32 vcc, 1, v251
  s_nop 4
  s_cbranch_vccz L_ret7
  s_sub_u32 s83, s83, 1
  s_cmp_lg_u32 s83, 0
  s_cbranch_scc1 L_spin7
  s_branch L_ret7
L_end:
  s_endpgm
L_code_end:
.set CODE_BYTES_M4, L_code_end-recurrent_scan__linear_attn_block__glu_gated_geglu__prompt_kernel-4
.section .rodata,"a"
.p2align 6
.amdhsa_kernel recurrent_scan__linear_attn_block__glu_gated_geglu__prompt_kernel
  .amdhsa_next_free_vgpr 512
  .amdhsa_next_free_sgpr 102
  .amdhsa_accum_offset 256
  .amdhsa_group_segment_fixed_size 0
  .amdhsa_kernarg_size 80
  .amdhsa_user_sgpr_count 2
  .amdhsa_user_sgpr_kernarg_segment_ptr 1
  .amdhsa_system_sgpr_workgroup_id_x 1
.end_amdhsa_kernel
```
